```python
import torch

def _softmax(x, axis=-1):
    return torch.softmax(x, dim=axis)
def _gelu(x):
    return torch.nn.functional.gelu(x, approximate="tanh")
def _silu(x):
    return torch.nn.functional.silu(x)
def _sigmoid(x):
    return torch.sigmoid(x)
def _layernorm(x, axis=-1, eps=1e-5):
    m = x.mean(dim=axis, keepdim=True)
    v = x.var(dim=axis, keepdim=True, unbiased=False)
    return (x - m) / torch.sqrt(v + eps)
def _scatter_add(tgt, idx, src, axis=0):
    return tgt.clone().index_add_(axis, idx, src)
def _segment_sum(src, seg, n):
    out = torch.zeros((n,) + src.shape[1:], dtype=src.dtype)
    return out.index_add_(0, seg, src)
def _pad(x, pw):
    flat = tuple(v for pair in reversed(pw) for v in pair)
    return torch.nn.functional.pad(x, flat)

kernel_name = 'parallel_sum__grouped_kv_mqa__dense_activation_mish__prompt'

def setup_inputs():

    _w = (lambda a: (lambda t: t.to(torch.bfloat16) if t.is_floating_point() else t)(torch.as_tensor(a)))
    def _A_setup():
        B, S, D, H = 1, 2048, 512, 32
        Dh = D // H
        return {
            "x": _w((lambda *s: torch.randn(*s, dtype=torch.bfloat16) * 0.05)(B, S, D)),
            "wq": _w((lambda *s: torch.randn(*s, dtype=torch.bfloat16) * 0.05)(D, H * Dh)),
            "wk": _w((lambda *s: torch.randn(*s, dtype=torch.bfloat16) * 0.05)(D, Dh)),
            "wv": _w((lambda *s: torch.randn(*s, dtype=torch.bfloat16) * 0.05)(D, Dh)),
            "wo": _w((lambda *s: torch.randn(*s, dtype=torch.bfloat16) * 0.05)(H * Dh, D)),
        }
    _A_in = _A_setup()

    def _B_setup():
        B, S, D, F = 1, 2048, 512, 1376
        return {
            "x": _w((lambda *s: torch.randn(*s, dtype=torch.bfloat16) * 0.05)(B, S, D)),
            "w1": _w((lambda *s: torch.randn(*s, dtype=torch.bfloat16) * 0.8)(D, F) * (D ** -0.5)),
            "b1": _w((lambda *s: torch.randn(*s, dtype=torch.bfloat16) * 0.4)(F)),
            "w2": _w((lambda *s: torch.randn(*s, dtype=torch.bfloat16) * 0.4)(F, D) * (F ** -0.5)),
        }
    _B_in = _B_setup()

    return {
        "A_x": _A_in["x"],
        "A_wq": _A_in["wq"],
        "A_wk": _A_in["wk"],
        "A_wv": _A_in["wv"],
        "A_wo": _A_in["wo"],
        "B_x": _B_in["x"],
        "B_w1": _B_in["w1"],
        "B_b1": _B_in["b1"],
        "B_w2": _B_in["w2"],
    }

def reference(A_x, A_wq, A_wk, A_wv, A_wo, B_x, B_w1, B_b1, B_w2):
    def _A_ref(x, wq, wk, wv, wo):
        B, S, D = x.shape
        H = 32
        Dh = D // H
        q = (lambda x, *d: x.permute(*d))((x @ wq).reshape(B, S, H, Dh), 0, 2, 1, 3)
        k = x @ wk
        v = x @ wv
        scores = torch.einsum("bhqd,bkd->bhqk", q, k) * (Dh ** -0.5)
        p = _softmax(scores, axis=-1)
        o = torch.einsum("bhqk,bkd->bhqd", p, v)
        return (lambda x, *d: x.permute(*d))(o, 0, 2, 1, 3).reshape(B, S, H * Dh) @ wo

    def _B_ref(x, w1, b1, w2):
        h = torch.einsum("bsd,df->bsf", x, w1) + b1
        sp = torch.log1p(torch.exp(-torch.abs(h))) + torch.where(h > 0, h, torch.zeros_like(h))
        act = h * torch.tanh(sp)
        return torch.einsum("bsf,fd->bsd", act, w2)

    x = A_x
    xn = _layernorm(x, axis=-1)
    return x + _A_ref(xn, A_wq, A_wk, A_wv, A_wo) + _B_ref(xn, B_w1, B_b1, B_w2)
```

```asm
; @launch grid=(256,1,1) block=(768,1,1) lds=163840
.amdgcn_target "amdgcn-amd-amdhsa--gfx950"
.text
.globl parallel_sum__grouped_kv_mqa__dense_activation_mish__prompt_kernel
.p2align 8
.type parallel_sum__grouped_kv_mqa__dense_activation_mish__prompt_kernel,@function
parallel_sum__grouped_kv_mqa__dense_activation_mish__prompt_kernel:
L_start:
    s_cmp_ge_u32 s2, 256
    s_cbranch_scc1 L_end
    s_load_dwordx16 s[8:23], s[0:1], 0
    s_load_dwordx8 s[24:31], s[0:1], 64
    v_lshrrev_b32 v1, 6, v0
    v_and_b32 v167, 63, v0
    v_readfirstlane_b32 s3, v1
    s_and_b32 s56, s2, 7
    s_bfe_u32 s7, s2, 0x20003
    s_lshl_b32 s4, s56, 2
    s_add_u32 s4, s4, s7
    s_lshr_b32 s5, s2, 5
    s_mov_b32 s62, 147456
    s_cmp_ge_u32 s3, 8
    s_cbranch_scc1 L_G
    s_lshl_b32 s56, s5, 2
    s_xor_b32 s56, s56, s3
    s_and_b32 s56, s56, 4
    s_lshr_b32 s57, s5, 1
    s_add_u32 s57, s57, s3
    s_and_b32 s57, s57, 3
    s_or_b32 s64, s56, s57
    v_lshrrev_b32 v160, 3, v167
    v_and_b32 v161, 7, v167
    v_lshlrev_b32 v162, 10, v160
    v_lshl_add_u32 v162, v161, 4, v162
    s_lshl_b32 s56, s4, 16
    s_lshl_b32 s57, s64, 13
    s_add_u32 s56, s56, s57
    s_add_u32 s57, s7, 0
    s_and_b32 s57, s57, 3
    s_lshl_b32 s57, s57, 7
    s_add_u32 s68, s57, s56
    s_add_u32 s57, s7, 1
    s_and_b32 s57, s57, 3
    s_lshl_b32 s57, s57, 7
    s_add_u32 s69, s57, s56
    s_add_u32 s57, s7, 2
    s_and_b32 s57, s57, 3
    s_lshl_b32 s57, s57, 7
    s_add_u32 s70, s57, s56
    s_add_u32 s57, s7, 3
    s_and_b32 s57, s57, 3
    s_lshl_b32 s57, s57, 7
    s_add_u32 s71, s57, s56
    s_mov_b32 s34, 2097152
    s_mov_b32 s35, 0x20000
    s_lshr_b32 s57, s5, 2
    s_lshr_b32 s58, s3, 2
    s_or_b32 s63, s57, s58
    s_cbranch_scc1 L_A_nowkv
    s_mov_b32 s42, 16384
    s_mov_b32 s43, 0x20000
    v_bfe_u32 v96, v167, 3, 2
    v_lshrrev_b32 v97, 5, v167
    v_lshl_add_u32 v96, v96, 1, v97
    v_lshlrev_b32 v97, 4, v161
    v_lshl_add_u32 v96, v96, 7, v97
    s_lshl_b32 s57, s3, 12
    s_add_u32 m0, s57, 71680
    s_lshr_b32 s58, s3, 1
    s_lshl_b32 s58, s58, 13
    s_and_b32 s59, s3, 1
    s_lshl_b32 s59, s59, 1
    s_add_u32 s59, s59, s7
    s_and_b32 s57, s59, 3
    s_lshl_b32 s57, s57, 11
    s_add_u32 s74, s57, s58
    s_add_u32 s59, s59, 1
    s_and_b32 s57, s59, 3
    s_lshl_b32 s57, s57, 11
    s_add_u32 s75, s57, s58
    s_add_u32 s59, s59, 1
    s_cmp_lt_u32 s5, 2
    s_waitcnt lgkmcnt(0)
    s_cselect_b32 s40, s12, s14
    s_cselect_b32 s41, s13, s15
    buffer_load_dwordx4 v96, s[40:43], s74 offen lds
    buffer_load_dwordx4 v96, s[40:43], s74 offen offset:1024 lds
    s_add_u32 m0, m0, 0x800
    s_mov_b32 s32, s8
    buffer_load_dwordx4 v96, s[40:43], s75 offen lds
    buffer_load_dwordx4 v96, s[40:43], s75 offen offset:1024 lds
    s_branch L_A_first
L_A_nowkv:
    s_cmp_ge_u32 s3, 4
    s_cbranch_scc0 L_A_first0
    v_mov_b32 v108, 0
    v_mov_b32 v109, 0
    v_lshlrev_b32 v96, 4, v167
    v_add_u32 v96, 65536, v96
    ds_write_b64 v96, v[108:109] offset:8
    s_waitcnt lgkmcnt(0)
    s_barrier
L_A_first0:
    s_waitcnt lgkmcnt(0)
    s_mov_b32 s32, s8
L_A_first:
    s_mov_b32 s33, s9
    buffer_load_dwordx4 v[0:3], v162, s[32:35], s68 offen offset:0 nt
    buffer_load_dwordx4 v[4:7], v162, s[32:35], s69 offen offset:0 nt
    buffer_load_dwordx4 v[8:11], v162, s[32:35], s70 offen offset:0 nt
    buffer_load_dwordx4 v[12:15], v162, s[32:35], s71 offen offset:0 nt
    buffer_load_dwordx4 v[16:19], v162, s[32:35], s68 offen offset:512 nt
    buffer_load_dwordx4 v[20:23], v162, s[32:35], s69 offen offset:512 nt
    buffer_load_dwordx4 v[24:27], v162, s[32:35], s70 offen offset:512 nt
    buffer_load_dwordx4 v[28:31], v162, s[32:35], s71 offen offset:512 nt
    v_lshlrev_b32 v165, 2, v167
    v_add_u32 v165, 65536, v165
    s_mov_b32 s48, s30
    s_mov_b32 s49, s31
    s_mov_b32 s50, 9437184
    s_mov_b32 s51, 0x20000
    s_cmp_ge_u32 s3, 4
    s_cbranch_scc1 L_A_hi0
    s_setprio 2
    buffer_load_dword v110, off, s[48:51], s62 sc1
    s_barrier
    s_branch L_A_setup
L_A_hi0:
    s_setprio 1
L_A_setup:
    v_lshlrev_b32 v166, 4, v167
    v_add_u32 v166, 65536, v166
    v_mov_b32 v164, 0xdddd
    v_mov_b32 v109, 0
    s_and_b32 s57, s64, 3
    s_lshl_b32 s57, s57, 3
    v_add_u32 v163, s57, v160
    v_xor_b32 v163, v163, v161
    v_lshlrev_b32 v163, 4, v163
    v_lshrrev_b32 v96, 1, v161
    v_lshl_add_u32 v163, v96, 10, v163
    v_and_b32 v96, 1, v161
    v_lshl_add_u32 v163, v96, 9, v163
    s_lshr_b32 s57, s64, 2
    s_lshl_b32 s57, s57, 15
    v_add_u32 v163, s57, v163
    s_lshl_b32 s57, s64, 5
    s_add_u32 s57, s57, 65536
    v_lshl_add_u32 v162, v160, 2, s57
    s_mov_b32 s60, 0x3f803f80
    s_mov_b32 s61, 0x00003f80
    v_mov_b32 v96, 0
    v_mov_b32 v97, 0
    v_mov_b32 v98, 0
    v_mov_b32 v99, 0
    v_mov_b32 v123, 65536
    s_mov_b32 s62, 0x3f800000
    s_cmp_eq_u32 s63, 0
    s_cbranch_scc1 L_A_prod
    s_cmp_ge_u32 s3, 4
    s_cbranch_scc0 L_A_w1
    s_waitcnt vmcnt(0)
L_A_w1:
    s_waitcnt vmcnt(1)
    v_dot2c_f32_bf16 v96, s60, v0
    v_dot2c_f32_bf16 v98, v0, v0
    v_dot2c_f32_bf16 v97, s60, v1
    v_dot2c_f32_bf16 v99, v1, v1
    v_dot2c_f32_bf16 v96, s60, v2
    v_dot2c_f32_bf16 v98, v2, v2
    v_dot2c_f32_bf16 v97, s60, v3
    v_dot2c_f32_bf16 v99, v3, v3
    v_dot2c_f32_bf16 v96, s60, v4
    v_dot2c_f32_bf16 v98, v4, v4
    v_dot2c_f32_bf16 v97, s60, v5
    v_dot2c_f32_bf16 v99, v5, v5
    v_dot2c_f32_bf16 v96, s60, v6
    v_dot2c_f32_bf16 v98, v6, v6
    v_dot2c_f32_bf16 v97, s60, v7
    v_dot2c_f32_bf16 v99, v7, v7
    v_dot2c_f32_bf16 v96, s60, v8
    v_dot2c_f32_bf16 v98, v8, v8
    v_dot2c_f32_bf16 v97, s60, v9
    v_dot2c_f32_bf16 v99, v9, v9
    v_dot2c_f32_bf16 v96, s60, v10
    v_dot2c_f32_bf16 v98, v10, v10
    v_dot2c_f32_bf16 v97, s60, v11
    v_dot2c_f32_bf16 v99, v11, v11
    v_dot2c_f32_bf16 v96, s60, v12
    v_dot2c_f32_bf16 v98, v12, v12
    v_dot2c_f32_bf16 v97, s60, v13
    v_dot2c_f32_bf16 v99, v13, v13
    v_dot2c_f32_bf16 v96, s60, v14
    v_dot2c_f32_bf16 v98, v14, v14
    v_dot2c_f32_bf16 v97, s60, v15
    v_dot2c_f32_bf16 v99, v15, v15
    v_dot2c_f32_bf16 v96, s60, v16
    v_dot2c_f32_bf16 v98, v16, v16
    v_dot2c_f32_bf16 v97, s60, v17
    v_dot2c_f32_bf16 v99, v17, v17
    v_dot2c_f32_bf16 v96, s60, v18
    v_dot2c_f32_bf16 v98, v18, v18
    v_dot2c_f32_bf16 v97, s60, v19
    v_dot2c_f32_bf16 v99, v19, v19
    v_dot2c_f32_bf16 v96, s60, v20
    v_dot2c_f32_bf16 v98, v20, v20
    v_dot2c_f32_bf16 v97, s60, v21
    v_dot2c_f32_bf16 v99, v21, v21
    v_dot2c_f32_bf16 v96, s60, v22
    v_dot2c_f32_bf16 v98, v22, v22
    v_dot2c_f32_bf16 v97, s60, v23
    v_dot2c_f32_bf16 v99, v23, v23
    v_dot2c_f32_bf16 v96, s60, v24
    v_dot2c_f32_bf16 v98, v24, v24
    v_dot2c_f32_bf16 v97, s60, v25
    v_dot2c_f32_bf16 v99, v25, v25
    v_dot2c_f32_bf16 v96, s60, v26
    v_dot2c_f32_bf16 v98, v26, v26
    v_dot2c_f32_bf16 v97, s60, v27
    v_dot2c_f32_bf16 v99, v27, v27
    v_dot2c_f32_bf16 v96, s60, v28
    v_dot2c_f32_bf16 v98, v28, v28
    v_dot2c_f32_bf16 v97, s60, v29
    v_dot2c_f32_bf16 v99, v29, v29
    v_dot2c_f32_bf16 v96, s60, v30
    v_dot2c_f32_bf16 v98, v30, v30
    v_dot2c_f32_bf16 v97, s60, v31
    v_dot2c_f32_bf16 v99, v31, v31
    s_nop 1
    v_add_f32 v96, v96, v97
    v_add_f32 v98, v98, v99
    s_nop 0
    v_add_f32_dpp v96, v96, v96 quad_perm:[1,0,3,2] row_mask:0xf bank_mask:0xf
    v_add_f32_dpp v98, v98, v98 quad_perm:[1,0,3,2] row_mask:0xf bank_mask:0xf
    s_nop 0
    v_add_f32_dpp v96, v96, v96 quad_perm:[2,3,0,1] row_mask:0xf bank_mask:0xf
    v_add_f32_dpp v98, v98, v98 quad_perm:[2,3,0,1] row_mask:0xf bank_mask:0xf
    s_nop 0
    v_add_f32_dpp v96, v96, v96 row_half_mirror row_mask:0xf bank_mask:0xf
    v_add_f32_dpp v98, v98, v98 row_half_mirror row_mask:0xf bank_mask:0xf
    v_mul_f32 v96, 0xbb000000, v96
    v_mul_f32 v98, 0x3b000000, v98
    v_cvt_pk_bf16_f32 v97, v96, v96
    v_fma_f32 v98, -v96, v96, v98
    v_max_f32 v98, 0, v98
    v_lshlrev_b32 v97, 16, v97
    v_cvt_pk_bf16_f32 v98, v98, v98
    v_lshlrev_b32 v98, 16, v98
    v_add_f32 v98, 0x3727c5ac, v98
    v_cvt_pk_bf16_f32 v98, v98, v98
    v_lshlrev_b32 v98, 16, v98
    v_sqrt_f32 v98, v98
    s_nop 0
    v_cvt_pk_bf16_f32 v99, v98, 0
    v_lshlrev_b32 v98, 16, v99
    v_rcp_f32 v98, v98
    ds_write_b32 v162, v99 offset:2304
    ds_write_b32 v162, v98 offset:2048
    s_branch L_A_center
L_A_prod:
    v_lshrrev_b32 v112, 4, v167
    s_and_b32 s59, s64, 3
    s_lshl_b32 s59, s59, 3
    v_add_u32 v114, s59, v161
    v_xor_b32 v114, v114, v112
    v_lshrrev_b32 v115, 1, v112
    v_and_b32 v116, 1, v112
    v_lshlrev_b32 v117, 10, v115
    v_lshl_add_u32 v117, v116, 9, v117
    s_lshr_b32 s59, s64, 2
    s_lshl_b32 s59, s59, 15
    v_add_u32 v117, s59, v117
    v_lshl_add_u32 v120, v114, 4, v117
    v_xor_b32 v114, 4, v114
    v_lshl_add_u32 v121, v114, 4, v117
    s_mov_b32 s59, 71680
    v_lshl_add_u32 v122, v167, 3, s59
    s_lshl_b32 s59, s64, 5
    s_add_u32 s59, s59, 65536
    s_lshl_b32 s72, s4, 11
    s_lshl_b32 s73, s4, 2
    s_add_u32 s73, s73, s5
    s_lshl_b32 s73, s73, 7
    s_add_u32 s73, s73, 131072
    s_cmp_lt_u32 s5, 2
    s_cbranch_scc0 L_A_sv
    v_lshl_add_u32 v160, v161, 2, s59
    v_lshlrev_b32 v118, 9, v116
    v_lshl_add_u32 v118, v161, 4, v118
    v_lshl_add_u32 v161, v115, 3, v118
    s_lshr_b32 s59, s64, 2
    s_lshl_b32 s59, s59, 10
    s_add_u32 s72, s72, s59
    s_and_b32 s59, s64, 3
    s_lshl_b32 s59, s59, 7
    s_add_u32 s72, s72, s59
    s_branch L_A_sk
L_A_sv:
    v_lshl_add_u32 v160, v116, 4, s59
    v_and_b32 v118, 15, v167
    v_lshlrev_b32 v118, 4, v118
    v_lshl_add_u32 v161, v112, 3, v118
    s_lshl_b32 s59, s64, 8
    s_add_u32 s72, s72, s59
    s_add_u32 s72, s72, 65536
L_A_sk:
    s_mov_b32 s74, 0x3f803f80
    s_mov_b32 s75, 0x3f803f80
    v_pk_mov_b32 v[124:125], s[74:75], s[74:75]
    v_pk_mov_b32 v[126:127], s[74:75], s[74:75]
    v_pk_mov_b32 v[128:129], s[74:75], s[74:75]
    v_pk_mov_b32 v[130:131], s[74:75], s[74:75]
    v_pk_mov_b32 v[132:133], s[74:75], s[74:75]
    v_pk_mov_b32 v[134:135], s[74:75], s[74:75]
    v_pk_mov_b32 v[136:137], s[74:75], s[74:75]
    v_pk_mov_b32 v[138:139], s[74:75], s[74:75]
    v_pk_mov_b32 v[140:141], s[74:75], s[74:75]
    v_pk_mov_b32 v[142:143], s[74:75], s[74:75]
    v_pk_mov_b32 v[144:145], s[74:75], s[74:75]
    v_pk_mov_b32 v[146:147], s[74:75], s[74:75]
    v_pk_mov_b32 v[148:149], s[74:75], s[74:75]
    v_pk_mov_b32 v[150:151], s[74:75], s[74:75]
    v_pk_mov_b32 v[152:153], s[74:75], s[74:75]
    v_pk_mov_b32 v[154:155], s[74:75], s[74:75]
    v_pk_mov_b32 v[156:157], s[74:75], s[74:75]
    v_pk_mov_b32 v[158:159], s[74:75], s[74:75]
    s_mov_b32 s58, 0x00ff00ff
    s_mov_b32 s59, 0x00ff00ff
    s_waitcnt vmcnt(9)
    s_mov_b64 exec, 1
    ds_inc_u32 v165, v164 offset:280
    s_mov_b64 exec, -1
    s_mov_b32 s76, 0x40000
L_spin_1:
    ds_read_b32 v115, v165 offset:280
    s_waitcnt lgkmcnt(0)
    v_readfirstlane_b32 s77, v115
    s_nop 0
    s_cmp_ge_u32 s77, 4
    s_cbranch_scc1 L_spun_2
    s_sub_u32 s76, s76, 1
    s_cbranch_scc0 L_spin_1
L_spun_2:
    ds_read_b64_tr_b16 v[32:33], v122 offset:0
    ds_read_b64_tr_b16 v[34:35], v122 offset:512
    ds_read_b64_tr_b16 v[36:37], v122 offset:1024
    ds_read_b64_tr_b16 v[38:39], v122 offset:1536
    ds_read_b64_tr_b16 v[40:41], v122 offset:2048
    ds_read_b64_tr_b16 v[42:43], v122 offset:2560
    ds_read_b64_tr_b16 v[44:45], v122 offset:3072
    ds_read_b64_tr_b16 v[46:47], v122 offset:3584
    ds_read_b64_tr_b16 v[48:49], v122 offset:4096
    ds_read_b64_tr_b16 v[50:51], v122 offset:4608
    ds_read_b64_tr_b16 v[52:53], v122 offset:5120
    ds_read_b64_tr_b16 v[54:55], v122 offset:5632
    ds_read_b64_tr_b16 v[56:57], v122 offset:6144
    ds_read_b64_tr_b16 v[58:59], v122 offset:6656
    ds_read_b64_tr_b16 v[60:61], v122 offset:7168
    ds_read_b64_tr_b16 v[62:63], v122 offset:7680
    ds_read_b64_tr_b16 v[64:65], v122 offset:8192
    ds_read_b64_tr_b16 v[66:67], v122 offset:8704
    ds_read_b64_tr_b16 v[68:69], v122 offset:9216
    ds_read_b64_tr_b16 v[70:71], v122 offset:9728
    ds_read_b64_tr_b16 v[72:73], v122 offset:10240
    ds_read_b64_tr_b16 v[74:75], v122 offset:10752
    ds_read_b64_tr_b16 v[76:77], v122 offset:11264
    ds_read_b64_tr_b16 v[78:79], v122 offset:11776
    ds_read_b64_tr_b16 v[80:81], v122 offset:12288
    ds_read_b64_tr_b16 v[82:83], v122 offset:12800
    ds_read_b64_tr_b16 v[84:85], v122 offset:13312
    ds_read_b64_tr_b16 v[86:87], v122 offset:13824
    ds_read_b64_tr_b16 v[88:89], v122 offset:14336
    ds_read_b64_tr_b16 v[90:91], v122 offset:14848
    ds_read_b64_tr_b16 v[92:93], v122 offset:15360
    ds_read_b64_tr_b16 v[94:95], v122 offset:15872
    s_waitcnt vmcnt(1)
    ds_write_b128 v163, v[0:3] offset:0
    v_dot2c_f32_bf16 v96, s60, v0
    v_dot2c_f32_bf16 v98, v0, v0
    v_dot2c_f32_bf16 v97, s60, v1
    v_dot2c_f32_bf16 v99, v1, v1
    v_dot2c_f32_bf16 v96, s60, v2
    v_dot2c_f32_bf16 v98, v2, v2
    v_dot2c_f32_bf16 v97, s60, v3
    v_dot2c_f32_bf16 v99, v3, v3
    ds_write_b128 v163, v[4:7] offset:4096
    v_dot2c_f32_bf16 v96, s60, v4
    v_dot2c_f32_bf16 v98, v4, v4
    v_dot2c_f32_bf16 v97, s60, v5
    v_dot2c_f32_bf16 v99, v5, v5
    v_dot2c_f32_bf16 v96, s60, v6
    v_dot2c_f32_bf16 v98, v6, v6
    v_dot2c_f32_bf16 v97, s60, v7
    v_dot2c_f32_bf16 v99, v7, v7
    ds_write_b128 v163, v[8:11] offset:8192
    v_dot2c_f32_bf16 v96, s60, v8
    v_dot2c_f32_bf16 v98, v8, v8
    v_dot2c_f32_bf16 v97, s60, v9
    v_dot2c_f32_bf16 v99, v9, v9
    v_dot2c_f32_bf16 v96, s60, v10
    v_dot2c_f32_bf16 v98, v10, v10
    v_dot2c_f32_bf16 v97, s60, v11
    v_dot2c_f32_bf16 v99, v11, v11
    ds_write_b128 v163, v[12:15] offset:12288
    v_dot2c_f32_bf16 v96, s60, v12
    v_dot2c_f32_bf16 v98, v12, v12
    v_dot2c_f32_bf16 v97, s60, v13
    v_dot2c_f32_bf16 v99, v13, v13
    v_dot2c_f32_bf16 v96, s60, v14
    v_dot2c_f32_bf16 v98, v14, v14
    v_dot2c_f32_bf16 v97, s60, v15
    v_dot2c_f32_bf16 v99, v15, v15
    ds_write_b128 v163, v[16:19] offset:16384
    v_dot2c_f32_bf16 v96, s60, v16
    v_dot2c_f32_bf16 v98, v16, v16
    v_dot2c_f32_bf16 v97, s60, v17
    v_dot2c_f32_bf16 v99, v17, v17
    v_dot2c_f32_bf16 v96, s60, v18
    v_dot2c_f32_bf16 v98, v18, v18
    v_dot2c_f32_bf16 v97, s60, v19
    v_dot2c_f32_bf16 v99, v19, v19
    ds_write_b128 v163, v[20:23] offset:20480
    v_dot2c_f32_bf16 v96, s60, v20
    v_dot2c_f32_bf16 v98, v20, v20
    v_dot2c_f32_bf16 v97, s60, v21
    v_dot2c_f32_bf16 v99, v21, v21
    v_dot2c_f32_bf16 v96, s60, v22
    v_dot2c_f32_bf16 v98, v22, v22
    v_dot2c_f32_bf16 v97, s60, v23
    v_dot2c_f32_bf16 v99, v23, v23
    ds_write_b128 v163, v[24:27] offset:24576
    v_dot2c_f32_bf16 v96, s60, v24
    v_dot2c_f32_bf16 v98, v24, v24
    v_dot2c_f32_bf16 v97, s60, v25
    v_dot2c_f32_bf16 v99, v25, v25
    v_dot2c_f32_bf16 v96, s60, v26
    v_dot2c_f32_bf16 v98, v26, v26
    v_dot2c_f32_bf16 v97, s60, v27
    v_dot2c_f32_bf16 v99, v27, v27
    ds_write_b128 v163, v[28:31] offset:28672
    v_dot2c_f32_bf16 v96, s60, v28
    v_dot2c_f32_bf16 v98, v28, v28
    v_dot2c_f32_bf16 v97, s60, v29
    v_dot2c_f32_bf16 v99, v29, v29
    v_dot2c_f32_bf16 v96, s60, v30
    v_dot2c_f32_bf16 v98, v30, v30
    v_dot2c_f32_bf16 v97, s60, v31
    v_dot2c_f32_bf16 v99, v31, v31
    s_mov_b64 exec, s[58:59]
    ds_read_b128 v[124:127], v120 offset:0
    ds_read_b128 v[128:131], v121 offset:2048
    ds_read_b128 v[132:135], v120 offset:4096
    ds_read_b128 v[136:139], v121 offset:6144
    ds_read_b128 v[140:143], v120 offset:8192
    ds_read_b128 v[144:147], v121 offset:10240
    ds_read_b128 v[148:151], v120 offset:12288
    ds_read_b128 v[152:155], v121 offset:14336
    ds_read_b128 v[156:159], v120 offset:16384
    s_mov_b64 exec, -1
    v_add_f32 v96, v96, v97
    v_add_f32 v98, v98, v99
    s_nop 0
    v_add_f32_dpp v96, v96, v96 quad_perm:[1,0,3,2] row_mask:0xf bank_mask:0xf
    v_add_f32_dpp v98, v98, v98 quad_perm:[1,0,3,2] row_mask:0xf bank_mask:0xf
    s_nop 0
    v_add_f32_dpp v96, v96, v96 quad_perm:[2,3,0,1] row_mask:0xf bank_mask:0xf
    v_add_f32_dpp v98, v98, v98 quad_perm:[2,3,0,1] row_mask:0xf bank_mask:0xf
    s_nop 0
    v_add_f32_dpp v96, v96, v96 row_half_mirror row_mask:0xf bank_mask:0xf
    v_add_f32_dpp v98, v98, v98 row_half_mirror row_mask:0xf bank_mask:0xf
    v_mul_f32 v96, 0xbb000000, v96
    v_mul_f32 v98, 0x3b000000, v98
    v_cvt_pk_bf16_f32 v97, v96, v96
    v_fma_f32 v98, -v96, v96, v98
    ds_write_b32 v162, v96 offset:2560
    v_max_f32 v98, 0, v98
    v_lshlrev_b32 v97, 16, v97
    v_cvt_pk_bf16_f32 v98, v98, v98
    v_lshlrev_b32 v98, 16, v98
    v_add_f32 v98, 0x3727c5ac, v98
    v_cvt_pk_bf16_f32 v98, v98, v98
    v_lshlrev_b32 v98, 16, v98
    v_sqrt_f32 v98, v98
    s_nop 0
    v_cvt_pk_bf16_f32 v99, v98, 0
    v_lshlrev_b32 v98, 16, v99
    v_rcp_f32 v98, v98
    ds_write_b32 v162, v99 offset:2304
    ds_write_b32 v162, v98 offset:2048
    s_cmp_lt_u32 s5, 2
    s_cbranch_scc0 L_kv_v
    ds_read_b32 v112, v160 offset:2048
    ds_read_b32 v116, v160 offset:2560
    s_waitcnt lgkmcnt(13)
    v_mfma_f32_16x16x32_bf16 v[100:103], v[32:35], v[124:127], 0
    s_mov_b64 exec, s[58:59]
    ds_read_b128 v[124:127], v121 offset:18432
    s_mov_b64 exec, -1
    s_waitcnt lgkmcnt(13)
    v_mfma_f32_16x16x32_bf16 v[104:107], v[36:39], v[128:131], 0
    s_mov_b64 exec, s[58:59]
    ds_read_b128 v[128:131], v120 offset:20480
    s_mov_b64 exec, -1
    s_waitcnt lgkmcnt(13)
    v_mfma_f32_16x16x32_bf16 v[100:103], v[40:43], v[132:135], v[100:103]
    s_mov_b64 exec, s[58:59]
    ds_read_b128 v[132:135], v121 offset:22528
    s_mov_b64 exec, -1
    s_waitcnt lgkmcnt(13)
    v_mfma_f32_16x16x32_bf16 v[104:107], v[44:47], v[136:139], v[104:107]
    s_mov_b64 exec, s[58:59]
    ds_read_b128 v[136:139], v120 offset:24576
    s_mov_b64 exec, -1
    s_waitcnt lgkmcnt(13)
    v_mfma_f32_16x16x32_bf16 v[100:103], v[48:51], v[140:143], v[100:103]
    s_mov_b64 exec, s[58:59]
    ds_read_b128 v[140:143], v121 offset:26624
    s_mov_b64 exec, -1
    s_waitcnt lgkmcnt(13)
    v_mfma_f32_16x16x32_bf16 v[104:107], v[52:55], v[144:147], v[104:107]
    s_mov_b64 exec, s[58:59]
    ds_read_b128 v[144:147], v120 offset:28672
    s_mov_b64 exec, -1
    s_waitcnt lgkmcnt(13)
    v_mfma_f32_16x16x32_bf16 v[100:103], v[56:59], v[148:151], v[100:103]
    s_mov_b64 exec, s[58:59]
    ds_read_b128 v[148:151], v121 offset:30720
    s_mov_b64 exec, -1
    s_waitcnt lgkmcnt(13)
    v_mfma_f32_16x16x32_bf16 v[104:107], v[60:63], v[152:155], v[104:107]
    s_waitcnt lgkmcnt(12)
    v_mfma_f32_16x16x32_bf16 v[100:103], v[64:67], v[156:159], v[100:103]
    s_waitcnt lgkmcnt(6)
    v_mfma_f32_16x16x32_bf16 v[104:107], v[68:71], v[124:127], v[104:107]
    s_waitcnt lgkmcnt(5)
    v_mfma_f32_16x16x32_bf16 v[100:103], v[72:75], v[128:131], v[100:103]
    s_waitcnt lgkmcnt(4)
    v_mfma_f32_16x16x32_bf16 v[104:107], v[76:79], v[132:135], v[104:107]
    s_waitcnt lgkmcnt(3)
    v_mfma_f32_16x16x32_bf16 v[100:103], v[80:83], v[136:139], v[100:103]
    s_waitcnt lgkmcnt(2)
    v_mfma_f32_16x16x32_bf16 v[104:107], v[84:87], v[140:143], v[104:107]
    s_waitcnt lgkmcnt(1)
    v_mfma_f32_16x16x32_bf16 v[100:103], v[88:91], v[144:147], v[100:103]
    s_waitcnt lgkmcnt(0)
    v_mfma_f32_16x16x32_bf16 v[104:107], v[92:95], v[148:151], v[104:107]
    s_waitcnt vmcnt(0)
    v_readfirstlane_b32 s6, v110
    s_nop 5
    v_pk_add_f32 v[100:101], v[100:101], v[104:105]
    v_pk_add_f32 v[102:103], v[102:103], v[106:107]
    s_add_u32 s6, s6, 1
    v_mov_b32_dpp v104, v100 row_ror:8 row_mask:0xf bank_mask:0xf
    v_mov_b32_dpp v105, v101 row_ror:8 row_mask:0xf bank_mask:0xf
    v_mov_b32_dpp v106, v102 row_ror:8 row_mask:0xf bank_mask:0xf
    v_mov_b32_dpp v107, v103 row_ror:8 row_mask:0xf bank_mask:0xf
    v_pk_fma_f32 v[100:101], v[104:105], v[116:117], v[100:101] op_sel_hi:[1,0,1]
    v_pk_fma_f32 v[102:103], v[106:107], v[116:117], v[102:103] op_sel_hi:[1,0,1]
    v_pk_mul_f32 v[100:101], v[100:101], v[112:113] op_sel_hi:[1,0]
    v_pk_mul_f32 v[102:103], v[102:103], v[112:113] op_sel_hi:[1,0]
    v_cvt_pk_bf16_f32 v108, v100, v101
    v_cvt_pk_bf16_f32 v109, v102, v103
    s_mov_b64 exec, s[58:59]
    buffer_store_dwordx2 v[108:109], v161, s[48:51], s72 offen sc1
    s_mov_b64 exec, -1
    v_dot2_f32_bf16 v111, v108, v108, 0
    v_dot2_f32_bf16 v111, v109, v109, v111
    s_nop 2
    v_mov_b32 v112, v111
    s_nop 1
    v_permlane32_swap_b32 v111, v112
    v_add_f32 v111, v111, v112
    s_mov_b64 exec, s[58:59]
    s_branch L_kv_pub
L_kv_v:
    ds_read_b128 v[112:115], v160 offset:2048
    ds_read_b128 v[116:119], v160 offset:2560
    s_waitcnt lgkmcnt(13)
    v_mfma_f32_16x16x32_bf16 v[100:103], v[124:127], v[32:35], 0
    s_mov_b64 exec, s[58:59]
    ds_read_b128 v[124:127], v121 offset:18432
    s_mov_b64 exec, -1
    s_waitcnt lgkmcnt(13)
    v_mfma_f32_16x16x32_bf16 v[104:107], v[128:131], v[36:39], 0
    s_mov_b64 exec, s[58:59]
    ds_read_b128 v[128:131], v120 offset:20480
    s_mov_b64 exec, -1
    s_waitcnt lgkmcnt(13)
    v_mfma_f32_16x16x32_bf16 v[100:103], v[132:135], v[40:43], v[100:103]
    s_mov_b64 exec, s[58:59]
    ds_read_b128 v[132:135], v121 offset:22528
    s_mov_b64 exec, -1
    s_waitcnt lgkmcnt(13)
    v_mfma_f32_16x16x32_bf16 v[104:107], v[136:139], v[44:47], v[104:107]
    s_mov_b64 exec, s[58:59]
    ds_read_b128 v[136:139], v120 offset:24576
    s_mov_b64 exec, -1
    s_waitcnt lgkmcnt(13)
    v_mfma_f32_16x16x32_bf16 v[100:103], v[140:143], v[48:51], v[100:103]
    s_mov_b64 exec, s[58:59]
    ds_read_b128 v[140:143], v121 offset:26624
    s_mov_b64 exec, -1
    s_waitcnt lgkmcnt(13)
    v_mfma_f32_16x16x32_bf16 v[104:107], v[144:147], v[52:55], v[104:107]
    s_mov_b64 exec, s[58:59]
    ds_read_b128 v[144:147], v120 offset:28672
    s_mov_b64 exec, -1
    s_waitcnt lgkmcnt(13)
    v_mfma_f32_16x16x32_bf16 v[100:103], v[148:151], v[56:59], v[100:103]
    s_mov_b64 exec, s[58:59]
    ds_read_b128 v[148:151], v121 offset:30720
    s_mov_b64 exec, -1
    s_waitcnt lgkmcnt(13)
    v_mfma_f32_16x16x32_bf16 v[104:107], v[152:155], v[60:63], v[104:107]
    s_waitcnt lgkmcnt(12)
    v_mfma_f32_16x16x32_bf16 v[100:103], v[156:159], v[64:67], v[100:103]
    s_waitcnt lgkmcnt(6)
    v_mfma_f32_16x16x32_bf16 v[104:107], v[124:127], v[68:71], v[104:107]
    s_waitcnt lgkmcnt(5)
    v_mfma_f32_16x16x32_bf16 v[100:103], v[128:131], v[72:75], v[100:103]
    s_waitcnt lgkmcnt(4)
    v_mfma_f32_16x16x32_bf16 v[104:107], v[132:135], v[76:79], v[104:107]
    s_waitcnt lgkmcnt(3)
    v_mfma_f32_16x16x32_bf16 v[100:103], v[136:139], v[80:83], v[100:103]
    s_waitcnt lgkmcnt(2)
    v_mfma_f32_16x16x32_bf16 v[104:107], v[140:143], v[84:87], v[104:107]
    s_waitcnt lgkmcnt(1)
    v_mfma_f32_16x16x32_bf16 v[100:103], v[144:147], v[88:91], v[100:103]
    s_waitcnt lgkmcnt(0)
    v_mfma_f32_16x16x32_bf16 v[104:107], v[148:151], v[92:95], v[104:107]
    s_waitcnt vmcnt(0)
    v_readfirstlane_b32 s6, v110
    s_nop 5
    v_pk_add_f32 v[100:101], v[100:101], v[104:105]
    v_pk_add_f32 v[102:103], v[102:103], v[106:107]
    s_add_u32 s6, s6, 1
    v_mov_b32 v104, v100
    v_mov_b32 v105, v100
    s_nop 1
    v_permlane32_swap_b32 v104, v105
    v_pk_fma_f32 v[100:101], v[104:105], v[116:117], v[100:101] op_sel:[1,0,0] op_sel_hi:[1,1,1]
    v_pk_fma_f32 v[102:103], v[104:105], v[118:119], v[102:103] op_sel:[1,0,0] op_sel_hi:[1,1,1]
    v_pk_mul_f32 v[100:101], v[100:101], v[112:113]
    v_pk_mul_f32 v[102:103], v[102:103], v[114:115]
    v_cvt_pk_bf16_f32 v108, v100, v101
    v_cvt_pk_bf16_f32 v109, v102, v103
    s_mov_b32 exec_hi, 0
    buffer_store_dwordx2 v[108:109], v161, s[48:51], s72 offen sc1
    v_dot2_f32_bf16 v111, v108, v108, 0
    v_dot2_f32_bf16 v111, v109, v109, v111
    v_mov_b32 v112, 0x7f800000
    s_nop 1
    v_cmp_ge_f32 vcc, 0x71800000, v111
    s_nop 1
    v_cndmask_b32_e64 v111, v112, 0, vcc
L_kv_pub:
    ds_max_u32 v123, v111 offset:104
    s_mov_b64 exec, 1
    ds_inc_u32 v165, v164 offset:168
    s_mov_b64 exec, -1
    s_mov_b64 exec, -1
L_A_center:
    v_dot2_f32_bf16 v100, v0, s61, v97
    v_dot2_f32_bf16 v101, v0, s62, v97
    v_dot2_f32_bf16 v102, v1, s61, v97
    v_dot2_f32_bf16 v103, v1, s62, v97
    v_dot2_f32_bf16 v104, v2, s61, v97
    v_dot2_f32_bf16 v105, v2, s62, v97
    v_cvt_pk_bf16_f32 v0, v100, v101
    v_dot2_f32_bf16 v106, v3, s61, v97
    v_dot2_f32_bf16 v107, v3, s62, v97
    v_cvt_pk_bf16_f32 v1, v102, v103
    v_dot2_f32_bf16 v100, v4, s61, v97
    v_dot2_f32_bf16 v101, v4, s62, v97
    v_cvt_pk_bf16_f32 v2, v104, v105
    v_dot2_f32_bf16 v102, v5, s61, v97
    v_dot2_f32_bf16 v103, v5, s62, v97
    v_cvt_pk_bf16_f32 v3, v106, v107
    ds_write_b128 v163, v[0:3] offset:0
    v_dot2_f32_bf16 v104, v6, s61, v97
    v_dot2_f32_bf16 v105, v6, s62, v97
    v_cvt_pk_bf16_f32 v4, v100, v101
    v_dot2_f32_bf16 v106, v7, s61, v97
    v_dot2_f32_bf16 v107, v7, s62, v97
    v_cvt_pk_bf16_f32 v5, v102, v103
    v_dot2_f32_bf16 v100, v8, s61, v97
    v_dot2_f32_bf16 v101, v8, s62, v97
    v_cvt_pk_bf16_f32 v6, v104, v105
    v_dot2_f32_bf16 v102, v9, s61, v97
    v_dot2_f32_bf16 v103, v9, s62, v97
    v_cvt_pk_bf16_f32 v7, v106, v107
    ds_write_b128 v163, v[4:7] offset:4096
    s_cmp_eq_u32 s63, 0
    s_cbranch_scc0 L_kv_done
    v_mov_b32 v112, s6
    v_lshlrev_b32 v114, 3, v167
    s_mov_b64 exec, 1
    s_waitcnt vmcnt(0)
    ds_inc_rtn_u32 v111, v123, v164 offset:24
    s_mov_b64 exec, 0xffff
    ds_read_b32 v113, v123 offset:104
    s_waitcnt lgkmcnt(0)
    v_readfirstlane_b32 s58, v111
    s_nop 0
    s_cmp_eq_u32 s58, 3
    s_cbranch_scc0 L_kv_nofl
    buffer_store_dwordx2 v[112:113], v114, s[48:51], s73 offen sc1
L_kv_nofl:
    s_mov_b64 exec, -1
    s_setprio 1
L_kv_done:
    v_dot2_f32_bf16 v104, v10, s61, v97
    v_dot2_f32_bf16 v105, v10, s62, v97
    v_cvt_pk_bf16_f32 v8, v100, v101
    v_dot2_f32_bf16 v106, v11, s61, v97
    v_dot2_f32_bf16 v107, v11, s62, v97
    v_cvt_pk_bf16_f32 v9, v102, v103
    v_dot2_f32_bf16 v100, v12, s61, v97
    v_dot2_f32_bf16 v101, v12, s62, v97
    v_cvt_pk_bf16_f32 v10, v104, v105
    v_dot2_f32_bf16 v102, v13, s61, v97
    v_dot2_f32_bf16 v103, v13, s62, v97
    v_cvt_pk_bf16_f32 v11, v106, v107
    ds_write_b128 v163, v[8:11] offset:8192
    v_dot2_f32_bf16 v104, v14, s61, v97
    v_dot2_f32_bf16 v105, v14, s62, v97
    v_cvt_pk_bf16_f32 v12, v100, v101
    v_dot2_f32_bf16 v106, v15, s61, v97
    v_dot2_f32_bf16 v107, v15, s62, v97
    v_cvt_pk_bf16_f32 v13, v102, v103
    v_dot2_f32_bf16 v100, v16, s61, v97
    v_dot2_f32_bf16 v101, v16, s62, v97
    v_cvt_pk_bf16_f32 v14, v104, v105
    v_dot2_f32_bf16 v102, v17, s61, v97
    v_dot2_f32_bf16 v103, v17, s62, v97
    v_cvt_pk_bf16_f32 v15, v106, v107
    ds_write_b128 v163, v[12:15] offset:12288
    v_dot2_f32_bf16 v104, v18, s61, v97
    v_dot2_f32_bf16 v105, v18, s62, v97
    v_cvt_pk_bf16_f32 v16, v100, v101
    v_dot2_f32_bf16 v106, v19, s61, v97
    v_dot2_f32_bf16 v107, v19, s62, v97
    v_cvt_pk_bf16_f32 v17, v102, v103
    v_dot2_f32_bf16 v100, v20, s61, v97
    v_dot2_f32_bf16 v101, v20, s62, v97
    v_cvt_pk_bf16_f32 v18, v104, v105
    v_dot2_f32_bf16 v102, v21, s61, v97
    v_dot2_f32_bf16 v103, v21, s62, v97
    v_cvt_pk_bf16_f32 v19, v106, v107
    ds_write_b128 v163, v[16:19] offset:16384
    v_dot2_f32_bf16 v104, v22, s61, v97
    v_dot2_f32_bf16 v105, v22, s62, v97
    v_cvt_pk_bf16_f32 v20, v100, v101
    v_dot2_f32_bf16 v106, v23, s61, v97
    v_dot2_f32_bf16 v107, v23, s62, v97
    v_cvt_pk_bf16_f32 v21, v102, v103
    v_dot2_f32_bf16 v100, v24, s61, v97
    v_dot2_f32_bf16 v101, v24, s62, v97
    v_cvt_pk_bf16_f32 v22, v104, v105
    v_dot2_f32_bf16 v102, v25, s61, v97
    v_dot2_f32_bf16 v103, v25, s62, v97
    v_cvt_pk_bf16_f32 v23, v106, v107
    ds_write_b128 v163, v[20:23] offset:20480
    v_dot2_f32_bf16 v104, v26, s61, v97
    v_dot2_f32_bf16 v105, v26, s62, v97
    v_cvt_pk_bf16_f32 v24, v100, v101
    v_dot2_f32_bf16 v106, v27, s61, v97
    v_dot2_f32_bf16 v107, v27, s62, v97
    v_cvt_pk_bf16_f32 v25, v102, v103
    v_dot2_f32_bf16 v100, v28, s61, v97
    v_dot2_f32_bf16 v101, v28, s62, v97
    v_cvt_pk_bf16_f32 v26, v104, v105
    v_dot2_f32_bf16 v102, v29, s61, v97
    v_dot2_f32_bf16 v103, v29, s62, v97
    v_cvt_pk_bf16_f32 v27, v106, v107
    ds_write_b128 v163, v[24:27] offset:24576
    v_dot2_f32_bf16 v104, v30, s61, v97
    v_dot2_f32_bf16 v105, v30, s62, v97
    v_cvt_pk_bf16_f32 v28, v100, v101
    v_dot2_f32_bf16 v106, v31, s61, v97
    v_dot2_f32_bf16 v107, v31, s62, v97
    v_cvt_pk_bf16_f32 v29, v102, v103
    v_cvt_pk_bf16_f32 v30, v104, v105
    s_nop 0
    v_cvt_pk_bf16_f32 v31, v106, v107
    ds_write_b128 v163, v[28:31] offset:28672
    s_cmp_ge_u32 s3, 4
    s_cbranch_scc1 L_A_hi2
    s_cmp_eq_u32 s63, 0
    s_cbranch_scc1 L_A_tag
    s_waitcnt vmcnt(0)
    v_readfirstlane_b32 s6, v110
    s_nop 0
    s_add_u32 s6, s6, 1
L_A_tag:
    v_mov_b32 v112, s6
    ds_write_b32 v123, v112 offset:296
    s_mov_b64 exec, 1
    ds_inc_u32 v165, v164 offset:328
    s_mov_b64 exec, -1
    s_setprio 0
    s_branch L_A_noq
L_A_hi2:
    s_and_b32 s57, s3, 1
    s_bfe_u32 s58, s3, 0x10001
    s_lshl_b32 s59, s58, 15
    v_lshrrev_b32 v96, 5, v167
    v_and_b32 v97, 31, v167
    v_xor_b32 v97, v96, v97
    v_lshl_add_u32 v96, v96, 9, s59
    v_xor_b32 v80, 0, v97
    v_lshl_add_u32 v80, v80, 4, v96
    v_xor_b32 v84, 0x8000, v80
    v_xor_b32 v81, 2, v97
    v_lshl_add_u32 v81, v81, 4, v96
    v_xor_b32 v85, 0x8000, v81
    v_xor_b32 v82, 4, v97
    v_lshl_add_u32 v82, v82, 4, v96
    v_xor_b32 v86, 0x8000, v82
    v_xor_b32 v83, 6, v97
    v_lshl_add_u32 v83, v83, 4, v96
    v_xor_b32 v87, 0x8000, v83
    v_lshrrev_b32 v96, 5, v167
    v_mul_u32_u24 v88, 1024, v96
    v_bfe_u32 v96, v167, 2, 2
    v_lshl_add_u32 v88, v96, 7, v88
    v_bfe_u32 v96, v167, 3, 1
    v_lshl_add_u32 v88, v96, 6, v88
    v_bfe_u32 v96, v167, 4, 1
    v_lshl_add_u32 v88, v96, 5, v88
    v_and_b32 v96, 3, v167
    v_lshl_add_u32 v88, v96, 3, v88
    s_lshl_b32 s60, s57, 6
    v_xor_b32 v88, s60, v88
    v_add_u32 v88, 98304, v88
    s_lshl_b32 s59, s58, 7
    v_and_b32 v90, 31, v167
    v_lshl_add_u32 v90, v90, 2, s59
    v_add_u32 v90, 65536, v90
    s_mov_b64 exec, 1
    ds_inc_u32 v165, v164 offset:328
    s_mov_b64 exec, -1
    s_mov_b32 s76, 0x40000
L_spin_3:
    ds_read_b32 v92, v165 offset:328
    s_waitcnt lgkmcnt(0)
    v_readfirstlane_b32 s77, v92
    s_nop 0
    s_cmp_ge_u32 s77, 12
    s_cbranch_scc1 L_spun_4
    s_sub_u32 s76, s76, 1
    s_cbranch_scc0 L_spin_3
L_spun_4:
    ds_read_b32 v92, v90 offset:2048
    ds_read_b32 v94, v165 offset:296
    ds_read_b128 v[4:7], v80 offset:0
    ds_read_b64_tr_b16 v[0:1], v88 offset:0
    ds_read_b64_tr_b16 v[2:3], v88 offset:512
    ds_read_b128 v[12:15], v81 offset:1024
    ds_read_b64_tr_b16 v[8:9], v88 offset:2048
    ds_read_b64_tr_b16 v[10:11], v88 offset:2560
    ds_read_b128 v[20:23], v82 offset:2048
    ds_read_b64_tr_b16 v[16:17], v88 offset:4096
    ds_read_b64_tr_b16 v[18:19], v88 offset:4608
    ds_read_b128 v[28:31], v83 offset:3072
    ds_read_b64_tr_b16 v[24:25], v88 offset:6144
    ds_read_b64_tr_b16 v[26:27], v88 offset:6656
    ds_read_b128 v[36:39], v80 offset:4096
    ds_read_b64_tr_b16 v[32:33], v88 offset:8192
    ds_read_b64_tr_b16 v[34:35], v88 offset:8704
    s_waitcnt lgkmcnt(12)
    v_mfma_f32_32x32x16_bf16 v[96:111], v[0:3], v[4:7], 0
    ds_read_b128 v[4:7], v81 offset:5120
    ds_read_b64_tr_b16 v[0:1], v88 offset:10240
    ds_read_b64_tr_b16 v[2:3], v88 offset:10752
    s_waitcnt lgkmcnt(12)
    v_mfma_f32_32x32x16_bf16 v[96:111], v[8:11], v[12:15], v[96:111]
    ds_read_b128 v[12:15], v82 offset:6144
    ds_read_b64_tr_b16 v[8:9], v88 offset:12288
    ds_read_b64_tr_b16 v[10:11], v88 offset:12800
    s_waitcnt lgkmcnt(12)
    v_mfma_f32_32x32x16_bf16 v[96:111], v[16:19], v[20:23], v[96:111]
    ds_read_b128 v[20:23], v83 offset:7168
    ds_read_b64_tr_b16 v[16:17], v88 offset:14336
    ds_read_b64_tr_b16 v[18:19], v88 offset:14848
    s_waitcnt lgkmcnt(12)
    v_mfma_f32_32x32x16_bf16 v[96:111], v[24:27], v[28:31], v[96:111]
    ds_read_b128 v[28:31], v80 offset:8192
    ds_read_b64_tr_b16 v[24:25], v88 offset:16384
    ds_read_b64_tr_b16 v[26:27], v88 offset:16896
    s_waitcnt lgkmcnt(12)
    v_mfma_f32_32x32x16_bf16 v[96:111], v[32:35], v[36:39], v[96:111]
    ds_read_b128 v[36:39], v81 offset:9216
    ds_read_b64_tr_b16 v[32:33], v88 offset:18432
    ds_read_b64_tr_b16 v[34:35], v88 offset:18944
    s_waitcnt lgkmcnt(12)
    v_mfma_f32_32x32x16_bf16 v[96:111], v[0:3], v[4:7], v[96:111]
    ds_read_b128 v[4:7], v82 offset:10240
    ds_read_b64_tr_b16 v[0:1], v88 offset:20480
    ds_read_b64_tr_b16 v[2:3], v88 offset:20992
    s_waitcnt lgkmcnt(12)
    v_mfma_f32_32x32x16_bf16 v[96:111], v[8:11], v[12:15], v[96:111]
    ds_read_b128 v[12:15], v83 offset:11264
    ds_read_b64_tr_b16 v[8:9], v88 offset:22528
    ds_read_b64_tr_b16 v[10:11], v88 offset:23040
    s_waitcnt lgkmcnt(12)
    v_mfma_f32_32x32x16_bf16 v[96:111], v[16:19], v[20:23], v[96:111]
    ds_read_b128 v[20:23], v80 offset:12288
    ds_read_b64_tr_b16 v[16:17], v88 offset:24576
    ds_read_b64_tr_b16 v[18:19], v88 offset:25088
    s_waitcnt lgkmcnt(12)
    v_mfma_f32_32x32x16_bf16 v[96:111], v[24:27], v[28:31], v[96:111]
    ds_read_b128 v[28:31], v81 offset:13312
    ds_read_b64_tr_b16 v[24:25], v88 offset:26624
    ds_read_b64_tr_b16 v[26:27], v88 offset:27136
    s_waitcnt lgkmcnt(12)
    v_mfma_f32_32x32x16_bf16 v[96:111], v[32:35], v[36:39], v[96:111]
    ds_read_b128 v[36:39], v82 offset:14336
    ds_read_b64_tr_b16 v[32:33], v88 offset:28672
    ds_read_b64_tr_b16 v[34:35], v88 offset:29184
    s_waitcnt lgkmcnt(12)
    v_mfma_f32_32x32x16_bf16 v[96:111], v[0:3], v[4:7], v[96:111]
    ds_read_b128 v[4:7], v83 offset:15360
    ds_read_b64_tr_b16 v[0:1], v88 offset:30720
    ds_read_b64_tr_b16 v[2:3], v88 offset:31232
    s_waitcnt lgkmcnt(12)
    v_mfma_f32_32x32x16_bf16 v[96:111], v[8:11], v[12:15], v[96:111]
    ds_read_b128 v[12:15], v80 offset:16384
    ds_read_b64_tr_b16 v[8:9], v88 offset:32768
    ds_read_b64_tr_b16 v[10:11], v88 offset:33280
    s_waitcnt lgkmcnt(12)
    v_mfma_f32_32x32x16_bf16 v[96:111], v[16:19], v[20:23], v[96:111]
    ds_read_b128 v[20:23], v81 offset:17408
    ds_read_b64_tr_b16 v[16:17], v88 offset:34816
    ds_read_b64_tr_b16 v[18:19], v88 offset:35328
    s_waitcnt lgkmcnt(12)
    v_mfma_f32_32x32x16_bf16 v[96:111], v[24:27], v[28:31], v[96:111]
    ds_read_b128 v[28:31], v82 offset:18432
    ds_read_b64_tr_b16 v[24:25], v88 offset:36864
    ds_read_b64_tr_b16 v[26:27], v88 offset:37376
    s_waitcnt lgkmcnt(12)
    v_mfma_f32_32x32x16_bf16 v[96:111], v[32:35], v[36:39], v[96:111]
    ds_read_b128 v[36:39], v83 offset:19456
    ds_read_b64_tr_b16 v[32:33], v88 offset:38912
    ds_read_b64_tr_b16 v[34:35], v88 offset:39424
    s_waitcnt lgkmcnt(12)
    v_mfma_f32_32x32x16_bf16 v[96:111], v[0:3], v[4:7], v[96:111]
    ds_read_b128 v[4:7], v80 offset:20480
    ds_read_b64_tr_b16 v[0:1], v88 offset:40960
    ds_read_b64_tr_b16 v[2:3], v88 offset:41472
    s_waitcnt lgkmcnt(12)
    v_mfma_f32_32x32x16_bf16 v[96:111], v[8:11], v[12:15], v[96:111]
    ds_read_b128 v[12:15], v81 offset:21504
    ds_read_b64_tr_b16 v[8:9], v88 offset:43008
    ds_read_b64_tr_b16 v[10:11], v88 offset:43520
    s_waitcnt lgkmcnt(12)
    v_mfma_f32_32x32x16_bf16 v[96:111], v[16:19], v[20:23], v[96:111]
    ds_read_b128 v[20:23], v82 offset:22528
    ds_read_b64_tr_b16 v[16:17], v88 offset:45056
    ds_read_b64_tr_b16 v[18:19], v88 offset:45568
    s_waitcnt lgkmcnt(12)
    v_mfma_f32_32x32x16_bf16 v[96:111], v[24:27], v[28:31], v[96:111]
    ds_read_b128 v[28:31], v83 offset:23552
    ds_read_b64_tr_b16 v[24:25], v88 offset:47104
    ds_read_b64_tr_b16 v[26:27], v88 offset:47616
    s_waitcnt lgkmcnt(12)
    v_mfma_f32_32x32x16_bf16 v[96:111], v[32:35], v[36:39], v[96:111]
    ds_read_b128 v[36:39], v80 offset:24576
    ds_read_b64_tr_b16 v[32:33], v88 offset:49152
    ds_read_b64_tr_b16 v[34:35], v88 offset:49664
    s_waitcnt lgkmcnt(12)
    v_mfma_f32_32x32x16_bf16 v[96:111], v[0:3], v[4:7], v[96:111]
    ds_read_b128 v[4:7], v81 offset:25600
    ds_read_b64_tr_b16 v[0:1], v88 offset:51200
    ds_read_b64_tr_b16 v[2:3], v88 offset:51712
    s_waitcnt lgkmcnt(12)
    v_mfma_f32_32x32x16_bf16 v[96:111], v[8:11], v[12:15], v[96:111]
    ds_read_b128 v[12:15], v82 offset:26624
    ds_read_b64_tr_b16 v[8:9], v88 offset:53248
    ds_read_b64_tr_b16 v[10:11], v88 offset:53760
    s_waitcnt lgkmcnt(12)
    v_mfma_f32_32x32x16_bf16 v[96:111], v[16:19], v[20:23], v[96:111]
    ds_read_b128 v[20:23], v83 offset:27648
    ds_read_b64_tr_b16 v[16:17], v88 offset:55296
    ds_read_b64_tr_b16 v[18:19], v88 offset:55808
    s_waitcnt lgkmcnt(12)
    v_mfma_f32_32x32x16_bf16 v[96:111], v[24:27], v[28:31], v[96:111]
    s_mov_b64 exec, 1
    ds_inc_u32 v165, v164 offset:184
    s_mov_b64 exec, -1
    ds_read_b128 v[28:31], v80 offset:28672
    ds_read_b64_tr_b16 v[24:25], v88 offset:57344
    ds_read_b64_tr_b16 v[26:27], v88 offset:57856
    s_waitcnt lgkmcnt(13)
    v_mfma_f32_32x32x16_bf16 v[96:111], v[32:35], v[36:39], v[96:111]
    ds_read_b128 v[36:39], v81 offset:29696
    ds_read_b64_tr_b16 v[32:33], v88 offset:59392
    ds_read_b64_tr_b16 v[34:35], v88 offset:59904
    s_waitcnt lgkmcnt(13)
    v_mfma_f32_32x32x16_bf16 v[96:111], v[0:3], v[4:7], v[96:111]
    ds_read_b128 v[4:7], v82 offset:30720
    ds_read_b64_tr_b16 v[0:1], v88 offset:61440
    ds_read_b64_tr_b16 v[2:3], v88 offset:61952
    s_waitcnt lgkmcnt(13)
    v_mfma_f32_32x32x16_bf16 v[96:111], v[8:11], v[12:15], v[96:111]
    ds_read_b128 v[12:15], v83 offset:31744
    ds_read_b64_tr_b16 v[8:9], v88 offset:63488
    ds_read_b64_tr_b16 v[10:11], v88 offset:64000
    s_waitcnt lgkmcnt(13)
    v_mfma_f32_32x32x16_bf16 v[96:111], v[16:19], v[20:23], v[96:111]
    s_waitcnt lgkmcnt(9)
    v_mfma_f32_32x32x16_bf16 v[96:111], v[24:27], v[28:31], v[96:111]
    s_waitcnt lgkmcnt(6)
    v_mfma_f32_32x32x16_bf16 v[96:111], v[32:35], v[36:39], v[96:111]
    s_waitcnt lgkmcnt(3)
    v_mfma_f32_32x32x16_bf16 v[96:111], v[0:3], v[4:7], v[96:111]
    s_waitcnt lgkmcnt(0)
    v_mfma_f32_32x32x16_bf16 v[96:111], v[8:11], v[12:15], v[96:111]
    s_mov_b64 exec, 1
    ds_inc_u32 v165, v164 offset:40
    s_mov_b64 exec, -1
    v_readfirstlane_b32 s6, v94
    v_mul_f32 v92, 0x3eb8aa3b, v92
    v_mov_b32 v16, 0
    v_mov_b32 v17, 0
    v_mov_b32 v18, 65536
    s_and_b32 s59, s3, 3
    s_mul_i32 s59, s59, 12288
    v_add_u32 v13, s59, v166
    s_cmp_eq_u32 s3, 7
    s_cbranch_scc0 L_q_z
    s_mov_b32 s76, 0x40000
L_spin_5:
    ds_read_b32 v10, v165 offset:40
    s_waitcnt lgkmcnt(0)
    v_readfirstlane_b32 s77, v10
    s_nop 0
    s_cmp_ge_u32 s77, 4
    s_cbranch_scc1 L_spun_6
    s_sub_u32 s76, s76, 1
    s_cbranch_scc0 L_spin_5
L_spun_6:
L_q_z:
    s_mov_b64 exec, 1
    ds_write_b64 v13, v[16:17] offset:8
    ds_write_b64 v13, v[16:17] offset:6152
    s_mov_b64 exec, -1
    v_pk_mul_f32 v[96:97], v[96:97], v[92:93] op_sel_hi:[1,0]
    v_pk_mul_f32 v[98:99], v[98:99], v[92:93] op_sel_hi:[1,0]
    v_pk_mul_f32 v[100:101], v[100:101], v[92:93] op_sel_hi:[1,0]
    v_pk_mul_f32 v[102:103], v[102:103], v[92:93] op_sel_hi:[1,0]
    v_pk_mul_f32 v[104:105], v[104:105], v[92:93] op_sel_hi:[1,0]
    v_pk_mul_f32 v[106:107], v[106:107], v[92:93] op_sel_hi:[1,0]
    v_pk_mul_f32 v[108:109], v[108:109], v[92:93] op_sel_hi:[1,0]
    v_pk_mul_f32 v[110:111], v[110:111], v[92:93] op_sel_hi:[1,0]
    v_cvt_pk_bf16_f32 v144, v96, v97
    v_cvt_pk_bf16_f32 v145, v98, v99
    v_cvt_pk_bf16_f32 v146, v100, v101
    v_cvt_pk_bf16_f32 v147, v102, v103
    ds_write_b128 v13, v[144:147] offset:1024
    v_cvt_pk_bf16_f32 v148, v104, v105
    v_cvt_pk_bf16_f32 v149, v106, v107
    v_cvt_pk_bf16_f32 v150, v108, v109
    v_cvt_pk_bf16_f32 v151, v110, v111
    ds_write_b128 v13, v[148:151] offset:7168
    v_dot2c_f32_bf16 v16, v144, v144
    v_dot2c_f32_bf16 v17, v148, v148
    v_dot2c_f32_bf16 v16, v145, v145
    v_dot2c_f32_bf16 v17, v149, v149
    v_dot2c_f32_bf16 v16, v146, v146
    v_dot2c_f32_bf16 v17, v150, v150
    v_dot2c_f32_bf16 v16, v147, v147
    v_dot2c_f32_bf16 v17, v151, v151
    s_nop 2
    v_max_u32 v16, v16, v17
    ds_max_u32 v18, v16 offset:88
    s_mov_b64 exec, 1
    ds_inc_u32 v165, v164 offset:56
    s_mov_b64 exec, -1
L_A_noq:
    s_mov_b32 s78, 0x3f803f80
    s_mov_b32 s79, 0x3f803f80
    s_waitcnt vmcnt(0)
    v_pk_mov_b32 v[32:33], s[78:79], s[78:79]
    v_pk_mov_b32 v[34:35], s[78:79], s[78:79]
    v_pk_mov_b32 v[36:37], s[78:79], s[78:79]
    v_pk_mov_b32 v[38:39], s[78:79], s[78:79]
    v_pk_mov_b32 v[40:41], s[78:79], s[78:79]
    v_pk_mov_b32 v[42:43], s[78:79], s[78:79]
    v_pk_mov_b32 v[44:45], s[78:79], s[78:79]
    v_pk_mov_b32 v[46:47], s[78:79], s[78:79]
    v_pk_mov_b32 v[48:49], s[78:79], s[78:79]
    v_pk_mov_b32 v[50:51], s[78:79], s[78:79]
    v_pk_mov_b32 v[52:53], s[78:79], s[78:79]
    v_pk_mov_b32 v[54:55], s[78:79], s[78:79]
    v_pk_mov_b32 v[56:57], s[78:79], s[78:79]
    v_pk_mov_b32 v[58:59], s[78:79], s[78:79]
    v_pk_mov_b32 v[60:61], s[78:79], s[78:79]
    v_pk_mov_b32 v[62:63], s[78:79], s[78:79]
    v_pk_mov_b32 v[64:65], s[78:79], s[78:79]
    v_pk_mov_b32 v[66:67], s[78:79], s[78:79]
    v_pk_mov_b32 v[68:69], s[78:79], s[78:79]
    v_pk_mov_b32 v[70:71], s[78:79], s[78:79]
    v_pk_mov_b32 v[72:73], s[78:79], s[78:79]
    v_pk_mov_b32 v[74:75], s[78:79], s[78:79]
    v_pk_mov_b32 v[76:77], s[78:79], s[78:79]
    v_pk_mov_b32 v[78:79], s[78:79], s[78:79]
    v_pk_mov_b32 v[80:81], s[78:79], s[78:79]
    v_pk_mov_b32 v[82:83], s[78:79], s[78:79]
    v_pk_mov_b32 v[84:85], s[78:79], s[78:79]
    v_pk_mov_b32 v[86:87], s[78:79], s[78:79]
    v_pk_mov_b32 v[88:89], s[78:79], s[78:79]
    v_pk_mov_b32 v[90:91], s[78:79], s[78:79]
    v_pk_mov_b32 v[92:93], s[78:79], s[78:79]
    v_pk_mov_b32 v[94:95], s[78:79], s[78:79]
    s_add_u32 s57, s3, 0
    s_and_b32 s57, s57, 3
    s_mul_i32 s40, s57, 6144
    s_add_u32 s41, s40, 24576
    s_add_u32 s57, s3, 1
    s_and_b32 s57, s57, 3
    s_mul_i32 s42, s57, 6144
    s_add_u32 s43, s42, 24576
    s_add_u32 s57, s3, 2
    s_and_b32 s57, s57, 3
    s_mul_i32 s44, s57, 6144
    s_add_u32 s45, s44, 24576
    s_add_u32 s57, s3, 3
    s_and_b32 s57, s57, 3
    s_mul_i32 s46, s57, 6144
    s_add_u32 s47, s46, 24576
    s_lshl_b32 s75, s57, 10
    v_mov_b32 v128, 0
    v_mov_b32 v144, 0
    v_mov_b32 v129, 0
    v_mov_b32 v145, 0
    v_mov_b32 v130, 0
    v_mov_b32 v146, 0
    v_mov_b32 v131, 0
    v_mov_b32 v147, 0
    v_mov_b32 v132, 0
    v_mov_b32 v148, 0
    v_mov_b32 v133, 0
    v_mov_b32 v149, 0
    v_mov_b32 v134, 0
    v_mov_b32 v150, 0
    v_mov_b32 v135, 0
    v_mov_b32 v151, 0
    v_mov_b32 v136, 0
    v_mov_b32 v152, 0
    s_lshr_b32 s68, s3, 2
    s_lshl_b32 s69, s4, 16
    s_lshl_b32 s57, s5, 12
    s_add_u32 s69, s69, s57
    s_add_u32 s69, s69, 196608
    v_add_u32 v165, s40, v166
    v_lshlrev_b32 v158, 4, v167
    v_lshrrev_b32 v97, 5, v167
    v_and_b32 v98, 15, v167
    v_lshlrev_b32 v97, 8, v97
    v_lshl_add_u32 v159, v98, 4, v97
    s_lshl_b32 s57, s7, 1
    s_add_u32 s57, s57, s5
    s_add_u32 s57, s57, s3
    s_and_b32 s65, s57, 7
    s_setprio 3
    s_cmp_ge_u32 s3, 4
    s_cbranch_scc1 L_A_nopoll
    s_mov_b32 s76, 0x40000
L_spin_7:
    ds_read_b32 v99, v166 offset:184
    s_waitcnt lgkmcnt(0)
    v_readfirstlane_b32 s77, v99
    s_nop 0
    s_cmp_ge_u32 s77, 1
    s_cbranch_scc1 L_spun_8
    s_sleep 1
    s_sub_u32 s76, s76, 1
    s_cbranch_scc0 L_spin_7
L_spun_8:
    v_and_b32 v98, 15, v167
    v_bfe_u32 v99, v167, 4, 1
    v_lshl_add_u32 v99, v99, 2, s65
    v_and_b32 v99, 7, v99
    v_lshlrev_b32 v98, 7, v98
    v_lshl_add_u32 v98, v99, 11, v98
    s_mov_b32 s57, 131072
    s_mov_b32 s76, 0x8000
    s_mov_b32 exec_lo, 0xffffffff
    s_mov_b32 exec_hi, 0
L_poll_9:
    buffer_load_dwordx2 v[100:101], v98, s[48:51], s57 offen sc1
    s_waitcnt vmcnt(0)
    v_cmp_eq_u32 vcc, s6, v100
    s_nop 0
    s_cmp_eq_u64 vcc, exec
    s_cbranch_scc1 L_polled_10
    s_sleep 4
    s_sub_u32 s76, s76, 1
    s_cbranch_scc0 L_poll_9
L_polled_10:
    s_mov_b64 exec, -1
L_A_nopoll:
    s_lshl_b32 s57, s65, 13
    s_add_u32 s58, s57, 65536
    s_add_u32 s59, s57, 0x1000
    s_add_u32 s60, s58, 0x1000
    s_mov_b32 s62, 0x0000ffff
    s_mov_b32 s63, 0x0000ffff
    s_cmp_ge_u32 s3, 4
    s_cbranch_scc0 L_A_z4
    s_mov_b32 s76, 0x40000
L_spin_11:
    ds_read_b32 v99, v166 offset:312
    s_waitcnt lgkmcnt(0)
    v_readfirstlane_b32 s77, v99
    s_nop 0
    s_cmp_ge_u32 s77, 4
    s_cbranch_scc1 L_spun_12
    s_sleep 1
    s_sub_u32 s76, s76, 1
    s_cbranch_scc0 L_spin_11
L_spun_12:
    buffer_load_dwordx4 v[0:3], v158, s[48:51], s57 offen offset:0 sc1
    s_mov_b64 exec, s[62:63]
    buffer_load_dwordx4 v[32:35], v159, s[48:51], s58 offen offset:0 sc1
    buffer_load_dwordx4 v[36:39], v159, s[48:51], s58 offen offset:512 sc1
    s_mov_b64 exec, -1
    buffer_load_dwordx4 v[4:7], v158, s[48:51], s57 offen offset:1024 sc1
    s_mov_b64 exec, s[62:63]
    buffer_load_dwordx4 v[40:43], v159, s[48:51], s58 offen offset:1024 sc1
    buffer_load_dwordx4 v[44:47], v159, s[48:51], s58 offen offset:1536 sc1
    s_mov_b64 exec, -1
    buffer_load_dwordx4 v[8:11], v158, s[48:51], s57 offen offset:2048 sc1
    s_mov_b64 exec, s[62:63]
    buffer_load_dwordx4 v[48:51], v159, s[48:51], s58 offen offset:2048 sc1
    buffer_load_dwordx4 v[52:55], v159, s[48:51], s58 offen offset:2560 sc1
    s_mov_b64 exec, -1
    buffer_load_dwordx4 v[12:15], v158, s[48:51], s57 offen offset:3072 sc1
    s_mov_b64 exec, s[62:63]
    buffer_load_dwordx4 v[56:59], v159, s[48:51], s58 offen offset:3072 sc1
    buffer_load_dwordx4 v[60:63], v159, s[48:51], s58 offen offset:3584 sc1
    s_mov_b64 exec, -1
    buffer_load_dwordx4 v[16:19], v158, s[48:51], s59 offen offset:0 sc1
    s_mov_b64 exec, s[62:63]
    buffer_load_dwordx4 v[64:67], v159, s[48:51], s60 offen offset:0 sc1
    buffer_load_dwordx4 v[68:71], v159, s[48:51], s60 offen offset:512 sc1
    s_mov_b64 exec, -1
    buffer_load_dwordx4 v[20:23], v158, s[48:51], s59 offen offset:1024 sc1
    s_mov_b64 exec, s[62:63]
    buffer_load_dwordx4 v[72:75], v159, s[48:51], s60 offen offset:1024 sc1
    buffer_load_dwordx4 v[76:79], v159, s[48:51], s60 offen offset:1536 sc1
    s_mov_b64 exec, -1
    buffer_load_dwordx4 v[24:27], v158, s[48:51], s59 offen offset:2048 sc1
    s_mov_b64 exec, s[62:63]
    buffer_load_dwordx4 v[80:83], v159, s[48:51], s60 offen offset:2048 sc1
    buffer_load_dwordx4 v[84:87], v159, s[48:51], s60 offen offset:2560 sc1
    s_mov_b64 exec, -1
    buffer_load_dwordx4 v[28:31], v158, s[48:51], s59 offen offset:3072 sc1
    s_mov_b64 exec, s[62:63]
    buffer_load_dwordx4 v[88:91], v159, s[48:51], s60 offen offset:3072 sc1
    buffer_load_dwordx4 v[92:95], v159, s[48:51], s60 offen offset:3584 sc1
    s_mov_b64 exec, -1
    s_mov_b64 exec, 1
    ds_inc_u32 v166, v164 offset:312
    s_mov_b64 exec, -1
    s_branch L_A_z3
L_A_z4:
    buffer_load_dwordx4 v[0:3], v158, s[48:51], s57 offen offset:0 sc1
    s_mov_b64 exec, s[62:63]
    buffer_load_dwordx4 v[32:35], v159, s[48:51], s58 offen offset:0 sc1
    buffer_load_dwordx4 v[36:39], v159, s[48:51], s58 offen offset:512 sc1
    s_mov_b64 exec, -1
    buffer_load_dwordx4 v[4:7], v158, s[48:51], s57 offen offset:1024 sc1
    s_mov_b64 exec, s[62:63]
    buffer_load_dwordx4 v[40:43], v159, s[48:51], s58 offen offset:1024 sc1
    buffer_load_dwordx4 v[44:47], v159, s[48:51], s58 offen offset:1536 sc1
    s_mov_b64 exec, -1
    buffer_load_dwordx4 v[8:11], v158, s[48:51], s57 offen offset:2048 sc1
    s_mov_b64 exec, s[62:63]
    buffer_load_dwordx4 v[48:51], v159, s[48:51], s58 offen offset:2048 sc1
    buffer_load_dwordx4 v[52:55], v159, s[48:51], s58 offen offset:2560 sc1
    s_mov_b64 exec, -1
    buffer_load_dwordx4 v[12:15], v158, s[48:51], s57 offen offset:3072 sc1
    s_mov_b64 exec, s[62:63]
    buffer_load_dwordx4 v[56:59], v159, s[48:51], s58 offen offset:3072 sc1
    buffer_load_dwordx4 v[60:63], v159, s[48:51], s58 offen offset:3584 sc1
    s_mov_b64 exec, -1
    v_mov_b32 v98, 65536
    s_mov_b32 exec_hi, 0
    ds_max_u32 v98, v101 offset:120
    s_mov_b64 exec, -1
    s_mov_b64 exec, 1
    ds_inc_u32 v166, v164 offset:56
    s_mov_b64 exec, -1
L_A_z3:
    s_mov_b32 s76, 0x40000
L_spin_13:
    ds_read_b32 v99, v166 offset:56
    s_waitcnt lgkmcnt(0)
    v_readfirstlane_b32 s77, v99
    s_nop 0
    s_cmp_ge_u32 s77, 12
    s_cbranch_scc1 L_spun_14
    s_sub_u32 s76, s76, 1
    s_cbranch_scc0 L_spin_13
L_spun_14:
    ds_read_b32 v98, v166 offset:88
    ds_read_b32 v99, v166 offset:120
    ds_read_b128 v[160:163], v165 offset:1024
    s_waitcnt lgkmcnt(0)
    v_readfirstlane_b32 s66, v98
    v_readfirstlane_b32 s67, v99
    s_nop 0
    v_mov_b32 v98, s66
    v_mul_f32 v98, s67, v98
    v_cmp_ge_f32 vcc, 0x44800000, v98
    s_nop 0
    s_cbranch_vccz L_fallback
    s_cmp_eq_u32 s68, 0
    s_cbranch_scc0 L_attn_y
    s_waitcnt vmcnt(11)
    v_mfma_f32_32x32x16_bf16 v[96:111], v[0:3], v[160:163], 0
    s_setprio 2
    s_nop 10
    v_exp_f32 v96, v96
    v_exp_f32 v97, v97
    v_exp_f32 v98, v98
    v_exp_f32 v99, v99
    v_exp_f32 v100, v100
    s_waitcnt vmcnt(8)
    v_mfma_f32_32x32x16_bf16 v[112:127], v[4:7], v[160:163], 0
    buffer_load_dwordx4 v[16:19], v158, s[48:51], s59 offen offset:0 sc1
    s_mov_b64 exec, s[62:63]
    buffer_load_dwordx4 v[64:67], v159, s[48:51], s60 offen offset:0 sc1
    buffer_load_dwordx4 v[68:71], v159, s[48:51], s60 offen offset:512 sc1
    s_mov_b64 exec, -1
    v_exp_f32 v101, v101
    v_exp_f32 v102, v102
    v_exp_f32 v103, v103
    v_exp_f32 v104, v104
    v_exp_f32 v105, v105
    v_exp_f32 v106, v106
    v_exp_f32 v107, v107
    v_exp_f32 v108, v108
    v_exp_f32 v109, v109
    v_exp_f32 v110, v110
    v_smfmac_f32_32x32x32_bf16 v[128:143], v[32:35], v[96:103], v164
    v_exp_f32 v111, v111
    v_exp_f32 v112, v112
    v_exp_f32 v113, v113
    v_smfmac_f32_32x32x32_bf16 v[128:143], v[36:39], v[104:111], v164
    v_exp_f32 v114, v114
    v_exp_f32 v115, v115
    v_exp_f32 v116, v116
    s_waitcnt vmcnt(8)
    v_mfma_f32_32x32x16_bf16 v[96:111], v[8:11], v[160:163], 0
    buffer_load_dwordx4 v[20:23], v158, s[48:51], s59 offen offset:1024 sc1
    s_mov_b64 exec, s[62:63]
    buffer_load_dwordx4 v[72:75], v159, s[48:51], s60 offen offset:1024 sc1
    buffer_load_dwordx4 v[76:79], v159, s[48:51], s60 offen offset:1536 sc1
    s_mov_b64 exec, -1
    v_exp_f32 v117, v117
    v_exp_f32 v118, v118
    v_exp_f32 v119, v119
    v_exp_f32 v120, v120
    v_exp_f32 v121, v121
    v_exp_f32 v122, v122
    v_exp_f32 v123, v123
    v_exp_f32 v124, v124
    v_exp_f32 v125, v125
    v_exp_f32 v126, v126
    v_smfmac_f32_32x32x32_bf16 v[128:143], v[40:43], v[112:119], v164
    v_exp_f32 v127, v127
    v_exp_f32 v96, v96
    v_exp_f32 v97, v97
    v_smfmac_f32_32x32x32_bf16 v[128:143], v[44:47], v[120:127], v164
    v_exp_f32 v98, v98
    v_exp_f32 v99, v99
    v_exp_f32 v100, v100
    s_waitcnt vmcnt(8)
    v_mfma_f32_32x32x16_bf16 v[112:127], v[12:15], v[160:163], 0
    buffer_load_dwordx4 v[24:27], v158, s[48:51], s59 offen offset:2048 sc1
    s_mov_b64 exec, s[62:63]
    buffer_load_dwordx4 v[80:83], v159, s[48:51], s60 offen offset:2048 sc1
    buffer_load_dwordx4 v[84:87], v159, s[48:51], s60 offen offset:2560 sc1
    s_mov_b64 exec, -1
    v_exp_f32 v101, v101
    v_exp_f32 v102, v102
    v_exp_f32 v103, v103
    v_exp_f32 v104, v104
    v_exp_f32 v105, v105
    v_exp_f32 v106, v106
    v_exp_f32 v107, v107
    v_exp_f32 v108, v108
    v_exp_f32 v109, v109
    v_exp_f32 v110, v110
    v_smfmac_f32_32x32x32_bf16 v[128:143], v[48:51], v[96:103], v164
    v_exp_f32 v111, v111
    v_exp_f32 v112, v112
    v_exp_f32 v113, v113
    v_smfmac_f32_32x32x32_bf16 v[128:143], v[52:55], v[104:111], v164
    v_exp_f32 v114, v114
    v_exp_f32 v115, v115
    v_exp_f32 v116, v116
    s_waitcnt vmcnt(8)
    v_mfma_f32_32x32x16_bf16 v[96:111], v[16:19], v[160:163], 0
    buffer_load_dwordx4 v[28:31], v158, s[48:51], s59 offen offset:3072 sc1
    s_mov_b64 exec, s[62:63]
    buffer_load_dwordx4 v[88:91], v159, s[48:51], s60 offen offset:3072 sc1
    buffer_load_dwordx4 v[92:95], v159, s[48:51], s60 offen offset:3584 sc1
    s_mov_b64 exec, -1
    s_mov_b64 exec, 1
    ds_inc_u32 v166, v164 offset:312
    s_mov_b64 exec, -1
    v_exp_f32 v117, v117
    v_exp_f32 v118, v118
    v_exp_f32 v119, v119
    v_exp_f32 v120, v120
    v_exp_f32 v121, v121
    v_exp_f32 v122, v122
    v_exp_f32 v123, v123
    v_exp_f32 v124, v124
    v_exp_f32 v125, v125
    v_exp_f32 v126, v126
    v_smfmac_f32_32x32x32_bf16 v[128:143], v[56:59], v[112:119], v164
    v_exp_f32 v127, v127
    v_exp_f32 v96, v96
    v_exp_f32 v97, v97
    v_smfmac_f32_32x32x32_bf16 v[128:143], v[60:63], v[120:127], v164
    v_exp_f32 v98, v98
    v_exp_f32 v99, v99
    v_exp_f32 v100, v100
    s_waitcnt vmcnt(8)
    v_mfma_f32_32x32x16_bf16 v[112:127], v[20:23], v[160:163], 0
    v_exp_f32 v101, v101
    v_exp_f32 v102, v102
    v_exp_f32 v103, v103
    v_exp_f32 v104, v104
    v_exp_f32 v105, v105
    v_exp_f32 v106, v106
    v_exp_f32 v107, v107
    v_exp_f32 v108, v108
    v_exp_f32 v109, v109
    v_exp_f32 v110, v110
    v_smfmac_f32_32x32x32_bf16 v[128:143], v[64:67], v[96:103], v164
    v_exp_f32 v111, v111
    v_exp_f32 v112, v112
    v_exp_f32 v113, v113
    v_smfmac_f32_32x32x32_bf16 v[128:143], v[68:71], v[104:111], v164
    v_exp_f32 v114, v114
    v_exp_f32 v115, v115
    v_exp_f32 v116, v116
    s_waitcnt vmcnt(5)
    v_mfma_f32_32x32x16_bf16 v[96:111], v[24:27], v[160:163], 0
    v_add_u32 v167, s41, v166
    v_exp_f32 v117, v117
    v_exp_f32 v118, v118
    v_exp_f32 v119, v119
    v_exp_f32 v120, v120
    v_exp_f32 v121, v121
    v_exp_f32 v122, v122
    v_exp_f32 v123, v123
    v_exp_f32 v124, v124
    v_exp_f32 v125, v125
    v_exp_f32 v126, v126
    v_smfmac_f32_32x32x32_bf16 v[128:143], v[72:75], v[112:119], v164
    v_exp_f32 v127, v127
    v_exp_f32 v96, v96
    v_exp_f32 v97, v97
    v_smfmac_f32_32x32x32_bf16 v[128:143], v[76:79], v[120:127], v164
    v_exp_f32 v98, v98
    v_exp_f32 v99, v99
    v_exp_f32 v100, v100
    s_waitcnt vmcnt(2)
    v_mfma_f32_32x32x16_bf16 v[112:127], v[28:31], v[160:163], 0
    ds_read_b128 v[160:163], v167 offset:1024
    v_exp_f32 v101, v101
    v_exp_f32 v102, v102
    v_exp_f32 v103, v103
    v_exp_f32 v104, v104
    v_exp_f32 v105, v105
    v_exp_f32 v106, v106
    v_exp_f32 v107, v107
    v_exp_f32 v108, v108
    v_exp_f32 v109, v109
    v_exp_f32 v110, v110
    v_smfmac_f32_32x32x32_bf16 v[128:143], v[80:83], v[96:103], v164
    v_exp_f32 v111, v111
    v_exp_f32 v112, v112
    v_exp_f32 v113, v113
    v_smfmac_f32_32x32x32_bf16 v[128:143], v[84:87], v[104:111], v164
    v_exp_f32 v114, v114
    v_exp_f32 v115, v115
    v_exp_f32 v116, v116
    s_waitcnt lgkmcnt(0)
    v_mfma_f32_32x32x16_bf16 v[96:111], v[0:3], v[160:163], 0
    v_exp_f32 v117, v117
    v_exp_f32 v118, v118
    v_exp_f32 v119, v119
    v_exp_f32 v120, v120
    v_exp_f32 v121, v121
    v_exp_f32 v122, v122
    v_exp_f32 v123, v123
    v_exp_f32 v124, v124
    v_exp_f32 v125, v125
    v_exp_f32 v126, v126
    s_waitcnt vmcnt(1)
    v_smfmac_f32_32x32x32_bf16 v[128:143], v[88:91], v[112:119], v164
    v_exp_f32 v127, v127
    v_exp_f32 v96, v96
    v_exp_f32 v97, v97
    s_waitcnt vmcnt(0)
    v_smfmac_f32_32x32x32_bf16 v[128:143], v[92:95], v[120:127], v164
    v_exp_f32 v98, v98
    v_exp_f32 v99, v99
    v_exp_f32 v100, v100
    v_mfma_f32_32x32x16_bf16 v[112:127], v[4:7], v[160:163], 0
    v_exp_f32 v101, v101
    v_exp_f32 v102, v102
    v_exp_f32 v103, v103
    v_exp_f32 v104, v104
    v_exp_f32 v105, v105
    v_exp_f32 v106, v106
    v_exp_f32 v107, v107
    v_exp_f32 v108, v108
    ds_write_b128 v165, v[128:131] offset:2048
    v_exp_f32 v109, v109
    ds_write_b128 v165, v[132:135] offset:3072
    v_exp_f32 v110, v110
    ds_write_b32 v165, v136 offset:0
    s_mov_b64 exec, 1
    ds_inc_u32 v165, v164 offset:8
    s_mov_b64 exec, -1
    v_smfmac_f32_32x32x32_bf16 v[144:159], v[32:35], v[96:103], v164
    v_exp_f32 v111, v111
    v_exp_f32 v112, v112
    v_exp_f32 v113, v113
    v_smfmac_f32_32x32x32_bf16 v[144:159], v[36:39], v[104:111], v164
    v_exp_f32 v114, v114
    v_exp_f32 v115, v115
    v_exp_f32 v116, v116
    v_mfma_f32_32x32x16_bf16 v[96:111], v[8:11], v[160:163], 0
    v_exp_f32 v117, v117
    v_exp_f32 v118, v118
    v_exp_f32 v119, v119
    v_exp_f32 v120, v120
    v_exp_f32 v121, v121
    v_exp_f32 v122, v122
    v_exp_f32 v123, v123
    v_exp_f32 v124, v124
    v_exp_f32 v125, v125
    v_exp_f32 v126, v126
    v_smfmac_f32_32x32x32_bf16 v[144:159], v[40:43], v[112:119], v164
    v_exp_f32 v127, v127
    v_exp_f32 v96, v96
    v_exp_f32 v97, v97
    v_smfmac_f32_32x32x32_bf16 v[144:159], v[44:47], v[120:127], v164
    v_exp_f32 v98, v98
    v_exp_f32 v99, v99
    v_exp_f32 v100, v100
    v_mfma_f32_32x32x16_bf16 v[112:127], v[12:15], v[160:163], 0
    v_exp_f32 v101, v101
    v_exp_f32 v102, v102
    v_exp_f32 v103, v103
    v_exp_f32 v104, v104
    v_exp_f32 v105, v105
    v_exp_f32 v106, v106
    v_exp_f32 v107, v107
    v_exp_f32 v108, v108
    v_exp_f32 v109, v109
    v_exp_f32 v110, v110
    v_smfmac_f32_32x32x32_bf16 v[144:159], v[48:51], v[96:103], v164
    v_exp_f32 v111, v111
    v_exp_f32 v112, v112
    v_exp_f32 v113, v113
    v_smfmac_f32_32x32x32_bf16 v[144:159], v[52:55], v[104:111], v164
    v_exp_f32 v114, v114
    v_exp_f32 v115, v115
    v_exp_f32 v116, v116
    v_mfma_f32_32x32x16_bf16 v[96:111], v[16:19], v[160:163], 0
    v_exp_f32 v117, v117
    v_exp_f32 v118, v118
    v_exp_f32 v119, v119
    v_exp_f32 v120, v120
    v_exp_f32 v121, v121
    v_exp_f32 v122, v122
    v_exp_f32 v123, v123
    v_exp_f32 v124, v124
    v_exp_f32 v125, v125
    v_exp_f32 v126, v126
    v_smfmac_f32_32x32x32_bf16 v[144:159], v[56:59], v[112:119], v164
    v_exp_f32 v127, v127
    v_exp_f32 v96, v96
    v_exp_f32 v97, v97
    v_smfmac_f32_32x32x32_bf16 v[144:159], v[60:63], v[120:127], v164
    v_exp_f32 v98, v98
    v_exp_f32 v99, v99
    v_exp_f32 v100, v100
    v_mfma_f32_32x32x16_bf16 v[112:127], v[20:23], v[160:163], 0
    v_exp_f32 v101, v101
    v_exp_f32 v102, v102
    v_exp_f32 v103, v103
    v_exp_f32 v104, v104
    v_exp_f32 v105, v105
    v_exp_f32 v106, v106
    v_exp_f32 v107, v107
    v_exp_f32 v108, v108
    v_exp_f32 v109, v109
    v_exp_f32 v110, v110
    v_smfmac_f32_32x32x32_bf16 v[144:159], v[64:67], v[96:103], v164
    v_exp_f32 v111, v111
    v_exp_f32 v112, v112
    v_exp_f32 v113, v113
    v_smfmac_f32_32x32x32_bf16 v[144:159], v[68:71], v[104:111], v164
    v_exp_f32 v114, v114
    v_exp_f32 v115, v115
    v_exp_f32 v116, v116
    v_mfma_f32_32x32x16_bf16 v[96:111], v[24:27], v[160:163], 0
    v_add_u32 v165, s42, v166
    v_exp_f32 v117, v117
    v_exp_f32 v118, v118
    v_exp_f32 v119, v119
    v_exp_f32 v120, v120
    v_exp_f32 v121, v121
    v_exp_f32 v122, v122
    v_exp_f32 v123, v123
    v_exp_f32 v124, v124
    v_exp_f32 v125, v125
    v_exp_f32 v126, v126
    v_smfmac_f32_32x32x32_bf16 v[144:159], v[72:75], v[112:119], v164
    v_exp_f32 v127, v127
    v_exp_f32 v96, v96
    v_exp_f32 v97, v97
    v_smfmac_f32_32x32x32_bf16 v[144:159], v[76:79], v[120:127], v164
    v_exp_f32 v98, v98
    v_exp_f32 v99, v99
    v_exp_f32 v100, v100
    v_mfma_f32_32x32x16_bf16 v[112:127], v[28:31], v[160:163], 0
    ds_read_b128 v[160:163], v165 offset:1024
    v_exp_f32 v101, v101
    ds_read_b32 v137, v165 offset:8
    v_exp_f32 v102, v102
    ds_read_b128 v[128:131], v165 offset:2048
    v_exp_f32 v103, v103
    ds_read_b128 v[132:135], v165 offset:3072
    v_exp_f32 v104, v104
    ds_read_b32 v136, v165 offset:0
    v_exp_f32 v105, v105
    v_exp_f32 v106, v106
    v_exp_f32 v107, v107
    v_exp_f32 v108, v108
    v_exp_f32 v109, v109
    v_exp_f32 v110, v110
    v_smfmac_f32_32x32x32_bf16 v[144:159], v[80:83], v[96:103], v164
    v_exp_f32 v111, v111
    v_exp_f32 v112, v112
    v_exp_f32 v113, v113
    v_smfmac_f32_32x32x32_bf16 v[144:159], v[84:87], v[104:111], v164
    v_exp_f32 v114, v114
    v_exp_f32 v115, v115
    v_exp_f32 v116, v116
    s_waitcnt lgkmcnt(4)
    v_mfma_f32_32x32x16_bf16 v[96:111], v[0:3], v[160:163], 0
    v_exp_f32 v117, v117
    v_exp_f32 v118, v118
    v_exp_f32 v119, v119
    v_exp_f32 v120, v120
    v_exp_f32 v121, v121
    v_exp_f32 v122, v122
    v_exp_f32 v123, v123
    v_exp_f32 v124, v124
    v_exp_f32 v125, v125
    v_exp_f32 v126, v126
    v_smfmac_f32_32x32x32_bf16 v[144:159], v[88:91], v[112:119], v164
    v_exp_f32 v127, v127
    v_exp_f32 v96, v96
    v_exp_f32 v97, v97
    v_smfmac_f32_32x32x32_bf16 v[144:159], v[92:95], v[120:127], v164
    v_exp_f32 v98, v98
    v_exp_f32 v99, v99
    v_exp_f32 v100, v100
    v_mfma_f32_32x32x16_bf16 v[112:127], v[4:7], v[160:163], 0
    v_exp_f32 v101, v101
    v_exp_f32 v102, v102
    v_exp_f32 v103, v103
    v_exp_f32 v104, v104
    v_exp_f32 v105, v105
    v_exp_f32 v106, v106
    v_exp_f32 v107, v107
    v_exp_f32 v108, v108
    ds_write_b128 v167, v[144:147] offset:2048
    v_exp_f32 v109, v109
    ds_write_b128 v167, v[148:151] offset:3072
    v_exp_f32 v110, v110
    ds_write_b32 v167, v152 offset:0
    s_mov_b64 exec, 1
    ds_inc_u32 v167, v164 offset:8
    s_mov_b64 exec, -1
    s_waitcnt lgkmcnt(4)
    v_readfirstlane_b32 s66, v137
    s_nop 0
    s_cmp_ge_u32 s66, 1
    s_cbranch_scc0 L_sumwait_16
L_sumok_15:
    v_smfmac_f32_32x32x32_bf16 v[128:143], v[32:35], v[96:103], v164
    v_exp_f32 v111, v111
    v_exp_f32 v112, v112
    v_exp_f32 v113, v113
    v_smfmac_f32_32x32x32_bf16 v[128:143], v[36:39], v[104:111], v164
    v_exp_f32 v114, v114
    v_exp_f32 v115, v115
    v_exp_f32 v116, v116
    v_mfma_f32_32x32x16_bf16 v[96:111], v[8:11], v[160:163], 0
    v_exp_f32 v117, v117
    v_exp_f32 v118, v118
    v_exp_f32 v119, v119
    v_exp_f32 v120, v120
    v_exp_f32 v121, v121
    v_exp_f32 v122, v122
    v_exp_f32 v123, v123
    v_exp_f32 v124, v124
    v_exp_f32 v125, v125
    v_exp_f32 v126, v126
    v_smfmac_f32_32x32x32_bf16 v[128:143], v[40:43], v[112:119], v164
    v_exp_f32 v127, v127
    v_exp_f32 v96, v96
    v_exp_f32 v97, v97
    v_smfmac_f32_32x32x32_bf16 v[128:143], v[44:47], v[120:127], v164
    v_exp_f32 v98, v98
    v_exp_f32 v99, v99
    v_exp_f32 v100, v100
    v_mfma_f32_32x32x16_bf16 v[112:127], v[12:15], v[160:163], 0
    v_exp_f32 v101, v101
    v_exp_f32 v102, v102
    v_exp_f32 v103, v103
    v_exp_f32 v104, v104
    v_exp_f32 v105, v105
    v_exp_f32 v106, v106
    v_exp_f32 v107, v107
    v_exp_f32 v108, v108
    v_exp_f32 v109, v109
    v_exp_f32 v110, v110
    v_smfmac_f32_32x32x32_bf16 v[128:143], v[48:51], v[96:103], v164
    v_exp_f32 v111, v111
    v_exp_f32 v112, v112
    v_exp_f32 v113, v113
    v_smfmac_f32_32x32x32_bf16 v[128:143], v[52:55], v[104:111], v164
    v_exp_f32 v114, v114
    v_exp_f32 v115, v115
    v_exp_f32 v116, v116
    v_mfma_f32_32x32x16_bf16 v[96:111], v[16:19], v[160:163], 0
    v_exp_f32 v117, v117
    v_exp_f32 v118, v118
    v_exp_f32 v119, v119
    v_exp_f32 v120, v120
    v_exp_f32 v121, v121
    v_exp_f32 v122, v122
    v_exp_f32 v123, v123
    v_exp_f32 v124, v124
    v_exp_f32 v125, v125
    v_exp_f32 v126, v126
    v_smfmac_f32_32x32x32_bf16 v[128:143], v[56:59], v[112:119], v164
    v_exp_f32 v127, v127
    v_exp_f32 v96, v96
    v_exp_f32 v97, v97
    v_smfmac_f32_32x32x32_bf16 v[128:143], v[60:63], v[120:127], v164
    v_exp_f32 v98, v98
    v_exp_f32 v99, v99
    v_exp_f32 v100, v100
    v_mfma_f32_32x32x16_bf16 v[112:127], v[20:23], v[160:163], 0
    v_exp_f32 v101, v101
    v_exp_f32 v102, v102
    v_exp_f32 v103, v103
    v_exp_f32 v104, v104
    v_exp_f32 v105, v105
    v_exp_f32 v106, v106
    v_exp_f32 v107, v107
    v_exp_f32 v108, v108
    v_exp_f32 v109, v109
    v_exp_f32 v110, v110
    v_smfmac_f32_32x32x32_bf16 v[128:143], v[64:67], v[96:103], v164
    v_exp_f32 v111, v111
    v_exp_f32 v112, v112
    v_exp_f32 v113, v113
    v_smfmac_f32_32x32x32_bf16 v[128:143], v[68:71], v[104:111], v164
    v_exp_f32 v114, v114
    v_exp_f32 v115, v115
    v_exp_f32 v116, v116
    v_mfma_f32_32x32x16_bf16 v[96:111], v[24:27], v[160:163], 0
    v_add_u32 v167, s43, v166
    v_exp_f32 v117, v117
    v_exp_f32 v118, v118
    v_exp_f32 v119, v119
    v_exp_f32 v120, v120
    v_exp_f32 v121, v121
    v_exp_f32 v122, v122
    v_exp_f32 v123, v123
    v_exp_f32 v124, v124
    v_exp_f32 v125, v125
    v_exp_f32 v126, v126
    v_smfmac_f32_32x32x32_bf16 v[128:143], v[72:75], v[112:119], v164
    v_exp_f32 v127, v127
    v_exp_f32 v96, v96
    v_exp_f32 v97, v97
    v_smfmac_f32_32x32x32_bf16 v[128:143], v[76:79], v[120:127], v164
    v_exp_f32 v98, v98
    v_exp_f32 v99, v99
    v_exp_f32 v100, v100
    v_mfma_f32_32x32x16_bf16 v[112:127], v[28:31], v[160:163], 0
    ds_read_b128 v[160:163], v167 offset:1024
    v_exp_f32 v101, v101
    ds_read_b32 v153, v167 offset:8
    v_exp_f32 v102, v102
    ds_read_b128 v[144:147], v167 offset:2048
    v_exp_f32 v103, v103
    ds_read_b128 v[148:151], v167 offset:3072
    v_exp_f32 v104, v104
    ds_read_b32 v152, v167 offset:0
    v_exp_f32 v105, v105
    v_exp_f32 v106, v106
    v_exp_f32 v107, v107
    v_exp_f32 v108, v108
    v_exp_f32 v109, v109
    v_exp_f32 v110, v110
    v_smfmac_f32_32x32x32_bf16 v[128:143], v[80:83], v[96:103], v164
    v_exp_f32 v111, v111
    v_exp_f32 v112, v112
    v_exp_f32 v113, v113
    v_smfmac_f32_32x32x32_bf16 v[128:143], v[84:87], v[104:111], v164
    v_exp_f32 v114, v114
    v_exp_f32 v115, v115
    v_exp_f32 v116, v116
    s_waitcnt lgkmcnt(4)
    v_mfma_f32_32x32x16_bf16 v[96:111], v[0:3], v[160:163], 0
    v_exp_f32 v117, v117
    v_exp_f32 v118, v118
    v_exp_f32 v119, v119
    v_exp_f32 v120, v120
    v_exp_f32 v121, v121
    v_exp_f32 v122, v122
    v_exp_f32 v123, v123
    v_exp_f32 v124, v124
    v_exp_f32 v125, v125
    v_exp_f32 v126, v126
    v_smfmac_f32_32x32x32_bf16 v[128:143], v[88:91], v[112:119], v164
    v_exp_f32 v127, v127
    s_setprio 1
    v_exp_f32 v96, v96
    v_exp_f32 v97, v97
    v_smfmac_f32_32x32x32_bf16 v[128:143], v[92:95], v[120:127], v164
    v_exp_f32 v98, v98
    v_exp_f32 v99, v99
    v_exp_f32 v100, v100
    v_mfma_f32_32x32x16_bf16 v[112:127], v[4:7], v[160:163], 0
    v_exp_f32 v101, v101
    v_exp_f32 v102, v102
    v_exp_f32 v103, v103
    v_exp_f32 v104, v104
    v_exp_f32 v105, v105
    v_exp_f32 v106, v106
    v_exp_f32 v107, v107
    v_exp_f32 v108, v108
    ds_write_b128 v165, v[128:131] offset:2048
    v_exp_f32 v109, v109
    ds_write_b128 v165, v[132:135] offset:3072
    v_exp_f32 v110, v110
    ds_write_b32 v165, v136 offset:0
    s_mov_b64 exec, 1
    ds_inc_u32 v165, v164 offset:8
    s_mov_b64 exec, -1
    s_waitcnt lgkmcnt(4)
    v_readfirstlane_b32 s66, v153
    s_nop 0
    s_cmp_ge_u32 s66, 1
    s_cbranch_scc0 L_sumwait_18
L_sumok_17:
    v_smfmac_f32_32x32x32_bf16 v[144:159], v[32:35], v[96:103], v164
    v_exp_f32 v111, v111
    v_exp_f32 v112, v112
    v_exp_f32 v113, v113
    v_smfmac_f32_32x32x32_bf16 v[144:159], v[36:39], v[104:111], v164
    v_exp_f32 v114, v114
    v_exp_f32 v115, v115
    v_exp_f32 v116, v116
    v_mfma_f32_32x32x16_bf16 v[96:111], v[8:11], v[160:163], 0
    v_exp_f32 v117, v117
    v_exp_f32 v118, v118
    v_exp_f32 v119, v119
    v_exp_f32 v120, v120
    v_exp_f32 v121, v121
    v_exp_f32 v122, v122
    v_exp_f32 v123, v123
    v_exp_f32 v124, v124
    v_exp_f32 v125, v125
    v_exp_f32 v126, v126
    v_smfmac_f32_32x32x32_bf16 v[144:159], v[40:43], v[112:119], v164
    v_exp_f32 v127, v127
    v_exp_f32 v96, v96
    v_exp_f32 v97, v97
    v_smfmac_f32_32x32x32_bf16 v[144:159], v[44:47], v[120:127], v164
    v_exp_f32 v98, v98
    v_exp_f32 v99, v99
    v_exp_f32 v100, v100
    v_mfma_f32_32x32x16_bf16 v[112:127], v[12:15], v[160:163], 0
    v_exp_f32 v101, v101
    v_exp_f32 v102, v102
    v_exp_f32 v103, v103
    v_exp_f32 v104, v104
    v_exp_f32 v105, v105
    v_exp_f32 v106, v106
    v_exp_f32 v107, v107
    v_exp_f32 v108, v108
    v_exp_f32 v109, v109
    v_exp_f32 v110, v110
    v_smfmac_f32_32x32x32_bf16 v[144:159], v[48:51], v[96:103], v164
    v_exp_f32 v111, v111
    v_exp_f32 v112, v112
    v_exp_f32 v113, v113
    v_smfmac_f32_32x32x32_bf16 v[144:159], v[52:55], v[104:111], v164
    v_exp_f32 v114, v114
    v_exp_f32 v115, v115
    v_exp_f32 v116, v116
    v_mfma_f32_32x32x16_bf16 v[96:111], v[16:19], v[160:163], 0
    v_exp_f32 v117, v117
    v_exp_f32 v118, v118
    v_exp_f32 v119, v119
    v_exp_f32 v120, v120
    v_exp_f32 v121, v121
    v_exp_f32 v122, v122
    v_exp_f32 v123, v123
    v_exp_f32 v124, v124
    v_exp_f32 v125, v125
    v_exp_f32 v126, v126
    v_smfmac_f32_32x32x32_bf16 v[144:159], v[56:59], v[112:119], v164
    v_exp_f32 v127, v127
    v_exp_f32 v96, v96
    v_exp_f32 v97, v97
    v_smfmac_f32_32x32x32_bf16 v[144:159], v[60:63], v[120:127], v164
    v_exp_f32 v98, v98
    v_exp_f32 v99, v99
    v_exp_f32 v100, v100
    v_mfma_f32_32x32x16_bf16 v[112:127], v[20:23], v[160:163], 0
    v_exp_f32 v101, v101
    v_exp_f32 v102, v102
    v_exp_f32 v103, v103
    v_exp_f32 v104, v104
    v_exp_f32 v105, v105
    v_exp_f32 v106, v106
    v_exp_f32 v107, v107
    v_exp_f32 v108, v108
    v_exp_f32 v109, v109
    v_exp_f32 v110, v110
    v_smfmac_f32_32x32x32_bf16 v[144:159], v[64:67], v[96:103], v164
    v_exp_f32 v111, v111
    v_exp_f32 v112, v112
    v_exp_f32 v113, v113
    v_smfmac_f32_32x32x32_bf16 v[144:159], v[68:71], v[104:111], v164
    v_exp_f32 v114, v114
    v_exp_f32 v115, v115
    v_exp_f32 v116, v116
    v_mfma_f32_32x32x16_bf16 v[96:111], v[24:27], v[160:163], 0
    v_add_u32 v165, s44, v166
    v_exp_f32 v117, v117
    v_exp_f32 v118, v118
    v_exp_f32 v119, v119
    v_exp_f32 v120, v120
    v_exp_f32 v121, v121
    v_exp_f32 v122, v122
    v_exp_f32 v123, v123
    v_exp_f32 v124, v124
    v_exp_f32 v125, v125
    v_exp_f32 v126, v126
    v_smfmac_f32_32x32x32_bf16 v[144:159], v[72:75], v[112:119], v164
    v_exp_f32 v127, v127
    v_exp_f32 v96, v96
    v_exp_f32 v97, v97
    v_smfmac_f32_32x32x32_bf16 v[144:159], v[76:79], v[120:127], v164
    v_exp_f32 v98, v98
    v_exp_f32 v99, v99
    v_exp_f32 v100, v100
    v_mfma_f32_32x32x16_bf16 v[112:127], v[28:31], v[160:163], 0
    ds_read_b128 v[160:163], v165 offset:1024
    v_exp_f32 v101, v101
    ds_read_b32 v137, v165 offset:8
    v_exp_f32 v102, v102
    ds_read_b128 v[128:131], v165 offset:2048
    v_exp_f32 v103, v103
    ds_read_b128 v[132:135], v165 offset:3072
    v_exp_f32 v104, v104
    ds_read_b32 v136, v165 offset:0
    v_exp_f32 v105, v105
    v_exp_f32 v106, v106
    v_exp_f32 v107, v107
    v_exp_f32 v108, v108
    v_exp_f32 v109, v109
    v_exp_f32 v110, v110
    v_smfmac_f32_32x32x32_bf16 v[144:159], v[80:83], v[96:103], v164
    v_exp_f32 v111, v111
    v_exp_f32 v112, v112
    v_exp_f32 v113, v113
    v_smfmac_f32_32x32x32_bf16 v[144:159], v[84:87], v[104:111], v164
    v_exp_f32 v114, v114
    v_exp_f32 v115, v115
    v_exp_f32 v116, v116
    s_waitcnt lgkmcnt(4)
    v_mfma_f32_32x32x16_bf16 v[96:111], v[0:3], v[160:163], 0
    v_exp_f32 v117, v117
    v_exp_f32 v118, v118
    v_exp_f32 v119, v119
    v_exp_f32 v120, v120
    v_exp_f32 v121, v121
    v_exp_f32 v122, v122
    v_exp_f32 v123, v123
    v_exp_f32 v124, v124
    v_exp_f32 v125, v125
    v_exp_f32 v126, v126
    v_smfmac_f32_32x32x32_bf16 v[144:159], v[88:91], v[112:119], v164
    v_exp_f32 v127, v127
    v_exp_f32 v96, v96
    v_exp_f32 v97, v97
    v_smfmac_f32_32x32x32_bf16 v[144:159], v[92:95], v[120:127], v164
    v_exp_f32 v98, v98
    v_exp_f32 v99, v99
    v_exp_f32 v100, v100
    v_mfma_f32_32x32x16_bf16 v[112:127], v[4:7], v[160:163], 0
    v_exp_f32 v101, v101
    v_exp_f32 v102, v102
    v_exp_f32 v103, v103
    v_exp_f32 v104, v104
    v_exp_f32 v105, v105
    v_exp_f32 v106, v106
    v_exp_f32 v107, v107
    v_exp_f32 v108, v108
    ds_write_b128 v167, v[144:147] offset:2048
    v_exp_f32 v109, v109
    ds_write_b128 v167, v[148:151] offset:3072
    v_exp_f32 v110, v110
    ds_write_b32 v167, v152 offset:0
    s_mov_b64 exec, 1
    ds_inc_u32 v167, v164 offset:8
    s_mov_b64 exec, -1
    s_waitcnt lgkmcnt(4)
    v_readfirstlane_b32 s66, v137
    s_nop 0
    s_cmp_ge_u32 s66, 2
    s_cbranch_scc0 L_sumwait_20
L_sumok_19:
    v_smfmac_f32_32x32x32_bf16 v[128:143], v[32:35], v[96:103], v164
    v_exp_f32 v111, v111
    v_exp_f32 v112, v112
    v_exp_f32 v113, v113
    v_smfmac_f32_32x32x32_bf16 v[128:143], v[36:39], v[104:111], v164
    v_exp_f32 v114, v114
    v_exp_f32 v115, v115
    v_exp_f32 v116, v116
    v_mfma_f32_32x32x16_bf16 v[96:111], v[8:11], v[160:163], 0
    v_exp_f32 v117, v117
    v_exp_f32 v118, v118
    v_exp_f32 v119, v119
    v_exp_f32 v120, v120
    v_exp_f32 v121, v121
    v_exp_f32 v122, v122
    v_exp_f32 v123, v123
    v_exp_f32 v124, v124
    v_exp_f32 v125, v125
    v_exp_f32 v126, v126
    v_smfmac_f32_32x32x32_bf16 v[128:143], v[40:43], v[112:119], v164
    v_exp_f32 v127, v127
    v_exp_f32 v96, v96
    v_exp_f32 v97, v97
    v_smfmac_f32_32x32x32_bf16 v[128:143], v[44:47], v[120:127], v164
    v_exp_f32 v98, v98
    v_exp_f32 v99, v99
    v_exp_f32 v100, v100
    v_mfma_f32_32x32x16_bf16 v[112:127], v[12:15], v[160:163], 0
    v_exp_f32 v101, v101
    v_exp_f32 v102, v102
    v_exp_f32 v103, v103
    v_exp_f32 v104, v104
    v_exp_f32 v105, v105
    v_exp_f32 v106, v106
    v_exp_f32 v107, v107
    v_exp_f32 v108, v108
    v_exp_f32 v109, v109
    v_exp_f32 v110, v110
    v_smfmac_f32_32x32x32_bf16 v[128:143], v[48:51], v[96:103], v164
    v_exp_f32 v111, v111
    v_exp_f32 v112, v112
    v_exp_f32 v113, v113
    v_smfmac_f32_32x32x32_bf16 v[128:143], v[52:55], v[104:111], v164
    v_exp_f32 v114, v114
    v_exp_f32 v115, v115
    v_exp_f32 v116, v116
    v_mfma_f32_32x32x16_bf16 v[96:111], v[16:19], v[160:163], 0
    v_exp_f32 v117, v117
    v_exp_f32 v118, v118
    v_exp_f32 v119, v119
    v_exp_f32 v120, v120
    v_exp_f32 v121, v121
    v_exp_f32 v122, v122
    v_exp_f32 v123, v123
    v_exp_f32 v124, v124
    v_exp_f32 v125, v125
    v_exp_f32 v126, v126
    v_smfmac_f32_32x32x32_bf16 v[128:143], v[56:59], v[112:119], v164
    v_exp_f32 v127, v127
    v_exp_f32 v96, v96
    v_exp_f32 v97, v97
    v_smfmac_f32_32x32x32_bf16 v[128:143], v[60:63], v[120:127], v164
    v_exp_f32 v98, v98
    v_exp_f32 v99, v99
    v_exp_f32 v100, v100
    v_mfma_f32_32x32x16_bf16 v[112:127], v[20:23], v[160:163], 0
    v_exp_f32 v101, v101
    v_exp_f32 v102, v102
    v_exp_f32 v103, v103
    v_exp_f32 v104, v104
    v_exp_f32 v105, v105
    v_exp_f32 v106, v106
    v_exp_f32 v107, v107
    v_exp_f32 v108, v108
    v_exp_f32 v109, v109
    v_exp_f32 v110, v110
    v_smfmac_f32_32x32x32_bf16 v[128:143], v[64:67], v[96:103], v164
    v_exp_f32 v111, v111
    v_exp_f32 v112, v112
    v_exp_f32 v113, v113
    v_smfmac_f32_32x32x32_bf16 v[128:143], v[68:71], v[104:111], v164
    v_exp_f32 v114, v114
    v_exp_f32 v115, v115
    v_exp_f32 v116, v116
    v_mfma_f32_32x32x16_bf16 v[96:111], v[24:27], v[160:163], 0
    v_add_u32 v167, s45, v166
    v_exp_f32 v117, v117
    v_exp_f32 v118, v118
    v_exp_f32 v119, v119
    v_exp_f32 v120, v120
    v_exp_f32 v121, v121
    v_exp_f32 v122, v122
    v_exp_f32 v123, v123
    v_exp_f32 v124, v124
    v_exp_f32 v125, v125
    v_exp_f32 v126, v126
    v_smfmac_f32_32x32x32_bf16 v[128:143], v[72:75], v[112:119], v164
    v_exp_f32 v127, v127
    v_exp_f32 v96, v96
    v_exp_f32 v97, v97
    v_smfmac_f32_32x32x32_bf16 v[128:143], v[76:79], v[120:127], v164
    v_exp_f32 v98, v98
    v_exp_f32 v99, v99
    v_exp_f32 v100, v100
    v_mfma_f32_32x32x16_bf16 v[112:127], v[28:31], v[160:163], 0
    ds_read_b128 v[160:163], v167 offset:1024
    v_exp_f32 v101, v101
    ds_read_b32 v153, v167 offset:8
    v_exp_f32 v102, v102
    ds_read_b128 v[144:147], v167 offset:2048
    v_exp_f32 v103, v103
    ds_read_b128 v[148:151], v167 offset:3072
    v_exp_f32 v104, v104
    ds_read_b32 v152, v167 offset:0
    v_exp_f32 v105, v105
    v_exp_f32 v106, v106
    v_exp_f32 v107, v107
    v_exp_f32 v108, v108
    v_exp_f32 v109, v109
    v_exp_f32 v110, v110
    v_smfmac_f32_32x32x32_bf16 v[128:143], v[80:83], v[96:103], v164
    v_exp_f32 v111, v111
    v_exp_f32 v112, v112
    v_exp_f32 v113, v113
    v_smfmac_f32_32x32x32_bf16 v[128:143], v[84:87], v[104:111], v164
    v_exp_f32 v114, v114
    v_exp_f32 v115, v115
    v_exp_f32 v116, v116
    s_waitcnt lgkmcnt(4)
    v_mfma_f32_32x32x16_bf16 v[96:111], v[0:3], v[160:163], 0
    v_exp_f32 v117, v117
    v_exp_f32 v118, v118
    v_exp_f32 v119, v119
    v_exp_f32 v120, v120
    v_exp_f32 v121, v121
    v_exp_f32 v122, v122
    v_exp_f32 v123, v123
    v_exp_f32 v124, v124
    v_exp_f32 v125, v125
    v_exp_f32 v126, v126
    v_smfmac_f32_32x32x32_bf16 v[128:143], v[88:91], v[112:119], v164
    v_exp_f32 v127, v127
    v_exp_f32 v96, v96
    v_exp_f32 v97, v97
    v_smfmac_f32_32x32x32_bf16 v[128:143], v[92:95], v[120:127], v164
    v_exp_f32 v98, v98
    v_exp_f32 v99, v99
    v_exp_f32 v100, v100
    v_mfma_f32_32x32x16_bf16 v[112:127], v[4:7], v[160:163], 0
    v_exp_f32 v101, v101
    v_exp_f32 v102, v102
    v_exp_f32 v103, v103
    v_exp_f32 v104, v104
    v_exp_f32 v105, v105
    v_exp_f32 v106, v106
    v_exp_f32 v107, v107
    v_exp_f32 v108, v108
    ds_write_b128 v165, v[128:131] offset:2048
    v_exp_f32 v109, v109
    ds_write_b128 v165, v[132:135] offset:3072
    v_exp_f32 v110, v110
    ds_write_b32 v165, v136 offset:0
    s_mov_b64 exec, 1
    ds_inc_u32 v165, v164 offset:8
    s_mov_b64 exec, -1
    s_waitcnt lgkmcnt(4)
    v_readfirstlane_b32 s66, v153
    s_nop 0
    s_cmp_ge_u32 s66, 2
    s_cbranch_scc0 L_sumwait_22
L_sumok_21:
    v_smfmac_f32_32x32x32_bf16 v[144:159], v[32:35], v[96:103], v164
    v_exp_f32 v111, v111
    v_exp_f32 v112, v112
    v_exp_f32 v113, v113
    v_smfmac_f32_32x32x32_bf16 v[144:159], v[36:39], v[104:111], v164
    v_exp_f32 v114, v114
    v_exp_f32 v115, v115
    v_exp_f32 v116, v116
    v_mfma_f32_32x32x16_bf16 v[96:111], v[8:11], v[160:163], 0
    v_exp_f32 v117, v117
    v_exp_f32 v118, v118
    v_exp_f32 v119, v119
    v_exp_f32 v120, v120
    v_exp_f32 v121, v121
    v_exp_f32 v122, v122
    v_exp_f32 v123, v123
    v_exp_f32 v124, v124
    v_exp_f32 v125, v125
    v_exp_f32 v126, v126
    v_smfmac_f32_32x32x32_bf16 v[144:159], v[40:43], v[112:119], v164
    v_exp_f32 v127, v127
    v_exp_f32 v96, v96
    v_exp_f32 v97, v97
    v_smfmac_f32_32x32x32_bf16 v[144:159], v[44:47], v[120:127], v164
    v_exp_f32 v98, v98
    v_exp_f32 v99, v99
    v_exp_f32 v100, v100
    v_mfma_f32_32x32x16_bf16 v[112:127], v[12:15], v[160:163], 0
    v_exp_f32 v101, v101
    v_exp_f32 v102, v102
    v_exp_f32 v103, v103
    v_exp_f32 v104, v104
    v_exp_f32 v105, v105
    v_exp_f32 v106, v106
    v_exp_f32 v107, v107
    v_exp_f32 v108, v108
    v_exp_f32 v109, v109
    v_exp_f32 v110, v110
    v_smfmac_f32_32x32x32_bf16 v[144:159], v[48:51], v[96:103], v164
    v_exp_f32 v111, v111
    v_exp_f32 v112, v112
    v_exp_f32 v113, v113
    v_smfmac_f32_32x32x32_bf16 v[144:159], v[52:55], v[104:111], v164
    v_exp_f32 v114, v114
    v_exp_f32 v115, v115
    v_exp_f32 v116, v116
    v_mfma_f32_32x32x16_bf16 v[96:111], v[16:19], v[160:163], 0
    v_exp_f32 v117, v117
    v_exp_f32 v118, v118
    v_exp_f32 v119, v119
    v_exp_f32 v120, v120
    v_exp_f32 v121, v121
    v_exp_f32 v122, v122
    v_exp_f32 v123, v123
    v_exp_f32 v124, v124
    v_exp_f32 v125, v125
    v_exp_f32 v126, v126
    v_smfmac_f32_32x32x32_bf16 v[144:159], v[56:59], v[112:119], v164
    v_exp_f32 v127, v127
    v_exp_f32 v96, v96
    v_exp_f32 v97, v97
    v_smfmac_f32_32x32x32_bf16 v[144:159], v[60:63], v[120:127], v164
    v_exp_f32 v98, v98
    v_exp_f32 v99, v99
    v_exp_f32 v100, v100
    v_mfma_f32_32x32x16_bf16 v[112:127], v[20:23], v[160:163], 0
    v_exp_f32 v101, v101
    v_exp_f32 v102, v102
    v_exp_f32 v103, v103
    v_exp_f32 v104, v104
    v_exp_f32 v105, v105
    v_exp_f32 v106, v106
    v_exp_f32 v107, v107
    v_exp_f32 v108, v108
    v_exp_f32 v109, v109
    v_exp_f32 v110, v110
    v_smfmac_f32_32x32x32_bf16 v[144:159], v[64:67], v[96:103], v164
    v_exp_f32 v111, v111
    v_exp_f32 v112, v112
    v_exp_f32 v113, v113
    v_smfmac_f32_32x32x32_bf16 v[144:159], v[68:71], v[104:111], v164
    v_exp_f32 v114, v114
    v_exp_f32 v115, v115
    v_exp_f32 v116, v116
    v_mfma_f32_32x32x16_bf16 v[96:111], v[24:27], v[160:163], 0
    v_add_u32 v165, s46, v166
    v_exp_f32 v117, v117
    v_exp_f32 v118, v118
    v_exp_f32 v119, v119
    v_exp_f32 v120, v120
    v_exp_f32 v121, v121
    v_exp_f32 v122, v122
    v_exp_f32 v123, v123
    v_exp_f32 v124, v124
    v_exp_f32 v125, v125
    v_exp_f32 v126, v126
    v_smfmac_f32_32x32x32_bf16 v[144:159], v[72:75], v[112:119], v164
    v_exp_f32 v127, v127
    v_exp_f32 v96, v96
    v_exp_f32 v97, v97
    v_smfmac_f32_32x32x32_bf16 v[144:159], v[76:79], v[120:127], v164
    v_exp_f32 v98, v98
    v_exp_f32 v99, v99
    v_exp_f32 v100, v100
    v_mfma_f32_32x32x16_bf16 v[112:127], v[28:31], v[160:163], 0
    ds_read_b128 v[160:163], v165 offset:1024
    v_exp_f32 v101, v101
    ds_read_b32 v137, v165 offset:8
    v_exp_f32 v102, v102
    ds_read_b128 v[128:131], v165 offset:2048
    v_exp_f32 v103, v103
    ds_read_b128 v[132:135], v165 offset:3072
    v_exp_f32 v104, v104
    ds_read_b32 v136, v165 offset:0
    v_exp_f32 v105, v105
    v_exp_f32 v106, v106
    v_exp_f32 v107, v107
    v_exp_f32 v108, v108
    v_exp_f32 v109, v109
    v_exp_f32 v110, v110
    v_smfmac_f32_32x32x32_bf16 v[144:159], v[80:83], v[96:103], v164
    v_exp_f32 v111, v111
    v_exp_f32 v112, v112
    v_exp_f32 v113, v113
    v_smfmac_f32_32x32x32_bf16 v[144:159], v[84:87], v[104:111], v164
    v_exp_f32 v114, v114
    v_exp_f32 v115, v115
    v_exp_f32 v116, v116
    s_waitcnt lgkmcnt(4)
    v_mfma_f32_32x32x16_bf16 v[96:111], v[0:3], v[160:163], 0
    v_exp_f32 v117, v117
    v_exp_f32 v118, v118
    v_exp_f32 v119, v119
    v_exp_f32 v120, v120
    v_exp_f32 v121, v121
    v_exp_f32 v122, v122
    v_exp_f32 v123, v123
    v_exp_f32 v124, v124
    v_exp_f32 v125, v125
    v_exp_f32 v126, v126
    v_smfmac_f32_32x32x32_bf16 v[144:159], v[88:91], v[112:119], v164
    v_exp_f32 v127, v127
    s_setprio 0
    v_exp_f32 v96, v96
    v_exp_f32 v97, v97
    v_smfmac_f32_32x32x32_bf16 v[144:159], v[92:95], v[120:127], v164
    v_exp_f32 v98, v98
    v_exp_f32 v99, v99
    v_exp_f32 v100, v100
    v_mfma_f32_32x32x16_bf16 v[112:127], v[4:7], v[160:163], 0
    v_exp_f32 v101, v101
    v_exp_f32 v102, v102
    v_exp_f32 v103, v103
    v_exp_f32 v104, v104
    v_exp_f32 v105, v105
    v_exp_f32 v106, v106
    v_exp_f32 v107, v107
    v_exp_f32 v108, v108
    ds_write_b128 v167, v[144:147] offset:2048
    v_exp_f32 v109, v109
    ds_write_b128 v167, v[148:151] offset:3072
    v_exp_f32 v110, v110
    ds_write_b32 v167, v152 offset:0
    s_mov_b64 exec, 1
    ds_inc_u32 v167, v164 offset:8
    s_mov_b64 exec, -1
    s_waitcnt lgkmcnt(4)
    v_readfirstlane_b32 s66, v137
    s_nop 0
    s_cmp_ge_u32 s66, 3
    s_cbranch_scc0 L_sumwait_24
L_sumok_23:
    v_smfmac_f32_32x32x32_bf16 v[128:143], v[32:35], v[96:103], v164
    v_exp_f32 v111, v111
    v_exp_f32 v112, v112
    v_exp_f32 v113, v113
    v_smfmac_f32_32x32x32_bf16 v[128:143], v[36:39], v[104:111], v164
    v_exp_f32 v114, v114
    v_exp_f32 v115, v115
    v_exp_f32 v116, v116
    v_mfma_f32_32x32x16_bf16 v[96:111], v[8:11], v[160:163], 0
    v_exp_f32 v117, v117
    v_exp_f32 v118, v118
    v_exp_f32 v119, v119
    v_exp_f32 v120, v120
    v_exp_f32 v121, v121
    v_exp_f32 v122, v122
    v_exp_f32 v123, v123
    v_exp_f32 v124, v124
    v_exp_f32 v125, v125
    v_exp_f32 v126, v126
    v_smfmac_f32_32x32x32_bf16 v[128:143], v[40:43], v[112:119], v164
    v_exp_f32 v127, v127
    v_exp_f32 v96, v96
    v_exp_f32 v97, v97
    v_smfmac_f32_32x32x32_bf16 v[128:143], v[44:47], v[120:127], v164
    v_exp_f32 v98, v98
    v_exp_f32 v99, v99
    v_exp_f32 v100, v100
    v_mfma_f32_32x32x16_bf16 v[112:127], v[12:15], v[160:163], 0
    v_exp_f32 v101, v101
    v_exp_f32 v102, v102
    v_exp_f32 v103, v103
    v_exp_f32 v104, v104
    v_exp_f32 v105, v105
    v_exp_f32 v106, v106
    v_exp_f32 v107, v107
    v_exp_f32 v108, v108
    v_exp_f32 v109, v109
    v_exp_f32 v110, v110
    v_smfmac_f32_32x32x32_bf16 v[128:143], v[48:51], v[96:103], v164
    v_exp_f32 v111, v111
    v_exp_f32 v112, v112
    v_exp_f32 v113, v113
    v_smfmac_f32_32x32x32_bf16 v[128:143], v[52:55], v[104:111], v164
    v_exp_f32 v114, v114
    v_exp_f32 v115, v115
    v_exp_f32 v116, v116
    v_mfma_f32_32x32x16_bf16 v[96:111], v[16:19], v[160:163], 0
    v_exp_f32 v117, v117
    v_exp_f32 v118, v118
    v_exp_f32 v119, v119
    v_exp_f32 v120, v120
    v_exp_f32 v121, v121
    v_exp_f32 v122, v122
    v_exp_f32 v123, v123
    v_exp_f32 v124, v124
    v_exp_f32 v125, v125
    v_exp_f32 v126, v126
    v_smfmac_f32_32x32x32_bf16 v[128:143], v[56:59], v[112:119], v164
    v_exp_f32 v127, v127
    v_exp_f32 v96, v96
    v_exp_f32 v97, v97
    v_smfmac_f32_32x32x32_bf16 v[128:143], v[60:63], v[120:127], v164
    v_exp_f32 v98, v98
    v_exp_f32 v99, v99
    v_exp_f32 v100, v100
    v_mfma_f32_32x32x16_bf16 v[112:127], v[20:23], v[160:163], 0
    v_exp_f32 v101, v101
    v_exp_f32 v102, v102
    v_exp_f32 v103, v103
    v_exp_f32 v104, v104
    v_exp_f32 v105, v105
    v_exp_f32 v106, v106
    v_exp_f32 v107, v107
    v_exp_f32 v108, v108
    v_exp_f32 v109, v109
    v_exp_f32 v110, v110
    v_smfmac_f32_32x32x32_bf16 v[128:143], v[64:67], v[96:103], v164
    v_exp_f32 v111, v111
    v_exp_f32 v112, v112
    v_exp_f32 v113, v113
    v_smfmac_f32_32x32x32_bf16 v[128:143], v[68:71], v[104:111], v164
    v_exp_f32 v114, v114
    v_exp_f32 v115, v115
    v_exp_f32 v116, v116
    v_mfma_f32_32x32x16_bf16 v[96:111], v[24:27], v[160:163], 0
    v_add_u32 v167, s47, v166
    v_exp_f32 v117, v117
    v_exp_f32 v118, v118
    v_exp_f32 v119, v119
    v_exp_f32 v120, v120
    v_exp_f32 v121, v121
    v_exp_f32 v122, v122
    v_exp_f32 v123, v123
    v_exp_f32 v124, v124
    v_exp_f32 v125, v125
    v_exp_f32 v126, v126
    v_smfmac_f32_32x32x32_bf16 v[128:143], v[72:75], v[112:119], v164
    v_exp_f32 v127, v127
    v_exp_f32 v96, v96
    v_exp_f32 v97, v97
    v_smfmac_f32_32x32x32_bf16 v[128:143], v[76:79], v[120:127], v164
    v_exp_f32 v98, v98
    v_exp_f32 v99, v99
    v_exp_f32 v100, v100
    v_mfma_f32_32x32x16_bf16 v[112:127], v[28:31], v[160:163], 0
    ds_read_b128 v[160:163], v167 offset:1024
    v_exp_f32 v101, v101
    ds_read_b32 v153, v167 offset:8
    v_exp_f32 v102, v102
    ds_read_b128 v[144:147], v167 offset:2048
    v_exp_f32 v103, v103
    ds_read_b128 v[148:151], v167 offset:3072
    v_exp_f32 v104, v104
    ds_read_b32 v152, v167 offset:0
    v_exp_f32 v105, v105
    v_exp_f32 v106, v106
    v_exp_f32 v107, v107
    v_exp_f32 v108, v108
    v_exp_f32 v109, v109
    v_exp_f32 v110, v110
    v_smfmac_f32_32x32x32_bf16 v[128:143], v[80:83], v[96:103], v164
    v_exp_f32 v111, v111
    v_exp_f32 v112, v112
    v_exp_f32 v113, v113
    v_smfmac_f32_32x32x32_bf16 v[128:143], v[84:87], v[104:111], v164
    v_exp_f32 v114, v114
    v_exp_f32 v115, v115
    v_exp_f32 v116, v116
    s_waitcnt lgkmcnt(4)
    v_mfma_f32_32x32x16_bf16 v[96:111], v[0:3], v[160:163], 0
    v_exp_f32 v117, v117
    v_exp_f32 v118, v118
    v_exp_f32 v119, v119
    v_exp_f32 v120, v120
    v_exp_f32 v121, v121
    v_exp_f32 v122, v122
    v_exp_f32 v123, v123
    v_exp_f32 v124, v124
    v_exp_f32 v125, v125
    v_exp_f32 v126, v126
    v_smfmac_f32_32x32x32_bf16 v[128:143], v[88:91], v[112:119], v164
    v_exp_f32 v127, v127
    v_exp_f32 v96, v96
    v_exp_f32 v97, v97
    v_smfmac_f32_32x32x32_bf16 v[128:143], v[92:95], v[120:127], v164
    v_exp_f32 v98, v98
    v_exp_f32 v99, v99
    v_exp_f32 v100, v100
    v_mfma_f32_32x32x16_bf16 v[112:127], v[4:7], v[160:163], 0
    v_exp_f32 v101, v101
    v_exp_f32 v102, v102
    v_exp_f32 v103, v103
    v_exp_f32 v104, v104
    v_exp_f32 v105, v105
    v_exp_f32 v106, v106
    v_exp_f32 v107, v107
    v_exp_f32 v108, v108
    v_exp_f32 v109, v109
    v_exp_f32 v110, v110
    s_waitcnt lgkmcnt(0)
    v_readfirstlane_b32 s66, v153
    s_nop 0
    s_cmp_ge_u32 s66, 3
    s_cbranch_scc0 L_sumwait_26
L_sumok_25:
    v_smfmac_f32_32x32x32_bf16 v[144:159], v[32:35], v[96:103], v164
    v_exp_f32 v111, v111
    v_exp_f32 v112, v112
    v_exp_f32 v113, v113
    v_smfmac_f32_32x32x32_bf16 v[144:159], v[36:39], v[104:111], v164
    v_exp_f32 v114, v114
    v_exp_f32 v115, v115
    v_exp_f32 v116, v116
    v_mfma_f32_32x32x16_bf16 v[96:111], v[8:11], v[160:163], 0
    v_exp_f32 v117, v117
    v_exp_f32 v118, v118
    v_exp_f32 v119, v119
    v_exp_f32 v120, v120
    v_exp_f32 v121, v121
    v_exp_f32 v122, v122
    v_exp_f32 v123, v123
    v_exp_f32 v124, v124
    v_exp_f32 v125, v125
    v_exp_f32 v126, v126
    v_smfmac_f32_32x32x32_bf16 v[144:159], v[40:43], v[112:119], v164
    v_exp_f32 v127, v127
    v_exp_f32 v96, v96
    v_exp_f32 v97, v97
    v_smfmac_f32_32x32x32_bf16 v[144:159], v[44:47], v[120:127], v164
    v_exp_f32 v98, v98
    v_exp_f32 v99, v99
    v_exp_f32 v100, v100
    v_mfma_f32_32x32x16_bf16 v[112:127], v[12:15], v[160:163], 0
    v_exp_f32 v101, v101
    v_exp_f32 v102, v102
    v_exp_f32 v103, v103
    v_exp_f32 v104, v104
    v_exp_f32 v105, v105
    v_exp_f32 v106, v106
    v_exp_f32 v107, v107
    v_exp_f32 v108, v108
    v_exp_f32 v109, v109
    v_exp_f32 v110, v110
    v_smfmac_f32_32x32x32_bf16 v[144:159], v[48:51], v[96:103], v164
    v_exp_f32 v111, v111
    v_exp_f32 v112, v112
    v_exp_f32 v113, v113
    v_smfmac_f32_32x32x32_bf16 v[144:159], v[52:55], v[104:111], v164
    v_exp_f32 v114, v114
    v_exp_f32 v115, v115
    v_exp_f32 v116, v116
    v_mfma_f32_32x32x16_bf16 v[96:111], v[16:19], v[160:163], 0
    v_exp_f32 v117, v117
    v_exp_f32 v118, v118
    v_exp_f32 v119, v119
    v_exp_f32 v120, v120
    v_exp_f32 v121, v121
    v_exp_f32 v122, v122
    v_exp_f32 v123, v123
    v_exp_f32 v124, v124
    v_exp_f32 v125, v125
    v_exp_f32 v126, v126
    v_smfmac_f32_32x32x32_bf16 v[144:159], v[56:59], v[112:119], v164
    v_exp_f32 v127, v127
    v_exp_f32 v96, v96
    v_exp_f32 v97, v97
    v_smfmac_f32_32x32x32_bf16 v[144:159], v[60:63], v[120:127], v164
    v_exp_f32 v98, v98
    v_exp_f32 v99, v99
    v_exp_f32 v100, v100
    v_mfma_f32_32x32x16_bf16 v[112:127], v[20:23], v[160:163], 0
    v_exp_f32 v101, v101
    v_exp_f32 v102, v102
    v_exp_f32 v103, v103
    v_exp_f32 v104, v104
    v_exp_f32 v105, v105
    v_exp_f32 v106, v106
    v_exp_f32 v107, v107
    v_exp_f32 v108, v108
    v_exp_f32 v109, v109
    v_exp_f32 v110, v110
    v_smfmac_f32_32x32x32_bf16 v[144:159], v[64:67], v[96:103], v164
    v_exp_f32 v111, v111
    v_exp_f32 v112, v112
    v_exp_f32 v113, v113
    v_smfmac_f32_32x32x32_bf16 v[144:159], v[68:71], v[104:111], v164
    v_exp_f32 v114, v114
    v_exp_f32 v115, v115
    v_exp_f32 v116, v116
    v_mfma_f32_32x32x16_bf16 v[96:111], v[24:27], v[160:163], 0
    v_exp_f32 v117, v117
    v_exp_f32 v118, v118
    v_exp_f32 v119, v119
    v_exp_f32 v120, v120
    v_exp_f32 v121, v121
    v_exp_f32 v122, v122
    v_exp_f32 v123, v123
    v_exp_f32 v124, v124
    v_exp_f32 v125, v125
    v_exp_f32 v126, v126
    v_smfmac_f32_32x32x32_bf16 v[144:159], v[72:75], v[112:119], v164
    v_exp_f32 v127, v127
    v_exp_f32 v96, v96
    v_exp_f32 v97, v97
    v_smfmac_f32_32x32x32_bf16 v[144:159], v[76:79], v[120:127], v164
    v_exp_f32 v98, v98
    v_exp_f32 v99, v99
    v_exp_f32 v100, v100
    v_mfma_f32_32x32x16_bf16 v[112:127], v[28:31], v[160:163], 0
    v_exp_f32 v101, v101
    v_exp_f32 v102, v102
    v_exp_f32 v103, v103
    v_exp_f32 v104, v104
    v_exp_f32 v105, v105
    v_exp_f32 v106, v106
    v_exp_f32 v107, v107
    v_exp_f32 v108, v108
    v_exp_f32 v109, v109
    v_exp_f32 v110, v110
    v_smfmac_f32_32x32x32_bf16 v[144:159], v[80:83], v[96:103], v164
    v_exp_f32 v111, v111
    v_exp_f32 v112, v112
    v_exp_f32 v113, v113
    v_smfmac_f32_32x32x32_bf16 v[144:159], v[84:87], v[104:111], v164
    v_exp_f32 v114, v114
    v_exp_f32 v115, v115
    v_exp_f32 v116, v116
    v_exp_f32 v117, v117
    v_exp_f32 v118, v118
    v_exp_f32 v119, v119
    v_exp_f32 v120, v120
    v_exp_f32 v121, v121
    v_exp_f32 v122, v122
    v_exp_f32 v123, v123
    v_exp_f32 v124, v124
    v_exp_f32 v125, v125
    v_exp_f32 v126, v126
    v_smfmac_f32_32x32x32_bf16 v[144:159], v[88:91], v[112:119], v164
    v_exp_f32 v127, v127
    s_nop 1
    v_smfmac_f32_32x32x32_bf16 v[144:159], v[92:95], v[120:127], v164
    s_setprio 3
    s_nop 10
    ds_write_b128 v167, v[144:147] offset:2048
    ds_write_b128 v167, v[148:151] offset:3072
    ds_write_b32 v167, v152 offset:0
    s_mov_b64 exec, 1
    ds_inc_u32 v167, v164 offset:8
    s_mov_b64 exec, -1
    ds_read_b32 v105, v165 offset:12
    ds_read_b128 v[96:99], v165 offset:4096
    ds_read_b128 v[100:103], v165 offset:5120
    ds_read_b32 v104, v165 offset:4
    s_waitcnt lgkmcnt(0)
    v_readfirstlane_b32 s66, v105
    s_nop 0
    s_cmp_ge_u32 s66, 4
    s_cbranch_scc0 L_sumwait_28
L_sumok_27:
    v_pk_add_f32 v[128:129], v[128:129], v[96:97]
    v_pk_add_f32 v[130:131], v[130:131], v[98:99]
    v_pk_add_f32 v[132:133], v[132:133], v[100:101]
    v_pk_add_f32 v[134:135], v[134:135], v[102:103]
    v_add_f32 v136, v136, v104
    v_rcp_f32 v136, v136
    s_add_u32 s66, s75, s69
    v_pk_mul_f32 v[128:129], v[128:129], v[136:137] op_sel_hi:[1,0]
    v_pk_mul_f32 v[130:131], v[130:131], v[136:137] op_sel_hi:[1,0]
    v_pk_mul_f32 v[132:133], v[132:133], v[136:137] op_sel_hi:[1,0]
    v_pk_mul_f32 v[134:135], v[134:135], v[136:137] op_sel_hi:[1,0]
    v_cvt_pk_bf16_f32 v140, v128, v129
    v_cvt_pk_bf16_f32 v141, v130, v131
    v_cvt_pk_bf16_f32 v142, v132, v133
    v_cvt_pk_bf16_f32 v143, v134, v135
    buffer_store_dwordx4 v[140:143], v166, s[48:51], s66 offen sc1
    s_lshl_b32 s56, s4, 12
    s_lshl_b32 s57, s5, 9
    s_add_u32 s56, s56, s57
    s_lshr_b32 s57, s75, 3
    s_add_u32 s56, s56, s57
    s_add_u32 s56, s56, 8126464
    v_mov_b32 v96, s6
    v_mbcnt_lo_u32_b32 v97, -1, 0
    v_lshlrev_b32 v97, 2, v97
    s_mov_b32 exec_hi, 0
    s_waitcnt vmcnt(0)
    buffer_store_dword v96, v97, s[48:51], s56 offen sc1
    s_mov_b64 exec, -1
    s_branch L_A_end
L_attn_y:
    s_waitcnt vmcnt(23)
    v_mfma_f32_32x32x16_bf16 v[96:111], v[0:3], v[160:163], 0
    s_setprio 2
    s_nop 10
    v_exp_f32 v96, v96
    v_exp_f32 v97, v97
    v_exp_f32 v98, v98
    v_exp_f32 v99, v99
    v_exp_f32 v100, v100
    s_waitcnt vmcnt(20)
    v_mfma_f32_32x32x16_bf16 v[112:127], v[4:7], v[160:163], 0
    v_exp_f32 v101, v101
    v_exp_f32 v102, v102
    v_exp_f32 v103, v103
    v_exp_f32 v104, v104
    v_exp_f32 v105, v105
    v_exp_f32 v106, v106
    v_exp_f32 v107, v107
    v_exp_f32 v108, v108
    v_exp_f32 v109, v109
    v_exp_f32 v110, v110
    v_smfmac_f32_32x32x32_bf16 v[128:143], v[32:35], v[96:103], v164
    v_exp_f32 v111, v111
    v_exp_f32 v112, v112
    v_exp_f32 v113, v113
    v_smfmac_f32_32x32x32_bf16 v[128:143], v[36:39], v[104:111], v164
    v_exp_f32 v114, v114
    v_exp_f32 v115, v115
    v_exp_f32 v116, v116
    s_waitcnt vmcnt(17)
    v_mfma_f32_32x32x16_bf16 v[96:111], v[8:11], v[160:163], 0
    v_exp_f32 v117, v117
    v_exp_f32 v118, v118
    v_exp_f32 v119, v119
    v_exp_f32 v120, v120
    v_exp_f32 v121, v121
    v_exp_f32 v122, v122
    v_exp_f32 v123, v123
    v_exp_f32 v124, v124
    v_exp_f32 v125, v125
    v_exp_f32 v126, v126
    v_smfmac_f32_32x32x32_bf16 v[128:143], v[40:43], v[112:119], v164
    v_exp_f32 v127, v127
    v_exp_f32 v96, v96
    v_exp_f32 v97, v97
    v_smfmac_f32_32x32x32_bf16 v[128:143], v[44:47], v[120:127], v164
    v_exp_f32 v98, v98
    v_exp_f32 v99, v99
    v_exp_f32 v100, v100
    s_waitcnt vmcnt(14)
    v_mfma_f32_32x32x16_bf16 v[112:127], v[12:15], v[160:163], 0
    v_exp_f32 v101, v101
    v_exp_f32 v102, v102
    v_exp_f32 v103, v103
    v_exp_f32 v104, v104
    v_exp_f32 v105, v105
    v_exp_f32 v106, v106
    v_exp_f32 v107, v107
    v_exp_f32 v108, v108
    v_exp_f32 v109, v109
    v_exp_f32 v110, v110
    v_smfmac_f32_32x32x32_bf16 v[128:143], v[48:51], v[96:103], v164
    v_exp_f32 v111, v111
    v_exp_f32 v112, v112
    v_exp_f32 v113, v113
    v_smfmac_f32_32x32x32_bf16 v[128:143], v[52:55], v[104:111], v164
    v_exp_f32 v114, v114
    v_exp_f32 v115, v115
    v_exp_f32 v116, v116
    s_waitcnt vmcnt(11)
    v_mfma_f32_32x32x16_bf16 v[96:111], v[16:19], v[160:163], 0
    v_exp_f32 v117, v117
    v_exp_f32 v118, v118
    v_exp_f32 v119, v119
    v_exp_f32 v120, v120
    v_exp_f32 v121, v121
    v_exp_f32 v122, v122
    v_exp_f32 v123, v123
    v_exp_f32 v124, v124
    v_exp_f32 v125, v125
    v_exp_f32 v126, v126
    v_smfmac_f32_32x32x32_bf16 v[128:143], v[56:59], v[112:119], v164
    v_exp_f32 v127, v127
    v_exp_f32 v96, v96
    v_exp_f32 v97, v97
    v_smfmac_f32_32x32x32_bf16 v[128:143], v[60:63], v[120:127], v164
    v_exp_f32 v98, v98
    v_exp_f32 v99, v99
    v_exp_f32 v100, v100
    s_waitcnt vmcnt(8)
    v_mfma_f32_32x32x16_bf16 v[112:127], v[20:23], v[160:163], 0
    v_exp_f32 v101, v101
    v_exp_f32 v102, v102
    v_exp_f32 v103, v103
    v_exp_f32 v104, v104
    v_exp_f32 v105, v105
    v_exp_f32 v106, v106
    v_exp_f32 v107, v107
    v_exp_f32 v108, v108
    v_exp_f32 v109, v109
    v_exp_f32 v110, v110
    v_smfmac_f32_32x32x32_bf16 v[128:143], v[64:67], v[96:103], v164
    v_exp_f32 v111, v111
    v_exp_f32 v112, v112
    v_exp_f32 v113, v113
    v_smfmac_f32_32x32x32_bf16 v[128:143], v[68:71], v[104:111], v164
    v_exp_f32 v114, v114
    v_exp_f32 v115, v115
    v_exp_f32 v116, v116
    s_waitcnt vmcnt(5)
    v_mfma_f32_32x32x16_bf16 v[96:111], v[24:27], v[160:163], 0
    v_add_u32 v167, s41, v166
    v_exp_f32 v117, v117
    v_exp_f32 v118, v118
    v_exp_f32 v119, v119
    v_exp_f32 v120, v120
    v_exp_f32 v121, v121
    v_exp_f32 v122, v122
    v_exp_f32 v123, v123
    v_exp_f32 v124, v124
    v_exp_f32 v125, v125
    v_exp_f32 v126, v126
    v_smfmac_f32_32x32x32_bf16 v[128:143], v[72:75], v[112:119], v164
    v_exp_f32 v127, v127
    v_exp_f32 v96, v96
    v_exp_f32 v97, v97
    v_smfmac_f32_32x32x32_bf16 v[128:143], v[76:79], v[120:127], v164
    v_exp_f32 v98, v98
    v_exp_f32 v99, v99
    v_exp_f32 v100, v100
    s_waitcnt vmcnt(2)
    v_mfma_f32_32x32x16_bf16 v[112:127], v[28:31], v[160:163], 0
    ds_read_b128 v[160:163], v167 offset:1024
    v_exp_f32 v101, v101
    v_exp_f32 v102, v102
    v_exp_f32 v103, v103
    v_exp_f32 v104, v104
    v_exp_f32 v105, v105
    v_exp_f32 v106, v106
    v_exp_f32 v107, v107
    v_exp_f32 v108, v108
    v_exp_f32 v109, v109
    v_exp_f32 v110, v110
    v_smfmac_f32_32x32x32_bf16 v[128:143], v[80:83], v[96:103], v164
    v_exp_f32 v111, v111
    v_exp_f32 v112, v112
    v_exp_f32 v113, v113
    v_smfmac_f32_32x32x32_bf16 v[128:143], v[84:87], v[104:111], v164
    v_exp_f32 v114, v114
    v_exp_f32 v115, v115
    v_exp_f32 v116, v116
    s_waitcnt lgkmcnt(0)
    v_mfma_f32_32x32x16_bf16 v[96:111], v[0:3], v[160:163], 0
    v_exp_f32 v117, v117
    v_exp_f32 v118, v118
    v_exp_f32 v119, v119
    v_exp_f32 v120, v120
    v_exp_f32 v121, v121
    v_exp_f32 v122, v122
    v_exp_f32 v123, v123
    v_exp_f32 v124, v124
    v_exp_f32 v125, v125
    v_exp_f32 v126, v126
    s_waitcnt vmcnt(1)
    v_smfmac_f32_32x32x32_bf16 v[128:143], v[88:91], v[112:119], v164
    v_exp_f32 v127, v127
    v_exp_f32 v96, v96
    v_exp_f32 v97, v97
    s_waitcnt vmcnt(0)
    v_smfmac_f32_32x32x32_bf16 v[128:143], v[92:95], v[120:127], v164
    v_exp_f32 v98, v98
    v_exp_f32 v99, v99
    v_exp_f32 v100, v100
    v_mfma_f32_32x32x16_bf16 v[112:127], v[4:7], v[160:163], 0
    v_exp_f32 v101, v101
    v_exp_f32 v102, v102
    v_exp_f32 v103, v103
    v_exp_f32 v104, v104
    v_exp_f32 v105, v105
    v_exp_f32 v106, v106
    v_exp_f32 v107, v107
    v_exp_f32 v108, v108
    ds_write_b128 v165, v[128:131] offset:4096
    v_exp_f32 v109, v109
    ds_write_b128 v165, v[132:135] offset:5120
    v_exp_f32 v110, v110
    ds_write_b32 v165, v136 offset:4
    s_mov_b64 exec, 1
    ds_inc_u32 v165, v164 offset:12
    s_mov_b64 exec, -1
    v_smfmac_f32_32x32x32_bf16 v[144:159], v[32:35], v[96:103], v164
    v_exp_f32 v111, v111
    v_exp_f32 v112, v112
    v_exp_f32 v113, v113
    v_smfmac_f32_32x32x32_bf16 v[144:159], v[36:39], v[104:111], v164
    v_exp_f32 v114, v114
    v_exp_f32 v115, v115
    v_exp_f32 v116, v116
    v_mfma_f32_32x32x16_bf16 v[96:111], v[8:11], v[160:163], 0
    v_exp_f32 v117, v117
    v_exp_f32 v118, v118
    v_exp_f32 v119, v119
    v_exp_f32 v120, v120
    v_exp_f32 v121, v121
    v_exp_f32 v122, v122
    v_exp_f32 v123, v123
    v_exp_f32 v124, v124
    v_exp_f32 v125, v125
    v_exp_f32 v126, v126
    v_smfmac_f32_32x32x32_bf16 v[144:159], v[40:43], v[112:119], v164
    v_exp_f32 v127, v127
    v_exp_f32 v96, v96
    v_exp_f32 v97, v97
    v_smfmac_f32_32x32x32_bf16 v[144:159], v[44:47], v[120:127], v164
    v_exp_f32 v98, v98
    v_exp_f32 v99, v99
    v_exp_f32 v100, v100
    v_mfma_f32_32x32x16_bf16 v[112:127], v[12:15], v[160:163], 0
    v_exp_f32 v101, v101
    v_exp_f32 v102, v102
    v_exp_f32 v103, v103
    v_exp_f32 v104, v104
    v_exp_f32 v105, v105
    v_exp_f32 v106, v106
    v_exp_f32 v107, v107
    v_exp_f32 v108, v108
    v_exp_f32 v109, v109
    v_exp_f32 v110, v110
    v_smfmac_f32_32x32x32_bf16 v[144:159], v[48:51], v[96:103], v164
    v_exp_f32 v111, v111
    v_exp_f32 v112, v112
    v_exp_f32 v113, v113
    v_smfmac_f32_32x32x32_bf16 v[144:159], v[52:55], v[104:111], v164
    v_exp_f32 v114, v114
    v_exp_f32 v115, v115
    v_exp_f32 v116, v116
    v_mfma_f32_32x32x16_bf16 v[96:111], v[16:19], v[160:163], 0
    v_exp_f32 v117, v117
    v_exp_f32 v118, v118
    v_exp_f32 v119, v119
    v_exp_f32 v120, v120
    v_exp_f32 v121, v121
    v_exp_f32 v122, v122
    v_exp_f32 v123, v123
    v_exp_f32 v124, v124
    v_exp_f32 v125, v125
    v_exp_f32 v126, v126
    v_smfmac_f32_32x32x32_bf16 v[144:159], v[56:59], v[112:119], v164
    v_exp_f32 v127, v127
    v_exp_f32 v96, v96
    v_exp_f32 v97, v97
    v_smfmac_f32_32x32x32_bf16 v[144:159], v[60:63], v[120:127], v164
    v_exp_f32 v98, v98
    v_exp_f32 v99, v99
    v_exp_f32 v100, v100
    v_mfma_f32_32x32x16_bf16 v[112:127], v[20:23], v[160:163], 0
    v_exp_f32 v101, v101
    v_exp_f32 v102, v102
    v_exp_f32 v103, v103
    v_exp_f32 v104, v104
    v_exp_f32 v105, v105
    v_exp_f32 v106, v106
    v_exp_f32 v107, v107
    v_exp_f32 v108, v108
    v_exp_f32 v109, v109
    v_exp_f32 v110, v110
    v_smfmac_f32_32x32x32_bf16 v[144:159], v[64:67], v[96:103], v164
    v_exp_f32 v111, v111
    v_exp_f32 v112, v112
    v_exp_f32 v113, v113
    v_smfmac_f32_32x32x32_bf16 v[144:159], v[68:71], v[104:111], v164
    v_exp_f32 v114, v114
    v_exp_f32 v115, v115
    v_exp_f32 v116, v116
    v_mfma_f32_32x32x16_bf16 v[96:111], v[24:27], v[160:163], 0
    v_add_u32 v165, s42, v166
    v_exp_f32 v117, v117
    v_exp_f32 v118, v118
    v_exp_f32 v119, v119
    v_exp_f32 v120, v120
    v_exp_f32 v121, v121
    v_exp_f32 v122, v122
    v_exp_f32 v123, v123
    v_exp_f32 v124, v124
    v_exp_f32 v125, v125
    v_exp_f32 v126, v126
    v_smfmac_f32_32x32x32_bf16 v[144:159], v[72:75], v[112:119], v164
    v_exp_f32 v127, v127
    v_exp_f32 v96, v96
    v_exp_f32 v97, v97
    v_smfmac_f32_32x32x32_bf16 v[144:159], v[76:79], v[120:127], v164
    v_exp_f32 v98, v98
    v_exp_f32 v99, v99
    v_exp_f32 v100, v100
    v_mfma_f32_32x32x16_bf16 v[112:127], v[28:31], v[160:163], 0
    ds_read_b128 v[160:163], v165 offset:1024
    v_exp_f32 v101, v101
    ds_read_b32 v137, v165 offset:12
    v_exp_f32 v102, v102
    ds_read_b128 v[128:131], v165 offset:4096
    v_exp_f32 v103, v103
    ds_read_b128 v[132:135], v165 offset:5120
    v_exp_f32 v104, v104
    ds_read_b32 v136, v165 offset:4
    v_exp_f32 v105, v105
    v_exp_f32 v106, v106
    v_exp_f32 v107, v107
    v_exp_f32 v108, v108
    v_exp_f32 v109, v109
    v_exp_f32 v110, v110
    v_smfmac_f32_32x32x32_bf16 v[144:159], v[80:83], v[96:103], v164
    v_exp_f32 v111, v111
    v_exp_f32 v112, v112
    v_exp_f32 v113, v113
    v_smfmac_f32_32x32x32_bf16 v[144:159], v[84:87], v[104:111], v164
    v_exp_f32 v114, v114
    v_exp_f32 v115, v115
    v_exp_f32 v116, v116
    s_waitcnt lgkmcnt(4)
    v_mfma_f32_32x32x16_bf16 v[96:111], v[0:3], v[160:163], 0
    v_exp_f32 v117, v117
    v_exp_f32 v118, v118
    v_exp_f32 v119, v119
    v_exp_f32 v120, v120
    v_exp_f32 v121, v121
    v_exp_f32 v122, v122
    v_exp_f32 v123, v123
    v_exp_f32 v124, v124
    v_exp_f32 v125, v125
    v_exp_f32 v126, v126
    v_smfmac_f32_32x32x32_bf16 v[144:159], v[88:91], v[112:119], v164
    v_exp_f32 v127, v127
    v_exp_f32 v96, v96
    v_exp_f32 v97, v97
    v_smfmac_f32_32x32x32_bf16 v[144:159], v[92:95], v[120:127], v164
    v_exp_f32 v98, v98
    v_exp_f32 v99, v99
    v_exp_f32 v100, v100
    v_mfma_f32_32x32x16_bf16 v[112:127], v[4:7], v[160:163], 0
    v_exp_f32 v101, v101
    v_exp_f32 v102, v102
    v_exp_f32 v103, v103
    v_exp_f32 v104, v104
    v_exp_f32 v105, v105
    v_exp_f32 v106, v106
    v_exp_f32 v107, v107
    v_exp_f32 v108, v108
    ds_write_b128 v167, v[144:147] offset:4096
    v_exp_f32 v109, v109
    ds_write_b128 v167, v[148:151] offset:5120
    v_exp_f32 v110, v110
    ds_write_b32 v167, v152 offset:4
    s_mov_b64 exec, 1
    ds_inc_u32 v167, v164 offset:12
    s_mov_b64 exec, -1
    s_waitcnt lgkmcnt(4)
    v_readfirstlane_b32 s66, v137
    s_nop 0
    s_cmp_ge_u32 s66, 1
    s_cbranch_scc0 L_sumwait_30
L_sumok_29:
    v_smfmac_f32_32x32x32_bf16 v[128:143], v[32:35], v[96:103], v164
    v_exp_f32 v111, v111
    v_exp_f32 v112, v112
    v_exp_f32 v113, v113
    v_smfmac_f32_32x32x32_bf16 v[128:143], v[36:39], v[104:111], v164
    v_exp_f32 v114, v114
    v_exp_f32 v115, v115
    v_exp_f32 v116, v116
    v_mfma_f32_32x32x16_bf16 v[96:111], v[8:11], v[160:163], 0
    v_exp_f32 v117, v117
    v_exp_f32 v118, v118
    v_exp_f32 v119, v119
    v_exp_f32 v120, v120
    v_exp_f32 v121, v121
    v_exp_f32 v122, v122
    v_exp_f32 v123, v123
    v_exp_f32 v124, v124
    v_exp_f32 v125, v125
    v_exp_f32 v126, v126
    v_smfmac_f32_32x32x32_bf16 v[128:143], v[40:43], v[112:119], v164
    v_exp_f32 v127, v127
    v_exp_f32 v96, v96
    v_exp_f32 v97, v97
    v_smfmac_f32_32x32x32_bf16 v[128:143], v[44:47], v[120:127], v164
    v_exp_f32 v98, v98
    v_exp_f32 v99, v99
    v_exp_f32 v100, v100
    v_mfma_f32_32x32x16_bf16 v[112:127], v[12:15], v[160:163], 0
    v_exp_f32 v101, v101
    v_exp_f32 v102, v102
    v_exp_f32 v103, v103
    v_exp_f32 v104, v104
    v_exp_f32 v105, v105
    v_exp_f32 v106, v106
    v_exp_f32 v107, v107
    v_exp_f32 v108, v108
    v_exp_f32 v109, v109
    v_exp_f32 v110, v110
    v_smfmac_f32_32x32x32_bf16 v[128:143], v[48:51], v[96:103], v164
    v_exp_f32 v111, v111
    v_exp_f32 v112, v112
    v_exp_f32 v113, v113
    v_smfmac_f32_32x32x32_bf16 v[128:143], v[52:55], v[104:111], v164
    v_exp_f32 v114, v114
    v_exp_f32 v115, v115
    v_exp_f32 v116, v116
    v_mfma_f32_32x32x16_bf16 v[96:111], v[16:19], v[160:163], 0
    v_exp_f32 v117, v117
    v_exp_f32 v118, v118
    v_exp_f32 v119, v119
    v_exp_f32 v120, v120
    v_exp_f32 v121, v121
    v_exp_f32 v122, v122
    v_exp_f32 v123, v123
    v_exp_f32 v124, v124
    v_exp_f32 v125, v125
    v_exp_f32 v126, v126
    v_smfmac_f32_32x32x32_bf16 v[128:143], v[56:59], v[112:119], v164
    v_exp_f32 v127, v127
    v_exp_f32 v96, v96
    v_exp_f32 v97, v97
    v_smfmac_f32_32x32x32_bf16 v[128:143], v[60:63], v[120:127], v164
    v_exp_f32 v98, v98
    v_exp_f32 v99, v99
    v_exp_f32 v100, v100
    v_mfma_f32_32x32x16_bf16 v[112:127], v[20:23], v[160:163], 0
    v_exp_f32 v101, v101
    v_exp_f32 v102, v102
    v_exp_f32 v103, v103
    v_exp_f32 v104, v104
    v_exp_f32 v105, v105
    v_exp_f32 v106, v106
    v_exp_f32 v107, v107
    v_exp_f32 v108, v108
    v_exp_f32 v109, v109
    v_exp_f32 v110, v110
    v_smfmac_f32_32x32x32_bf16 v[128:143], v[64:67], v[96:103], v164
    v_exp_f32 v111, v111
    v_exp_f32 v112, v112
    v_exp_f32 v113, v113
    v_smfmac_f32_32x32x32_bf16 v[128:143], v[68:71], v[104:111], v164
    v_exp_f32 v114, v114
    v_exp_f32 v115, v115
    v_exp_f32 v116, v116
    v_mfma_f32_32x32x16_bf16 v[96:111], v[24:27], v[160:163], 0
    v_add_u32 v167, s43, v166
    v_exp_f32 v117, v117
    v_exp_f32 v118, v118
    v_exp_f32 v119, v119
    v_exp_f32 v120, v120
    v_exp_f32 v121, v121
    v_exp_f32 v122, v122
    v_exp_f32 v123, v123
    v_exp_f32 v124, v124
    v_exp_f32 v125, v125
    v_exp_f32 v126, v126
    v_smfmac_f32_32x32x32_bf16 v[128:143], v[72:75], v[112:119], v164
    v_exp_f32 v127, v127
    v_exp_f32 v96, v96
    v_exp_f32 v97, v97
    v_smfmac_f32_32x32x32_bf16 v[128:143], v[76:79], v[120:127], v164
    v_exp_f32 v98, v98
    v_exp_f32 v99, v99
    v_exp_f32 v100, v100
    v_mfma_f32_32x32x16_bf16 v[112:127], v[28:31], v[160:163], 0
    ds_read_b128 v[160:163], v167 offset:1024
    v_exp_f32 v101, v101
    ds_read_b32 v153, v167 offset:12
    v_exp_f32 v102, v102
    ds_read_b128 v[144:147], v167 offset:4096
    v_exp_f32 v103, v103
    ds_read_b128 v[148:151], v167 offset:5120
    v_exp_f32 v104, v104
    ds_read_b32 v152, v167 offset:4
    v_exp_f32 v105, v105
    v_exp_f32 v106, v106
    v_exp_f32 v107, v107
    v_exp_f32 v108, v108
    v_exp_f32 v109, v109
    v_exp_f32 v110, v110
    v_smfmac_f32_32x32x32_bf16 v[128:143], v[80:83], v[96:103], v164
    v_exp_f32 v111, v111
    v_exp_f32 v112, v112
    v_exp_f32 v113, v113
    v_smfmac_f32_32x32x32_bf16 v[128:143], v[84:87], v[104:111], v164
    v_exp_f32 v114, v114
    v_exp_f32 v115, v115
    v_exp_f32 v116, v116
    s_waitcnt lgkmcnt(4)
    v_mfma_f32_32x32x16_bf16 v[96:111], v[0:3], v[160:163], 0
    v_exp_f32 v117, v117
    v_exp_f32 v118, v118
    v_exp_f32 v119, v119
    v_exp_f32 v120, v120
    v_exp_f32 v121, v121
    v_exp_f32 v122, v122
    v_exp_f32 v123, v123
    v_exp_f32 v124, v124
    v_exp_f32 v125, v125
    v_exp_f32 v126, v126
    v_smfmac_f32_32x32x32_bf16 v[128:143], v[88:91], v[112:119], v164
    v_exp_f32 v127, v127
    s_setprio 1
    v_exp_f32 v96, v96
    v_exp_f32 v97, v97
    v_smfmac_f32_32x32x32_bf16 v[128:143], v[92:95], v[120:127], v164
    v_exp_f32 v98, v98
    v_exp_f32 v99, v99
    v_exp_f32 v100, v100
    v_mfma_f32_32x32x16_bf16 v[112:127], v[4:7], v[160:163], 0
    v_exp_f32 v101, v101
    v_exp_f32 v102, v102
    v_exp_f32 v103, v103
    v_exp_f32 v104, v104
    v_exp_f32 v105, v105
    v_exp_f32 v106, v106
    v_exp_f32 v107, v107
    v_exp_f32 v108, v108
    ds_write_b128 v165, v[128:131] offset:4096
    v_exp_f32 v109, v109
    ds_write_b128 v165, v[132:135] offset:5120
    v_exp_f32 v110, v110
    ds_write_b32 v165, v136 offset:4
    s_mov_b64 exec, 1
    ds_inc_u32 v165, v164 offset:12
    s_mov_b64 exec, -1
    s_waitcnt lgkmcnt(4)
    v_readfirstlane_b32 s66, v153
    s_nop 0
    s_cmp_ge_u32 s66, 1
    s_cbranch_scc0 L_sumwait_32
L_sumok_31:
    v_smfmac_f32_32x32x32_bf16 v[144:159], v[32:35], v[96:103], v164
    v_exp_f32 v111, v111
    v_exp_f32 v112, v112
    v_exp_f32 v113, v113
    v_smfmac_f32_32x32x32_bf16 v[144:159], v[36:39], v[104:111], v164
    v_exp_f32 v114, v114
    v_exp_f32 v115, v115
    v_exp_f32 v116, v116
    v_mfma_f32_32x32x16_bf16 v[96:111], v[8:11], v[160:163], 0
    v_exp_f32 v117, v117
    v_exp_f32 v118, v118
    v_exp_f32 v119, v119
    v_exp_f32 v120, v120
    v_exp_f32 v121, v121
    v_exp_f32 v122, v122
    v_exp_f32 v123, v123
    v_exp_f32 v124, v124
    v_exp_f32 v125, v125
    v_exp_f32 v126, v126
    v_smfmac_f32_32x32x32_bf16 v[144:159], v[40:43], v[112:119], v164
    v_exp_f32 v127, v127
    v_exp_f32 v96, v96
    v_exp_f32 v97, v97
    v_smfmac_f32_32x32x32_bf16 v[144:159], v[44:47], v[120:127], v164
    v_exp_f32 v98, v98
    v_exp_f32 v99, v99
    v_exp_f32 v100, v100
    v_mfma_f32_32x32x16_bf16 v[112:127], v[12:15], v[160:163], 0
    v_exp_f32 v101, v101
    v_exp_f32 v102, v102
    v_exp_f32 v103, v103
    v_exp_f32 v104, v104
    v_exp_f32 v105, v105
    v_exp_f32 v106, v106
    v_exp_f32 v107, v107
    v_exp_f32 v108, v108
    v_exp_f32 v109, v109
    v_exp_f32 v110, v110
    v_smfmac_f32_32x32x32_bf16 v[144:159], v[48:51], v[96:103], v164
    v_exp_f32 v111, v111
    v_exp_f32 v112, v112
    v_exp_f32 v113, v113
    v_smfmac_f32_32x32x32_bf16 v[144:159], v[52:55], v[104:111], v164
    v_exp_f32 v114, v114
    v_exp_f32 v115, v115
    v_exp_f32 v116, v116
    v_mfma_f32_32x32x16_bf16 v[96:111], v[16:19], v[160:163], 0
    v_exp_f32 v117, v117
    v_exp_f32 v118, v118
    v_exp_f32 v119, v119
    v_exp_f32 v120, v120
    v_exp_f32 v121, v121
    v_exp_f32 v122, v122
    v_exp_f32 v123, v123
    v_exp_f32 v124, v124
    v_exp_f32 v125, v125
    v_exp_f32 v126, v126
    v_smfmac_f32_32x32x32_bf16 v[144:159], v[56:59], v[112:119], v164
    v_exp_f32 v127, v127
    v_exp_f32 v96, v96
    v_exp_f32 v97, v97
    v_smfmac_f32_32x32x32_bf16 v[144:159], v[60:63], v[120:127], v164
    v_exp_f32 v98, v98
    v_exp_f32 v99, v99
    v_exp_f32 v100, v100
    v_mfma_f32_32x32x16_bf16 v[112:127], v[20:23], v[160:163], 0
    v_exp_f32 v101, v101
    v_exp_f32 v102, v102
    v_exp_f32 v103, v103
    v_exp_f32 v104, v104
    v_exp_f32 v105, v105
    v_exp_f32 v106, v106
    v_exp_f32 v107, v107
    v_exp_f32 v108, v108
    v_exp_f32 v109, v109
    v_exp_f32 v110, v110
    v_smfmac_f32_32x32x32_bf16 v[144:159], v[64:67], v[96:103], v164
    v_exp_f32 v111, v111
    v_exp_f32 v112, v112
    v_exp_f32 v113, v113
    v_smfmac_f32_32x32x32_bf16 v[144:159], v[68:71], v[104:111], v164
    v_exp_f32 v114, v114
    v_exp_f32 v115, v115
    v_exp_f32 v116, v116
    v_mfma_f32_32x32x16_bf16 v[96:111], v[24:27], v[160:163], 0
    v_add_u32 v165, s44, v166
    v_exp_f32 v117, v117
    v_exp_f32 v118, v118
    v_exp_f32 v119, v119
    v_exp_f32 v120, v120
    v_exp_f32 v121, v121
    v_exp_f32 v122, v122
    v_exp_f32 v123, v123
    v_exp_f32 v124, v124
    v_exp_f32 v125, v125
    v_exp_f32 v126, v126
    v_smfmac_f32_32x32x32_bf16 v[144:159], v[72:75], v[112:119], v164
    v_exp_f32 v127, v127
    v_exp_f32 v96, v96
    v_exp_f32 v97, v97
    v_smfmac_f32_32x32x32_bf16 v[144:159], v[76:79], v[120:127], v164
    v_exp_f32 v98, v98
    v_exp_f32 v99, v99
    v_exp_f32 v100, v100
    v_mfma_f32_32x32x16_bf16 v[112:127], v[28:31], v[160:163], 0
    ds_read_b128 v[160:163], v165 offset:1024
    v_exp_f32 v101, v101
    ds_read_b32 v137, v165 offset:12
    v_exp_f32 v102, v102
    ds_read_b128 v[128:131], v165 offset:4096
    v_exp_f32 v103, v103
    ds_read_b128 v[132:135], v165 offset:5120
    v_exp_f32 v104, v104
    ds_read_b32 v136, v165 offset:4
    v_exp_f32 v105, v105
    v_exp_f32 v106, v106
    v_exp_f32 v107, v107
    v_exp_f32 v108, v108
    v_exp_f32 v109, v109
    v_exp_f32 v110, v110
    v_smfmac_f32_32x32x32_bf16 v[144:159], v[80:83], v[96:103], v164
    v_exp_f32 v111, v111
    v_exp_f32 v112, v112
    v_exp_f32 v113, v113
    v_smfmac_f32_32x32x32_bf16 v[144:159], v[84:87], v[104:111], v164
    v_exp_f32 v114, v114
    v_exp_f32 v115, v115
    v_exp_f32 v116, v116
    s_waitcnt lgkmcnt(4)
    v_mfma_f32_32x32x16_bf16 v[96:111], v[0:3], v[160:163], 0
    v_exp_f32 v117, v117
    v_exp_f32 v118, v118
    v_exp_f32 v119, v119
    v_exp_f32 v120, v120
    v_exp_f32 v121, v121
    v_exp_f32 v122, v122
    v_exp_f32 v123, v123
    v_exp_f32 v124, v124
    v_exp_f32 v125, v125
    v_exp_f32 v126, v126
    v_smfmac_f32_32x32x32_bf16 v[144:159], v[88:91], v[112:119], v164
    v_exp_f32 v127, v127
    v_exp_f32 v96, v96
    v_exp_f32 v97, v97
    v_smfmac_f32_32x32x32_bf16 v[144:159], v[92:95], v[120:127], v164
    v_exp_f32 v98, v98
    v_exp_f32 v99, v99
    v_exp_f32 v100, v100
    v_mfma_f32_32x32x16_bf16 v[112:127], v[4:7], v[160:163], 0
    v_exp_f32 v101, v101
    v_exp_f32 v102, v102
    v_exp_f32 v103, v103
    v_exp_f32 v104, v104
    v_exp_f32 v105, v105
    v_exp_f32 v106, v106
    v_exp_f32 v107, v107
    v_exp_f32 v108, v108
    ds_write_b128 v167, v[144:147] offset:4096
    v_exp_f32 v109, v109
    ds_write_b128 v167, v[148:151] offset:5120
    v_exp_f32 v110, v110
    ds_write_b32 v167, v152 offset:4
    s_mov_b64 exec, 1
    ds_inc_u32 v167, v164 offset:12
    s_mov_b64 exec, -1
    s_waitcnt lgkmcnt(4)
    v_readfirstlane_b32 s66, v137
    s_nop 0
    s_cmp_ge_u32 s66, 2
    s_cbranch_scc0 L_sumwait_34
L_sumok_33:
    v_smfmac_f32_32x32x32_bf16 v[128:143], v[32:35], v[96:103], v164
    v_exp_f32 v111, v111
    v_exp_f32 v112, v112
    v_exp_f32 v113, v113
    v_smfmac_f32_32x32x32_bf16 v[128:143], v[36:39], v[104:111], v164
    v_exp_f32 v114, v114
    v_exp_f32 v115, v115
    v_exp_f32 v116, v116
    v_mfma_f32_32x32x16_bf16 v[96:111], v[8:11], v[160:163], 0
    v_exp_f32 v117, v117
    v_exp_f32 v118, v118
    v_exp_f32 v119, v119
    v_exp_f32 v120, v120
    v_exp_f32 v121, v121
    v_exp_f32 v122, v122
    v_exp_f32 v123, v123
    v_exp_f32 v124, v124
    v_exp_f32 v125, v125
    v_exp_f32 v126, v126
    v_smfmac_f32_32x32x32_bf16 v[128:143], v[40:43], v[112:119], v164
    v_exp_f32 v127, v127
    v_exp_f32 v96, v96
    v_exp_f32 v97, v97
    v_smfmac_f32_32x32x32_bf16 v[128:143], v[44:47], v[120:127], v164
    v_exp_f32 v98, v98
    v_exp_f32 v99, v99
    v_exp_f32 v100, v100
    v_mfma_f32_32x32x16_bf16 v[112:127], v[12:15], v[160:163], 0
    v_exp_f32 v101, v101
    v_exp_f32 v102, v102
    v_exp_f32 v103, v103
    v_exp_f32 v104, v104
    v_exp_f32 v105, v105
    v_exp_f32 v106, v106
    v_exp_f32 v107, v107
    v_exp_f32 v108, v108
    v_exp_f32 v109, v109
    v_exp_f32 v110, v110
    v_smfmac_f32_32x32x32_bf16 v[128:143], v[48:51], v[96:103], v164
    v_exp_f32 v111, v111
    v_exp_f32 v112, v112
    v_exp_f32 v113, v113
    v_smfmac_f32_32x32x32_bf16 v[128:143], v[52:55], v[104:111], v164
    v_exp_f32 v114, v114
    v_exp_f32 v115, v115
    v_exp_f32 v116, v116
    v_mfma_f32_32x32x16_bf16 v[96:111], v[16:19], v[160:163], 0
    v_exp_f32 v117, v117
    v_exp_f32 v118, v118
    v_exp_f32 v119, v119
    v_exp_f32 v120, v120
    v_exp_f32 v121, v121
    v_exp_f32 v122, v122
    v_exp_f32 v123, v123
    v_exp_f32 v124, v124
    v_exp_f32 v125, v125
    v_exp_f32 v126, v126
    v_smfmac_f32_32x32x32_bf16 v[128:143], v[56:59], v[112:119], v164
    v_exp_f32 v127, v127
    v_exp_f32 v96, v96
    v_exp_f32 v97, v97
    v_smfmac_f32_32x32x32_bf16 v[128:143], v[60:63], v[120:127], v164
    v_exp_f32 v98, v98
    v_exp_f32 v99, v99
    v_exp_f32 v100, v100
    v_mfma_f32_32x32x16_bf16 v[112:127], v[20:23], v[160:163], 0
    v_exp_f32 v101, v101
    v_exp_f32 v102, v102
    v_exp_f32 v103, v103
    v_exp_f32 v104, v104
    v_exp_f32 v105, v105
    v_exp_f32 v106, v106
    v_exp_f32 v107, v107
    v_exp_f32 v108, v108
    v_exp_f32 v109, v109
    v_exp_f32 v110, v110
    v_smfmac_f32_32x32x32_bf16 v[128:143], v[64:67], v[96:103], v164
    v_exp_f32 v111, v111
    v_exp_f32 v112, v112
    v_exp_f32 v113, v113
    v_smfmac_f32_32x32x32_bf16 v[128:143], v[68:71], v[104:111], v164
    v_exp_f32 v114, v114
    v_exp_f32 v115, v115
    v_exp_f32 v116, v116
    v_mfma_f32_32x32x16_bf16 v[96:111], v[24:27], v[160:163], 0
    v_add_u32 v167, s45, v166
    v_exp_f32 v117, v117
    v_exp_f32 v118, v118
    v_exp_f32 v119, v119
    v_exp_f32 v120, v120
    v_exp_f32 v121, v121
    v_exp_f32 v122, v122
    v_exp_f32 v123, v123
    v_exp_f32 v124, v124
    v_exp_f32 v125, v125
    v_exp_f32 v126, v126
    v_smfmac_f32_32x32x32_bf16 v[128:143], v[72:75], v[112:119], v164
    v_exp_f32 v127, v127
    v_exp_f32 v96, v96
    v_exp_f32 v97, v97
    v_smfmac_f32_32x32x32_bf16 v[128:143], v[76:79], v[120:127], v164
    v_exp_f32 v98, v98
    v_exp_f32 v99, v99
    v_exp_f32 v100, v100
    v_mfma_f32_32x32x16_bf16 v[112:127], v[28:31], v[160:163], 0
    ds_read_b128 v[160:163], v167 offset:1024
    v_exp_f32 v101, v101
    ds_read_b32 v153, v167 offset:12
    v_exp_f32 v102, v102
    ds_read_b128 v[144:147], v167 offset:4096
    v_exp_f32 v103, v103
    ds_read_b128 v[148:151], v167 offset:5120
    v_exp_f32 v104, v104
    ds_read_b32 v152, v167 offset:4
    v_exp_f32 v105, v105
    v_exp_f32 v106, v106
    v_exp_f32 v107, v107
    v_exp_f32 v108, v108
    v_exp_f32 v109, v109
    v_exp_f32 v110, v110
    v_smfmac_f32_32x32x32_bf16 v[128:143], v[80:83], v[96:103], v164
    v_exp_f32 v111, v111
    v_exp_f32 v112, v112
    v_exp_f32 v113, v113
    v_smfmac_f32_32x32x32_bf16 v[128:143], v[84:87], v[104:111], v164
    v_exp_f32 v114, v114
    v_exp_f32 v115, v115
    v_exp_f32 v116, v116
    s_waitcnt lgkmcnt(4)
    v_mfma_f32_32x32x16_bf16 v[96:111], v[0:3], v[160:163], 0
    v_exp_f32 v117, v117
    v_exp_f32 v118, v118
    v_exp_f32 v119, v119
    v_exp_f32 v120, v120
    v_exp_f32 v121, v121
    v_exp_f32 v122, v122
    v_exp_f32 v123, v123
    v_exp_f32 v124, v124
    v_exp_f32 v125, v125
    v_exp_f32 v126, v126
    v_smfmac_f32_32x32x32_bf16 v[128:143], v[88:91], v[112:119], v164
    v_exp_f32 v127, v127
    v_exp_f32 v96, v96
    v_exp_f32 v97, v97
    v_smfmac_f32_32x32x32_bf16 v[128:143], v[92:95], v[120:127], v164
    v_exp_f32 v98, v98
    v_exp_f32 v99, v99
    v_exp_f32 v100, v100
    v_mfma_f32_32x32x16_bf16 v[112:127], v[4:7], v[160:163], 0
    v_exp_f32 v101, v101
    v_exp_f32 v102, v102
    v_exp_f32 v103, v103
    v_exp_f32 v104, v104
    v_exp_f32 v105, v105
    v_exp_f32 v106, v106
    v_exp_f32 v107, v107
    v_exp_f32 v108, v108
    ds_write_b128 v165, v[128:131] offset:4096
    v_exp_f32 v109, v109
    ds_write_b128 v165, v[132:135] offset:5120
    v_exp_f32 v110, v110
    ds_write_b32 v165, v136 offset:4
    s_mov_b64 exec, 1
    ds_inc_u32 v165, v164 offset:12
    s_mov_b64 exec, -1
    s_waitcnt lgkmcnt(4)
    v_readfirstlane_b32 s66, v153
    s_nop 0
    s_cmp_ge_u32 s66, 2
    s_cbranch_scc0 L_sumwait_36
L_sumok_35:
    v_smfmac_f32_32x32x32_bf16 v[144:159], v[32:35], v[96:103], v164
    v_exp_f32 v111, v111
    v_exp_f32 v112, v112
    v_exp_f32 v113, v113
    v_smfmac_f32_32x32x32_bf16 v[144:159], v[36:39], v[104:111], v164
    v_exp_f32 v114, v114
    v_exp_f32 v115, v115
    v_exp_f32 v116, v116
    v_mfma_f32_32x32x16_bf16 v[96:111], v[8:11], v[160:163], 0
    v_exp_f32 v117, v117
    v_exp_f32 v118, v118
    v_exp_f32 v119, v119
    v_exp_f32 v120, v120
    v_exp_f32 v121, v121
    v_exp_f32 v122, v122
    v_exp_f32 v123, v123
    v_exp_f32 v124, v124
    v_exp_f32 v125, v125
    v_exp_f32 v126, v126
    v_smfmac_f32_32x32x32_bf16 v[144:159], v[40:43], v[112:119], v164
    v_exp_f32 v127, v127
    v_exp_f32 v96, v96
    v_exp_f32 v97, v97
    v_smfmac_f32_32x32x32_bf16 v[144:159], v[44:47], v[120:127], v164
    v_exp_f32 v98, v98
    v_exp_f32 v99, v99
    v_exp_f32 v100, v100
    v_mfma_f32_32x32x16_bf16 v[112:127], v[12:15], v[160:163], 0
    v_exp_f32 v101, v101
    v_exp_f32 v102, v102
    v_exp_f32 v103, v103
    v_exp_f32 v104, v104
    v_exp_f32 v105, v105
    v_exp_f32 v106, v106
    v_exp_f32 v107, v107
    v_exp_f32 v108, v108
    v_exp_f32 v109, v109
    v_exp_f32 v110, v110
    v_smfmac_f32_32x32x32_bf16 v[144:159], v[48:51], v[96:103], v164
    v_exp_f32 v111, v111
    v_exp_f32 v112, v112
    v_exp_f32 v113, v113
    v_smfmac_f32_32x32x32_bf16 v[144:159], v[52:55], v[104:111], v164
    v_exp_f32 v114, v114
    v_exp_f32 v115, v115
    v_exp_f32 v116, v116
    v_mfma_f32_32x32x16_bf16 v[96:111], v[16:19], v[160:163], 0
    v_exp_f32 v117, v117
    v_exp_f32 v118, v118
    v_exp_f32 v119, v119
    v_exp_f32 v120, v120
    v_exp_f32 v121, v121
    v_exp_f32 v122, v122
    v_exp_f32 v123, v123
    v_exp_f32 v124, v124
    v_exp_f32 v125, v125
    v_exp_f32 v126, v126
    v_smfmac_f32_32x32x32_bf16 v[144:159], v[56:59], v[112:119], v164
    v_exp_f32 v127, v127
    v_exp_f32 v96, v96
    v_exp_f32 v97, v97
    v_smfmac_f32_32x32x32_bf16 v[144:159], v[60:63], v[120:127], v164
    v_exp_f32 v98, v98
    v_exp_f32 v99, v99
    v_exp_f32 v100, v100
    v_mfma_f32_32x32x16_bf16 v[112:127], v[20:23], v[160:163], 0
    v_exp_f32 v101, v101
    v_exp_f32 v102, v102
    v_exp_f32 v103, v103
    v_exp_f32 v104, v104
    v_exp_f32 v105, v105
    v_exp_f32 v106, v106
    v_exp_f32 v107, v107
    v_exp_f32 v108, v108
    v_exp_f32 v109, v109
    v_exp_f32 v110, v110
    v_smfmac_f32_32x32x32_bf16 v[144:159], v[64:67], v[96:103], v164
    v_exp_f32 v111, v111
    v_exp_f32 v112, v112
    v_exp_f32 v113, v113
    v_smfmac_f32_32x32x32_bf16 v[144:159], v[68:71], v[104:111], v164
    v_exp_f32 v114, v114
    v_exp_f32 v115, v115
    v_exp_f32 v116, v116
    v_mfma_f32_32x32x16_bf16 v[96:111], v[24:27], v[160:163], 0
    v_add_u32 v165, s46, v166
    v_exp_f32 v117, v117
    v_exp_f32 v118, v118
    v_exp_f32 v119, v119
    v_exp_f32 v120, v120
    v_exp_f32 v121, v121
    v_exp_f32 v122, v122
    v_exp_f32 v123, v123
    v_exp_f32 v124, v124
    v_exp_f32 v125, v125
    v_exp_f32 v126, v126
    v_smfmac_f32_32x32x32_bf16 v[144:159], v[72:75], v[112:119], v164
    v_exp_f32 v127, v127
    v_exp_f32 v96, v96
    v_exp_f32 v97, v97
    v_smfmac_f32_32x32x32_bf16 v[144:159], v[76:79], v[120:127], v164
    v_exp_f32 v98, v98
    v_exp_f32 v99, v99
    v_exp_f32 v100, v100
    v_mfma_f32_32x32x16_bf16 v[112:127], v[28:31], v[160:163], 0
    ds_read_b128 v[160:163], v165 offset:1024
    v_exp_f32 v101, v101
    ds_read_b32 v137, v165 offset:12
    v_exp_f32 v102, v102
    ds_read_b128 v[128:131], v165 offset:4096
    v_exp_f32 v103, v103
    ds_read_b128 v[132:135], v165 offset:5120
    v_exp_f32 v104, v104
    ds_read_b32 v136, v165 offset:4
    v_exp_f32 v105, v105
    v_exp_f32 v106, v106
    v_exp_f32 v107, v107
    v_exp_f32 v108, v108
    v_exp_f32 v109, v109
    v_exp_f32 v110, v110
    v_smfmac_f32_32x32x32_bf16 v[144:159], v[80:83], v[96:103], v164
    v_exp_f32 v111, v111
    v_exp_f32 v112, v112
    v_exp_f32 v113, v113
    v_smfmac_f32_32x32x32_bf16 v[144:159], v[84:87], v[104:111], v164
    v_exp_f32 v114, v114
    v_exp_f32 v115, v115
    v_exp_f32 v116, v116
    s_waitcnt lgkmcnt(4)
    v_mfma_f32_32x32x16_bf16 v[96:111], v[0:3], v[160:163], 0
    v_exp_f32 v117, v117
    v_exp_f32 v118, v118
    v_exp_f32 v119, v119
    v_exp_f32 v120, v120
    v_exp_f32 v121, v121
    v_exp_f32 v122, v122
    v_exp_f32 v123, v123
    v_exp_f32 v124, v124
    v_exp_f32 v125, v125
    v_exp_f32 v126, v126
    v_smfmac_f32_32x32x32_bf16 v[144:159], v[88:91], v[112:119], v164
    v_exp_f32 v127, v127
    s_setprio 0
    v_exp_f32 v96, v96
    v_exp_f32 v97, v97
    v_smfmac_f32_32x32x32_bf16 v[144:159], v[92:95], v[120:127], v164
    v_exp_f32 v98, v98
    v_exp_f32 v99, v99
    v_exp_f32 v100, v100
    v_mfma_f32_32x32x16_bf16 v[112:127], v[4:7], v[160:163], 0
    v_exp_f32 v101, v101
    v_exp_f32 v102, v102
    v_exp_f32 v103, v103
    v_exp_f32 v104, v104
    v_exp_f32 v105, v105
    v_exp_f32 v106, v106
    v_exp_f32 v107, v107
    v_exp_f32 v108, v108
    ds_write_b128 v167, v[144:147] offset:4096
    v_exp_f32 v109, v109
    ds_write_b128 v167, v[148:151] offset:5120
    v_exp_f32 v110, v110
    ds_write_b32 v167, v152 offset:4
    s_mov_b64 exec, 1
    ds_inc_u32 v167, v164 offset:12
    s_mov_b64 exec, -1
    s_waitcnt lgkmcnt(4)
    v_readfirstlane_b32 s66, v137
    s_nop 0
    s_cmp_ge_u32 s66, 3
    s_cbranch_scc0 L_sumwait_38
L_sumok_37:
    v_smfmac_f32_32x32x32_bf16 v[128:143], v[32:35], v[96:103], v164
    v_exp_f32 v111, v111
    v_exp_f32 v112, v112
    v_exp_f32 v113, v113
    v_smfmac_f32_32x32x32_bf16 v[128:143], v[36:39], v[104:111], v164
    v_exp_f32 v114, v114
    v_exp_f32 v115, v115
    v_exp_f32 v116, v116
    v_mfma_f32_32x32x16_bf16 v[96:111], v[8:11], v[160:163], 0
    v_exp_f32 v117, v117
    v_exp_f32 v118, v118
    v_exp_f32 v119, v119
    v_exp_f32 v120, v120
    v_exp_f32 v121, v121
    v_exp_f32 v122, v122
    v_exp_f32 v123, v123
    v_exp_f32 v124, v124
    v_exp_f32 v125, v125
    v_exp_f32 v126, v126
    v_smfmac_f32_32x32x32_bf16 v[128:143], v[40:43], v[112:119], v164
    v_exp_f32 v127, v127
    v_exp_f32 v96, v96
    v_exp_f32 v97, v97
    v_smfmac_f32_32x32x32_bf16 v[128:143], v[44:47], v[120:127], v164
    v_exp_f32 v98, v98
    v_exp_f32 v99, v99
    v_exp_f32 v100, v100
    v_mfma_f32_32x32x16_bf16 v[112:127], v[12:15], v[160:163], 0
    v_exp_f32 v101, v101
    v_exp_f32 v102, v102
    v_exp_f32 v103, v103
    v_exp_f32 v104, v104
    v_exp_f32 v105, v105
    v_exp_f32 v106, v106
    v_exp_f32 v107, v107
    v_exp_f32 v108, v108
    v_exp_f32 v109, v109
    v_exp_f32 v110, v110
    v_smfmac_f32_32x32x32_bf16 v[128:143], v[48:51], v[96:103], v164
    v_exp_f32 v111, v111
    v_exp_f32 v112, v112
    v_exp_f32 v113, v113
    v_smfmac_f32_32x32x32_bf16 v[128:143], v[52:55], v[104:111], v164
    v_exp_f32 v114, v114
    v_exp_f32 v115, v115
    v_exp_f32 v116, v116
    v_mfma_f32_32x32x16_bf16 v[96:111], v[16:19], v[160:163], 0
    v_exp_f32 v117, v117
    v_exp_f32 v118, v118
    v_exp_f32 v119, v119
    v_exp_f32 v120, v120
    v_exp_f32 v121, v121
    v_exp_f32 v122, v122
    v_exp_f32 v123, v123
    v_exp_f32 v124, v124
    v_exp_f32 v125, v125
    v_exp_f32 v126, v126
    v_smfmac_f32_32x32x32_bf16 v[128:143], v[56:59], v[112:119], v164
    v_exp_f32 v127, v127
    v_exp_f32 v96, v96
    v_exp_f32 v97, v97
    v_smfmac_f32_32x32x32_bf16 v[128:143], v[60:63], v[120:127], v164
    v_exp_f32 v98, v98
    v_exp_f32 v99, v99
    v_exp_f32 v100, v100
    v_mfma_f32_32x32x16_bf16 v[112:127], v[20:23], v[160:163], 0
    v_exp_f32 v101, v101
    v_exp_f32 v102, v102
    v_exp_f32 v103, v103
    v_exp_f32 v104, v104
    v_exp_f32 v105, v105
    v_exp_f32 v106, v106
    v_exp_f32 v107, v107
    v_exp_f32 v108, v108
    v_exp_f32 v109, v109
    v_exp_f32 v110, v110
    v_smfmac_f32_32x32x32_bf16 v[128:143], v[64:67], v[96:103], v164
    v_exp_f32 v111, v111
    v_exp_f32 v112, v112
    v_exp_f32 v113, v113
    v_smfmac_f32_32x32x32_bf16 v[128:143], v[68:71], v[104:111], v164
    v_exp_f32 v114, v114
    v_exp_f32 v115, v115
    v_exp_f32 v116, v116
    v_mfma_f32_32x32x16_bf16 v[96:111], v[24:27], v[160:163], 0
    v_add_u32 v167, s47, v166
    v_exp_f32 v117, v117
    v_exp_f32 v118, v118
    v_exp_f32 v119, v119
    v_exp_f32 v120, v120
    v_exp_f32 v121, v121
    v_exp_f32 v122, v122
    v_exp_f32 v123, v123
    v_exp_f32 v124, v124
    v_exp_f32 v125, v125
    v_exp_f32 v126, v126
    v_smfmac_f32_32x32x32_bf16 v[128:143], v[72:75], v[112:119], v164
    v_exp_f32 v127, v127
    v_exp_f32 v96, v96
    v_exp_f32 v97, v97
    v_smfmac_f32_32x32x32_bf16 v[128:143], v[76:79], v[120:127], v164
    v_exp_f32 v98, v98
    v_exp_f32 v99, v99
    v_exp_f32 v100, v100
    v_mfma_f32_32x32x16_bf16 v[112:127], v[28:31], v[160:163], 0
    ds_read_b128 v[160:163], v167 offset:1024
    v_exp_f32 v101, v101
    ds_read_b32 v153, v167 offset:12
    v_exp_f32 v102, v102
    ds_read_b128 v[144:147], v167 offset:4096
    v_exp_f32 v103, v103
    ds_read_b128 v[148:151], v167 offset:5120
    v_exp_f32 v104, v104
    ds_read_b32 v152, v167 offset:4
    v_exp_f32 v105, v105
    v_exp_f32 v106, v106
    v_exp_f32 v107, v107
    v_exp_f32 v108, v108
    v_exp_f32 v109, v109
    v_exp_f32 v110, v110
    v_smfmac_f32_32x32x32_bf16 v[128:143], v[80:83], v[96:103], v164
    v_exp_f32 v111, v111
    v_exp_f32 v112, v112
    v_exp_f32 v113, v113
    v_smfmac_f32_32x32x32_bf16 v[128:143], v[84:87], v[104:111], v164
    v_exp_f32 v114, v114
    v_exp_f32 v115, v115
    v_exp_f32 v116, v116
    s_waitcnt lgkmcnt(4)
    v_mfma_f32_32x32x16_bf16 v[96:111], v[0:3], v[160:163], 0
    v_exp_f32 v117, v117
    v_exp_f32 v118, v118
    v_exp_f32 v119, v119
    v_exp_f32 v120, v120
    v_exp_f32 v121, v121
    v_exp_f32 v122, v122
    v_exp_f32 v123, v123
    v_exp_f32 v124, v124
    v_exp_f32 v125, v125
    v_exp_f32 v126, v126
    v_smfmac_f32_32x32x32_bf16 v[128:143], v[88:91], v[112:119], v164
    v_exp_f32 v127, v127
    v_exp_f32 v96, v96
    v_exp_f32 v97, v97
    v_smfmac_f32_32x32x32_bf16 v[128:143], v[92:95], v[120:127], v164
    v_exp_f32 v98, v98
    v_exp_f32 v99, v99
    v_exp_f32 v100, v100
    v_mfma_f32_32x32x16_bf16 v[112:127], v[4:7], v[160:163], 0
    v_exp_f32 v101, v101
    v_exp_f32 v102, v102
    v_exp_f32 v103, v103
    v_exp_f32 v104, v104
    v_exp_f32 v105, v105
    v_exp_f32 v106, v106
    v_exp_f32 v107, v107
    v_exp_f32 v108, v108
    ds_write_b128 v165, v[128:131] offset:4096
    v_exp_f32 v109, v109
    ds_write_b128 v165, v[132:135] offset:5120
    v_exp_f32 v110, v110
    ds_write_b32 v165, v136 offset:4
    s_mov_b64 exec, 1
    ds_inc_u32 v165, v164 offset:12
    s_mov_b64 exec, -1
    s_waitcnt lgkmcnt(4)
    v_readfirstlane_b32 s66, v153
    s_nop 0
    s_cmp_ge_u32 s66, 3
    s_cbranch_scc0 L_sumwait_40
L_sumok_39:
    v_smfmac_f32_32x32x32_bf16 v[144:159], v[32:35], v[96:103], v164
    v_exp_f32 v111, v111
    v_exp_f32 v112, v112
    v_exp_f32 v113, v113
    v_smfmac_f32_32x32x32_bf16 v[144:159], v[36:39], v[104:111], v164
    v_exp_f32 v114, v114
    v_exp_f32 v115, v115
    v_exp_f32 v116, v116
    v_mfma_f32_32x32x16_bf16 v[96:111], v[8:11], v[160:163], 0
    v_exp_f32 v117, v117
    v_exp_f32 v118, v118
    v_exp_f32 v119, v119
    v_exp_f32 v120, v120
    v_exp_f32 v121, v121
    v_exp_f32 v122, v122
    v_exp_f32 v123, v123
    v_exp_f32 v124, v124
    v_exp_f32 v125, v125
    v_exp_f32 v126, v126
    v_smfmac_f32_32x32x32_bf16 v[144:159], v[40:43], v[112:119], v164
    v_exp_f32 v127, v127
    v_exp_f32 v96, v96
    v_exp_f32 v97, v97
    v_smfmac_f32_32x32x32_bf16 v[144:159], v[44:47], v[120:127], v164
    v_exp_f32 v98, v98
    v_exp_f32 v99, v99
    v_exp_f32 v100, v100
    v_mfma_f32_32x32x16_bf16 v[112:127], v[12:15], v[160:163], 0
    v_exp_f32 v101, v101
    v_exp_f32 v102, v102
    v_exp_f32 v103, v103
    v_exp_f32 v104, v104
    v_exp_f32 v105, v105
    v_exp_f32 v106, v106
    v_exp_f32 v107, v107
    v_exp_f32 v108, v108
    v_exp_f32 v109, v109
    v_exp_f32 v110, v110
    v_smfmac_f32_32x32x32_bf16 v[144:159], v[48:51], v[96:103], v164
    v_exp_f32 v111, v111
    v_exp_f32 v112, v112
    v_exp_f32 v113, v113
    v_smfmac_f32_32x32x32_bf16 v[144:159], v[52:55], v[104:111], v164
    v_exp_f32 v114, v114
    v_exp_f32 v115, v115
    v_exp_f32 v116, v116
    v_mfma_f32_32x32x16_bf16 v[96:111], v[16:19], v[160:163], 0
    v_exp_f32 v117, v117
    v_exp_f32 v118, v118
    v_exp_f32 v119, v119
    v_exp_f32 v120, v120
    v_exp_f32 v121, v121
    v_exp_f32 v122, v122
    v_exp_f32 v123, v123
    v_exp_f32 v124, v124
    v_exp_f32 v125, v125
    v_exp_f32 v126, v126
    v_smfmac_f32_32x32x32_bf16 v[144:159], v[56:59], v[112:119], v164
    v_exp_f32 v127, v127
    v_exp_f32 v96, v96
    v_exp_f32 v97, v97
    v_smfmac_f32_32x32x32_bf16 v[144:159], v[60:63], v[120:127], v164
    v_exp_f32 v98, v98
    v_exp_f32 v99, v99
    v_exp_f32 v100, v100
    v_mfma_f32_32x32x16_bf16 v[112:127], v[20:23], v[160:163], 0
    v_exp_f32 v101, v101
    v_exp_f32 v102, v102
    v_exp_f32 v103, v103
    v_exp_f32 v104, v104
    v_exp_f32 v105, v105
    v_exp_f32 v106, v106
    v_exp_f32 v107, v107
    v_exp_f32 v108, v108
    v_exp_f32 v109, v109
    v_exp_f32 v110, v110
    v_smfmac_f32_32x32x32_bf16 v[144:159], v[64:67], v[96:103], v164
    v_exp_f32 v111, v111
    v_exp_f32 v112, v112
    v_exp_f32 v113, v113
    v_smfmac_f32_32x32x32_bf16 v[144:159], v[68:71], v[104:111], v164
    v_exp_f32 v114, v114
    v_exp_f32 v115, v115
    v_exp_f32 v116, v116
    v_mfma_f32_32x32x16_bf16 v[96:111], v[24:27], v[160:163], 0
    v_exp_f32 v117, v117
    v_exp_f32 v118, v118
    v_exp_f32 v119, v119
    v_exp_f32 v120, v120
    v_exp_f32 v121, v121
    v_exp_f32 v122, v122
    v_exp_f32 v123, v123
    v_exp_f32 v124, v124
    v_exp_f32 v125, v125
    v_exp_f32 v126, v126
    v_smfmac_f32_32x32x32_bf16 v[144:159], v[72:75], v[112:119], v164
    v_exp_f32 v127, v127
    v_exp_f32 v96, v96
    v_exp_f32 v97, v97
    v_smfmac_f32_32x32x32_bf16 v[144:159], v[76:79], v[120:127], v164
    v_exp_f32 v98, v98
    v_exp_f32 v99, v99
    v_exp_f32 v100, v100
    v_mfma_f32_32x32x16_bf16 v[112:127], v[28:31], v[160:163], 0
    v_exp_f32 v101, v101
    ds_read_b32 v137, v167 offset:8
    v_exp_f32 v102, v102
    ds_read_b128 v[128:131], v167 offset:2048
    v_exp_f32 v103, v103
    ds_read_b128 v[132:135], v167 offset:3072
    v_exp_f32 v104, v104
    ds_read_b32 v136, v167 offset:0
    v_exp_f32 v105, v105
    v_exp_f32 v106, v106
    v_exp_f32 v107, v107
    v_exp_f32 v108, v108
    v_exp_f32 v109, v109
    v_exp_f32 v110, v110
    v_smfmac_f32_32x32x32_bf16 v[144:159], v[80:83], v[96:103], v164
    v_exp_f32 v111, v111
    v_exp_f32 v112, v112
    v_exp_f32 v113, v113
    v_smfmac_f32_32x32x32_bf16 v[144:159], v[84:87], v[104:111], v164
    v_exp_f32 v114, v114
    v_exp_f32 v115, v115
    v_exp_f32 v116, v116
    v_exp_f32 v117, v117
    v_exp_f32 v118, v118
    v_exp_f32 v119, v119
    v_exp_f32 v120, v120
    v_exp_f32 v121, v121
    v_exp_f32 v122, v122
    v_exp_f32 v123, v123
    v_exp_f32 v124, v124
    v_exp_f32 v125, v125
    v_exp_f32 v126, v126
    v_smfmac_f32_32x32x32_bf16 v[144:159], v[88:91], v[112:119], v164
    v_exp_f32 v127, v127
    s_nop 1
    v_smfmac_f32_32x32x32_bf16 v[144:159], v[92:95], v[120:127], v164
    s_setprio 3
    s_waitcnt lgkmcnt(0)
    v_readfirstlane_b32 s66, v137
    s_nop 0
    s_cmp_ge_u32 s66, 4
    s_cbranch_scc0 L_sumwait_42
L_sumok_41:
    s_nop 5
    v_pk_add_f32 v[144:145], v[144:145], v[128:129]
    v_pk_add_f32 v[146:147], v[146:147], v[130:131]
    v_pk_add_f32 v[148:149], v[148:149], v[132:133]
    v_pk_add_f32 v[150:151], v[150:151], v[134:135]
    v_add_f32 v152, v152, v136
    v_rcp_f32 v152, v152
    s_add_u32 s66, s75, s69
    s_add_u32 s66, s66, 0x8000
    v_pk_mul_f32 v[144:145], v[144:145], v[152:153] op_sel_hi:[1,0]
    v_pk_mul_f32 v[146:147], v[146:147], v[152:153] op_sel_hi:[1,0]
    v_pk_mul_f32 v[148:149], v[148:149], v[152:153] op_sel_hi:[1,0]
    v_pk_mul_f32 v[150:151], v[150:151], v[152:153] op_sel_hi:[1,0]
    v_cvt_pk_bf16_f32 v156, v144, v145
    v_cvt_pk_bf16_f32 v157, v146, v147
    v_cvt_pk_bf16_f32 v158, v148, v149
    v_cvt_pk_bf16_f32 v159, v150, v151
    buffer_store_dwordx4 v[156:159], v166, s[48:51], s66 offen sc1
    s_lshl_b32 s56, s4, 12
    s_lshl_b32 s57, s5, 9
    s_add_u32 s56, s56, s57
    s_lshr_b32 s57, s75, 3
    s_add_u32 s56, s56, s57
    s_add_u32 s56, s56, 8257536
    v_mov_b32 v128, s6
    v_mbcnt_lo_u32_b32 v129, -1, 0
    v_lshlrev_b32 v129, 2, v129
    s_mov_b32 exec_hi, 0
    s_waitcnt vmcnt(0)
    buffer_store_dword v128, v129, s[48:51], s56 offen sc1
    s_mov_b64 exec, -1
    s_mov_b64 exec, 1
    ds_inc_u32 v166, v164 offset:248
    s_mov_b64 exec, -1
L_A_end:
    s_or_b32 s56, s2, s3
    s_cbranch_scc1 L_A_out
    v_subrev_u32 v0, 65536, v166
    v_lshlrev_b32 v0, 3, v0
    s_mov_b32 s76, 0x8000
L_ep:
    s_mov_b32 s57, 163840
    buffer_load_dword v1, v0, s[48:51], s57 offen sc1
    s_mov_b32 s57, 172032
    buffer_load_dword v2, v0, s[48:51], s57 offen sc1
    s_mov_b32 s57, 180224
    buffer_load_dword v3, v0, s[48:51], s57 offen sc1
    s_mov_b32 s57, 188416
    buffer_load_dword v4, v0, s[48:51], s57 offen sc1
    s_waitcnt vmcnt(0)
    v_xor_b32 v1, s6, v1
    v_xor_b32 v2, s6, v2
    v_xor_b32 v3, s6, v3
    v_xor_b32 v4, s6, v4
    v_or3_b32 v1, v1, v2, v3
    v_or_b32 v1, v1, v4
    v_cmp_ne_u32 vcc, 0, v1
    s_nop 0
    s_cbranch_vccz L_ep_ok
    s_sleep 8
    s_sub_u32 s76, s76, 1
    s_cbranch_scc0 L_ep
L_ep_ok:
    v_mov_b32 v1, s6
    s_mov_b32 s57, 147456
    s_mov_b64 exec, 1
    buffer_store_dword v1, off, s[48:51], s57 sc1
L_A_out:
    s_endpgm
L_sumwait_16:
    s_mov_b32 s76, 0x40000
L_sumspin_43:
    s_sleep 1
    ds_read_b32 v137, v165 offset:8
    ds_read_b128 v[128:131], v165 offset:2048
    ds_read_b128 v[132:135], v165 offset:3072
    ds_read_b32 v136, v165 offset:0
    s_waitcnt lgkmcnt(0)
    v_readfirstlane_b32 s66, v137
    s_nop 0
    s_cmp_ge_u32 s66, 1
    s_cbranch_scc1 L_sumok_15
    s_sub_u32 s76, s76, 1
    s_cbranch_scc0 L_sumspin_43
    s_branch L_sumok_15
L_sumwait_18:
    s_mov_b32 s76, 0x40000
L_sumspin_44:
    s_sleep 1
    ds_read_b32 v153, v167 offset:8
    ds_read_b128 v[144:147], v167 offset:2048
    ds_read_b128 v[148:151], v167 offset:3072
    ds_read_b32 v152, v167 offset:0
    s_waitcnt lgkmcnt(0)
    v_readfirstlane_b32 s66, v153
    s_nop 0
    s_cmp_ge_u32 s66, 1
    s_cbranch_scc1 L_sumok_17
    s_sub_u32 s76, s76, 1
    s_cbranch_scc0 L_sumspin_44
    s_branch L_sumok_17
L_sumwait_20:
    s_mov_b32 s76, 0x40000
L_sumspin_45:
    s_sleep 1
    ds_read_b32 v137, v165 offset:8
    ds_read_b128 v[128:131], v165 offset:2048
    ds_read_b128 v[132:135], v165 offset:3072
    ds_read_b32 v136, v165 offset:0
    s_waitcnt lgkmcnt(0)
    v_readfirstlane_b32 s66, v137
    s_nop 0
    s_cmp_ge_u32 s66, 2
    s_cbranch_scc1 L_sumok_19
    s_sub_u32 s76, s76, 1
    s_cbranch_scc0 L_sumspin_45
    s_branch L_sumok_19
L_sumwait_22:
    s_mov_b32 s76, 0x40000
L_sumspin_46:
    s_sleep 1
    ds_read_b32 v153, v167 offset:8
    ds_read_b128 v[144:147], v167 offset:2048
    ds_read_b128 v[148:151], v167 offset:3072
    ds_read_b32 v152, v167 offset:0
    s_waitcnt lgkmcnt(0)
    v_readfirstlane_b32 s66, v153
    s_nop 0
    s_cmp_ge_u32 s66, 2
    s_cbranch_scc1 L_sumok_21
    s_sub_u32 s76, s76, 1
    s_cbranch_scc0 L_sumspin_46
    s_branch L_sumok_21
L_sumwait_24:
    s_mov_b32 s76, 0x40000
L_sumspin_47:
    s_sleep 1
    ds_read_b32 v137, v165 offset:8
    ds_read_b128 v[128:131], v165 offset:2048
    ds_read_b128 v[132:135], v165 offset:3072
    ds_read_b32 v136, v165 offset:0
    s_waitcnt lgkmcnt(0)
    v_readfirstlane_b32 s66, v137
    s_nop 0
    s_cmp_ge_u32 s66, 3
    s_cbranch_scc1 L_sumok_23
    s_sub_u32 s76, s76, 1
    s_cbranch_scc0 L_sumspin_47
    s_branch L_sumok_23
L_sumwait_26:
    s_mov_b32 s76, 0x40000
L_sumspin_48:
    s_sleep 1
    ds_read_b32 v153, v167 offset:8
    ds_read_b128 v[144:147], v167 offset:2048
    ds_read_b128 v[148:151], v167 offset:3072
    ds_read_b32 v152, v167 offset:0
    s_waitcnt lgkmcnt(0)
    v_readfirstlane_b32 s66, v153
    s_nop 0
    s_cmp_ge_u32 s66, 3
    s_cbranch_scc1 L_sumok_25
    s_sub_u32 s76, s76, 1
    s_cbranch_scc0 L_sumspin_48
    s_branch L_sumok_25
L_sumwait_28:
    s_mov_b32 s76, 0x40000
L_sumspin_49:
    s_sleep 1
    ds_read_b32 v105, v165 offset:12
    ds_read_b128 v[96:99], v165 offset:4096
    ds_read_b128 v[100:103], v165 offset:5120
    ds_read_b32 v104, v165 offset:4
    s_waitcnt lgkmcnt(0)
    v_readfirstlane_b32 s66, v105
    s_nop 0
    s_cmp_ge_u32 s66, 4
    s_cbranch_scc1 L_sumok_27
    s_sub_u32 s76, s76, 1
    s_cbranch_scc0 L_sumspin_49
    s_branch L_sumok_27
L_sumwait_30:
    s_mov_b32 s76, 0x40000
L_sumspin_50:
    s_sleep 1
    ds_read_b32 v137, v165 offset:12
    ds_read_b128 v[128:131], v165 offset:4096
    ds_read_b128 v[132:135], v165 offset:5120
    ds_read_b32 v136, v165 offset:4
    s_waitcnt lgkmcnt(0)
    v_readfirstlane_b32 s66, v137
    s_nop 0
    s_cmp_ge_u32 s66, 1
    s_cbranch_scc1 L_sumok_29
    s_sub_u32 s76, s76, 1
    s_cbranch_scc0 L_sumspin_50
    s_branch L_sumok_29
L_sumwait_32:
    s_mov_b32 s76, 0x40000
L_sumspin_51:
    s_sleep 1
    ds_read_b32 v153, v167 offset:12
    ds_read_b128 v[144:147], v167 offset:4096
    ds_read_b128 v[148:151], v167 offset:5120
    ds_read_b32 v152, v167 offset:4
    s_waitcnt lgkmcnt(0)
    v_readfirstlane_b32 s66, v153
    s_nop 0
    s_cmp_ge_u32 s66, 1
    s_cbranch_scc1 L_sumok_31
    s_sub_u32 s76, s76, 1
    s_cbranch_scc0 L_sumspin_51
    s_branch L_sumok_31
L_sumwait_34:
    s_mov_b32 s76, 0x40000
L_sumspin_52:
    s_sleep 1
    ds_read_b32 v137, v165 offset:12
    ds_read_b128 v[128:131], v165 offset:4096
    ds_read_b128 v[132:135], v165 offset:5120
    ds_read_b32 v136, v165 offset:4
    s_waitcnt lgkmcnt(0)
    v_readfirstlane_b32 s66, v137
    s_nop 0
    s_cmp_ge_u32 s66, 2
    s_cbranch_scc1 L_sumok_33
    s_sub_u32 s76, s76, 1
    s_cbranch_scc0 L_sumspin_52
    s_branch L_sumok_33
L_sumwait_36:
    s_mov_b32 s76, 0x40000
L_sumspin_53:
    s_sleep 1
    ds_read_b32 v153, v167 offset:12
    ds_read_b128 v[144:147], v167 offset:4096
    ds_read_b128 v[148:151], v167 offset:5120
    ds_read_b32 v152, v167 offset:4
    s_waitcnt lgkmcnt(0)
    v_readfirstlane_b32 s66, v153
    s_nop 0
    s_cmp_ge_u32 s66, 2
    s_cbranch_scc1 L_sumok_35
    s_sub_u32 s76, s76, 1
    s_cbranch_scc0 L_sumspin_53
    s_branch L_sumok_35
L_sumwait_38:
    s_mov_b32 s76, 0x40000
L_sumspin_54:
    s_sleep 1
    ds_read_b32 v137, v165 offset:12
    ds_read_b128 v[128:131], v165 offset:4096
    ds_read_b128 v[132:135], v165 offset:5120
    ds_read_b32 v136, v165 offset:4
    s_waitcnt lgkmcnt(0)
    v_readfirstlane_b32 s66, v137
    s_nop 0
    s_cmp_ge_u32 s66, 3
    s_cbranch_scc1 L_sumok_37
    s_sub_u32 s76, s76, 1
    s_cbranch_scc0 L_sumspin_54
    s_branch L_sumok_37
L_sumwait_40:
    s_mov_b32 s76, 0x40000
L_sumspin_55:
    s_sleep 1
    ds_read_b32 v153, v167 offset:12
    ds_read_b128 v[144:147], v167 offset:4096
    ds_read_b128 v[148:151], v167 offset:5120
    ds_read_b32 v152, v167 offset:4
    s_waitcnt lgkmcnt(0)
    v_readfirstlane_b32 s66, v153
    s_nop 0
    s_cmp_ge_u32 s66, 3
    s_cbranch_scc1 L_sumok_39
    s_sub_u32 s76, s76, 1
    s_cbranch_scc0 L_sumspin_55
    s_branch L_sumok_39
L_sumwait_42:
    s_mov_b32 s76, 0x40000
L_sumspin_56:
    s_sleep 1
    ds_read_b32 v137, v167 offset:8
    ds_read_b128 v[128:131], v167 offset:2048
    ds_read_b128 v[132:135], v167 offset:3072
    ds_read_b32 v136, v167 offset:0
    s_waitcnt lgkmcnt(0)
    v_readfirstlane_b32 s66, v137
    s_nop 0
    s_cmp_ge_u32 s66, 4
    s_cbranch_scc1 L_sumok_41
    s_sub_u32 s76, s76, 1
    s_cbranch_scc0 L_sumspin_56
    s_branch L_sumok_41
L_fallback:
    s_cmp_ge_u32 s3, 4
    s_cbranch_scc1 L_fb0
    buffer_load_dwordx4 v[16:19], v158, s[48:51], s59 offen offset:0 sc1
    s_mov_b64 exec, s[62:63]
    buffer_load_dwordx4 v[64:67], v159, s[48:51], s60 offen offset:0 sc1
    buffer_load_dwordx4 v[68:71], v159, s[48:51], s60 offen offset:512 sc1
    s_mov_b64 exec, -1
    buffer_load_dwordx4 v[20:23], v158, s[48:51], s59 offen offset:1024 sc1
    s_mov_b64 exec, s[62:63]
    buffer_load_dwordx4 v[72:75], v159, s[48:51], s60 offen offset:1024 sc1
    buffer_load_dwordx4 v[76:79], v159, s[48:51], s60 offen offset:1536 sc1
    s_mov_b64 exec, -1
    buffer_load_dwordx4 v[24:27], v158, s[48:51], s59 offen offset:2048 sc1
    s_mov_b64 exec, s[62:63]
    buffer_load_dwordx4 v[80:83], v159, s[48:51], s60 offen offset:2048 sc1
    buffer_load_dwordx4 v[84:87], v159, s[48:51], s60 offen offset:2560 sc1
    s_mov_b64 exec, -1
    buffer_load_dwordx4 v[28:31], v158, s[48:51], s59 offen offset:3072 sc1
    s_mov_b64 exec, s[62:63]
    buffer_load_dwordx4 v[88:91], v159, s[48:51], s60 offen offset:3072 sc1
    buffer_load_dwordx4 v[92:95], v159, s[48:51], s60 offen offset:3584 sc1
    s_mov_b64 exec, -1
    s_mov_b64 exec, 1
    ds_inc_u32 v166, v164 offset:312
    s_mov_b64 exec, -1
L_fb0:
    s_waitcnt vmcnt(0)
    v_and_b32 v144, 31, v167
    v_lshlrev_b32 v144, 2, v144
    v_add_u32 v144, 65536, v144
    s_lshl_b32 s70, s3, 7
    v_add_u32 v147, s70, v144
    v_mov_b32 v146, 0xff800000
    ds_write_b32 v147, v146 offset:4096
    s_mov_b64 exec, 1
    ds_inc_u32 v166, v164 offset:72
    s_mov_b64 exec, -1
    s_mov_b32 s76, 0x40000
L_spin_57:
    ds_read_b32 v146, v166 offset:72
    s_waitcnt lgkmcnt(0)
    v_readfirstlane_b32 s77, v146
    s_nop 0
    s_cmp_ge_u32 s77, 8
    s_cbranch_scc1 L_spun_58
    s_sleep 1
    s_sub_u32 s76, s76, 1
    s_cbranch_scc0 L_spin_57
L_spun_58:
    v_mov_b32 v147, v144
    v_mov_b32 v145, v166
    s_mov_b32 s70, 0
L_fb1:
    ds_read_b128 v[160:163], v145 offset:1024
    v_mov_b32 v146, 0xff800000
    s_waitcnt lgkmcnt(0)
    v_mfma_f32_32x32x16_bf16 v[96:111], v[0:3], v[160:163], 0
    s_nop 11
    v_max3_f32 v146, v146, v96, v97
    v_max3_f32 v146, v146, v98, v99
    v_max3_f32 v146, v146, v100, v101
    v_max3_f32 v146, v146, v102, v103
    v_max3_f32 v146, v146, v104, v105
    v_max3_f32 v146, v146, v106, v107
    v_max3_f32 v146, v146, v108, v109
    v_max3_f32 v146, v146, v110, v111
    v_mfma_f32_32x32x16_bf16 v[96:111], v[4:7], v[160:163], 0
    s_nop 11
    v_max3_f32 v146, v146, v96, v97
    v_max3_f32 v146, v146, v98, v99
    v_max3_f32 v146, v146, v100, v101
    v_max3_f32 v146, v146, v102, v103
    v_max3_f32 v146, v146, v104, v105
    v_max3_f32 v146, v146, v106, v107
    v_max3_f32 v146, v146, v108, v109
    v_max3_f32 v146, v146, v110, v111
    v_mfma_f32_32x32x16_bf16 v[96:111], v[8:11], v[160:163], 0
    s_nop 11
    v_max3_f32 v146, v146, v96, v97
    v_max3_f32 v146, v146, v98, v99
    v_max3_f32 v146, v146, v100, v101
    v_max3_f32 v146, v146, v102, v103
    v_max3_f32 v146, v146, v104, v105
    v_max3_f32 v146, v146, v106, v107
    v_max3_f32 v146, v146, v108, v109
    v_max3_f32 v146, v146, v110, v111
    v_mfma_f32_32x32x16_bf16 v[96:111], v[12:15], v[160:163], 0
    s_nop 11
    v_max3_f32 v146, v146, v96, v97
    v_max3_f32 v146, v146, v98, v99
    v_max3_f32 v146, v146, v100, v101
    v_max3_f32 v146, v146, v102, v103
    v_max3_f32 v146, v146, v104, v105
    v_max3_f32 v146, v146, v106, v107
    v_max3_f32 v146, v146, v108, v109
    v_max3_f32 v146, v146, v110, v111
    v_mfma_f32_32x32x16_bf16 v[96:111], v[16:19], v[160:163], 0
    s_nop 11
    v_max3_f32 v146, v146, v96, v97
    v_max3_f32 v146, v146, v98, v99
    v_max3_f32 v146, v146, v100, v101
    v_max3_f32 v146, v146, v102, v103
    v_max3_f32 v146, v146, v104, v105
    v_max3_f32 v146, v146, v106, v107
    v_max3_f32 v146, v146, v108, v109
    v_max3_f32 v146, v146, v110, v111
    v_mfma_f32_32x32x16_bf16 v[96:111], v[20:23], v[160:163], 0
    s_nop 11
    v_max3_f32 v146, v146, v96, v97
    v_max3_f32 v146, v146, v98, v99
    v_max3_f32 v146, v146, v100, v101
    v_max3_f32 v146, v146, v102, v103
    v_max3_f32 v146, v146, v104, v105
    v_max3_f32 v146, v146, v106, v107
    v_max3_f32 v146, v146, v108, v109
    v_max3_f32 v146, v146, v110, v111
    v_mfma_f32_32x32x16_bf16 v[96:111], v[24:27], v[160:163], 0
    s_nop 11
    v_max3_f32 v146, v146, v96, v97
    v_max3_f32 v146, v146, v98, v99
    v_max3_f32 v146, v146, v100, v101
    v_max3_f32 v146, v146, v102, v103
    v_max3_f32 v146, v146, v104, v105
    v_max3_f32 v146, v146, v106, v107
    v_max3_f32 v146, v146, v108, v109
    v_max3_f32 v146, v146, v110, v111
    v_mfma_f32_32x32x16_bf16 v[96:111], v[28:31], v[160:163], 0
    s_nop 11
    v_max3_f32 v146, v146, v96, v97
    v_max3_f32 v146, v146, v98, v99
    v_max3_f32 v146, v146, v100, v101
    v_max3_f32 v146, v146, v102, v103
    v_max3_f32 v146, v146, v104, v105
    v_max3_f32 v146, v146, v106, v107
    v_max3_f32 v146, v146, v108, v109
    v_max3_f32 v146, v146, v110, v111
    ds_max_f32 v147, v146 offset:4096
    v_add_u32 v147, 128, v147
    v_add_u32 v145, 6144, v145
    s_add_u32 s70, s70, 1
    s_cmp_lt_u32 s70, 8
    s_cbranch_scc1 L_fb1
    s_waitcnt lgkmcnt(0)
    s_mov_b64 exec, 1
    ds_inc_u32 v166, v164 offset:264
    s_mov_b64 exec, -1
    s_mov_b32 s76, 0x40000
L_spin_59:
    ds_read_b32 v146, v166 offset:264
    s_waitcnt lgkmcnt(0)
    v_readfirstlane_b32 s77, v146
    s_nop 0
    s_cmp_ge_u32 s77, 8
    s_cbranch_scc1 L_spun_60
    s_sleep 1
    s_sub_u32 s76, s76, 1
    s_cbranch_scc0 L_spin_59
L_spun_60:
    s_mov_b32 s70, 0
L_fb2:
    s_lshr_b32 s71, s70, 1
    s_add_u32 s72, s71, s3
    s_and_b32 s72, s72, 3
    s_and_b32 s73, s70, 1
    s_lshl_b32 s74, s73, 2
    s_add_u32 s72, s72, s74
    s_lshl_b32 s71, s71, 1
    s_add_u32 s67, s71, s68
    s_mul_i32 s74, s72, 6144
    v_add_u32 v165, s74, v166
    s_lshl_b32 s74, s72, 7
    v_add_u32 v147, s74, v144
    ds_read_b128 v[160:163], v165 offset:1024
    ds_read_b32 v146, v147 offset:4096
    s_mov_b32 s76, 0x40000
L_fb3:
    ds_read_b32 v137, v165 offset:8
    ds_read_b128 v[128:131], v165 offset:2048
    ds_read_b128 v[132:135], v165 offset:3072
    ds_read_b32 v136, v165 offset:0
    s_waitcnt lgkmcnt(0)
    v_readfirstlane_b32 s66, v137
    s_nop 0
    s_cmp_ge_u32 s66, s67
    s_cbranch_scc1 L_fb3b
    s_sleep 1
    s_sub_u32 s76, s76, 1
    s_cbranch_scc0 L_fb3
L_fb3b:
    s_cmp_eq_u32 s67, 0
    s_cbranch_scc0 L_fb4
    v_mov_b32 v128, 0
    v_mov_b32 v129, 0
    v_mov_b32 v130, 0
    v_mov_b32 v131, 0
    v_mov_b32 v132, 0
    v_mov_b32 v133, 0
    v_mov_b32 v134, 0
    v_mov_b32 v135, 0
    v_mov_b32 v136, 0
L_fb4:
    v_mfma_f32_32x32x16_bf16 v[96:111], v[0:3], v[160:163], 0
    s_nop 11
    v_sub_f32 v96, v96, v146
    v_sub_f32 v97, v97, v146
    v_sub_f32 v98, v98, v146
    v_sub_f32 v99, v99, v146
    v_sub_f32 v100, v100, v146
    v_sub_f32 v101, v101, v146
    v_sub_f32 v102, v102, v146
    v_sub_f32 v103, v103, v146
    v_sub_f32 v104, v104, v146
    v_sub_f32 v105, v105, v146
    v_sub_f32 v106, v106, v146
    v_sub_f32 v107, v107, v146
    v_sub_f32 v108, v108, v146
    v_sub_f32 v109, v109, v146
    v_sub_f32 v110, v110, v146
    v_sub_f32 v111, v111, v146
    v_exp_f32 v96, v96
    v_exp_f32 v97, v97
    v_exp_f32 v98, v98
    v_exp_f32 v99, v99
    v_exp_f32 v100, v100
    v_exp_f32 v101, v101
    v_exp_f32 v102, v102
    v_exp_f32 v103, v103
    v_exp_f32 v104, v104
    v_exp_f32 v105, v105
    v_exp_f32 v106, v106
    v_exp_f32 v107, v107
    v_exp_f32 v108, v108
    v_exp_f32 v109, v109
    v_exp_f32 v110, v110
    v_exp_f32 v111, v111
    v_smfmac_f32_32x32x32_bf16 v[128:143], v[32:35], v[96:103], v164
    s_nop 0
    v_smfmac_f32_32x32x32_bf16 v[128:143], v[36:39], v[104:111], v164
    v_mfma_f32_32x32x16_bf16 v[96:111], v[4:7], v[160:163], 0
    s_nop 11
    v_sub_f32 v96, v96, v146
    v_sub_f32 v97, v97, v146
    v_sub_f32 v98, v98, v146
    v_sub_f32 v99, v99, v146
    v_sub_f32 v100, v100, v146
    v_sub_f32 v101, v101, v146
    v_sub_f32 v102, v102, v146
    v_sub_f32 v103, v103, v146
    v_sub_f32 v104, v104, v146
    v_sub_f32 v105, v105, v146
    v_sub_f32 v106, v106, v146
    v_sub_f32 v107, v107, v146
    v_sub_f32 v108, v108, v146
    v_sub_f32 v109, v109, v146
    v_sub_f32 v110, v110, v146
    v_sub_f32 v111, v111, v146
    v_exp_f32 v96, v96
    v_exp_f32 v97, v97
    v_exp_f32 v98, v98
    v_exp_f32 v99, v99
    v_exp_f32 v100, v100
    v_exp_f32 v101, v101
    v_exp_f32 v102, v102
    v_exp_f32 v103, v103
    v_exp_f32 v104, v104
    v_exp_f32 v105, v105
    v_exp_f32 v106, v106
    v_exp_f32 v107, v107
    v_exp_f32 v108, v108
    v_exp_f32 v109, v109
    v_exp_f32 v110, v110
    v_exp_f32 v111, v111
    v_smfmac_f32_32x32x32_bf16 v[128:143], v[40:43], v[96:103], v164
    s_nop 0
    v_smfmac_f32_32x32x32_bf16 v[128:143], v[44:47], v[104:111], v164
    v_mfma_f32_32x32x16_bf16 v[96:111], v[8:11], v[160:163], 0
    s_nop 11
    v_sub_f32 v96, v96, v146
    v_sub_f32 v97, v97, v146
    v_sub_f32 v98, v98, v146
    v_sub_f32 v99, v99, v146
    v_sub_f32 v100, v100, v146
    v_sub_f32 v101, v101, v146
    v_sub_f32 v102, v102, v146
    v_sub_f32 v103, v103, v146
    v_sub_f32 v104, v104, v146
    v_sub_f32 v105, v105, v146
    v_sub_f32 v106, v106, v146
    v_sub_f32 v107, v107, v146
    v_sub_f32 v108, v108, v146
    v_sub_f32 v109, v109, v146
    v_sub_f32 v110, v110, v146
    v_sub_f32 v111, v111, v146
    v_exp_f32 v96, v96
    v_exp_f32 v97, v97
    v_exp_f32 v98, v98
    v_exp_f32 v99, v99
    v_exp_f32 v100, v100
    v_exp_f32 v101, v101
    v_exp_f32 v102, v102
    v_exp_f32 v103, v103
    v_exp_f32 v104, v104
    v_exp_f32 v105, v105
    v_exp_f32 v106, v106
    v_exp_f32 v107, v107
    v_exp_f32 v108, v108
    v_exp_f32 v109, v109
    v_exp_f32 v110, v110
    v_exp_f32 v111, v111
    v_smfmac_f32_32x32x32_bf16 v[128:143], v[48:51], v[96:103], v164
    s_nop 0
    v_smfmac_f32_32x32x32_bf16 v[128:143], v[52:55], v[104:111], v164
    v_mfma_f32_32x32x16_bf16 v[96:111], v[12:15], v[160:163], 0
    s_nop 11
    v_sub_f32 v96, v96, v146
    v_sub_f32 v97, v97, v146
    v_sub_f32 v98, v98, v146
    v_sub_f32 v99, v99, v146
    v_sub_f32 v100, v100, v146
    v_sub_f32 v101, v101, v146
    v_sub_f32 v102, v102, v146
    v_sub_f32 v103, v103, v146
    v_sub_f32 v104, v104, v146
    v_sub_f32 v105, v105, v146
    v_sub_f32 v106, v106, v146
    v_sub_f32 v107, v107, v146
    v_sub_f32 v108, v108, v146
    v_sub_f32 v109, v109, v146
    v_sub_f32 v110, v110, v146
    v_sub_f32 v111, v111, v146
    v_exp_f32 v96, v96
    v_exp_f32 v97, v97
    v_exp_f32 v98, v98
    v_exp_f32 v99, v99
    v_exp_f32 v100, v100
    v_exp_f32 v101, v101
    v_exp_f32 v102, v102
    v_exp_f32 v103, v103
    v_exp_f32 v104, v104
    v_exp_f32 v105, v105
    v_exp_f32 v106, v106
    v_exp_f32 v107, v107
    v_exp_f32 v108, v108
    v_exp_f32 v109, v109
    v_exp_f32 v110, v110
    v_exp_f32 v111, v111
    v_smfmac_f32_32x32x32_bf16 v[128:143], v[56:59], v[96:103], v164
    s_nop 0
    v_smfmac_f32_32x32x32_bf16 v[128:143], v[60:63], v[104:111], v164
    v_mfma_f32_32x32x16_bf16 v[96:111], v[16:19], v[160:163], 0
    s_nop 11
    v_sub_f32 v96, v96, v146
    v_sub_f32 v97, v97, v146
    v_sub_f32 v98, v98, v146
    v_sub_f32 v99, v99, v146
    v_sub_f32 v100, v100, v146
    v_sub_f32 v101, v101, v146
    v_sub_f32 v102, v102, v146
    v_sub_f32 v103, v103, v146
    v_sub_f32 v104, v104, v146
    v_sub_f32 v105, v105, v146
    v_sub_f32 v106, v106, v146
    v_sub_f32 v107, v107, v146
    v_sub_f32 v108, v108, v146
    v_sub_f32 v109, v109, v146
    v_sub_f32 v110, v110, v146
    v_sub_f32 v111, v111, v146
    v_exp_f32 v96, v96
    v_exp_f32 v97, v97
    v_exp_f32 v98, v98
    v_exp_f32 v99, v99
    v_exp_f32 v100, v100
    v_exp_f32 v101, v101
    v_exp_f32 v102, v102
    v_exp_f32 v103, v103
    v_exp_f32 v104, v104
    v_exp_f32 v105, v105
    v_exp_f32 v106, v106
    v_exp_f32 v107, v107
    v_exp_f32 v108, v108
    v_exp_f32 v109, v109
    v_exp_f32 v110, v110
    v_exp_f32 v111, v111
    v_smfmac_f32_32x32x32_bf16 v[128:143], v[64:67], v[96:103], v164
    s_nop 0
    v_smfmac_f32_32x32x32_bf16 v[128:143], v[68:71], v[104:111], v164
    v_mfma_f32_32x32x16_bf16 v[96:111], v[20:23], v[160:163], 0
    s_nop 11
    v_sub_f32 v96, v96, v146
    v_sub_f32 v97, v97, v146
    v_sub_f32 v98, v98, v146
    v_sub_f32 v99, v99, v146
    v_sub_f32 v100, v100, v146
    v_sub_f32 v101, v101, v146
    v_sub_f32 v102, v102, v146
    v_sub_f32 v103, v103, v146
    v_sub_f32 v104, v104, v146
    v_sub_f32 v105, v105, v146
    v_sub_f32 v106, v106, v146
    v_sub_f32 v107, v107, v146
    v_sub_f32 v108, v108, v146
    v_sub_f32 v109, v109, v146
    v_sub_f32 v110, v110, v146
    v_sub_f32 v111, v111, v146
    v_exp_f32 v96, v96
    v_exp_f32 v97, v97
    v_exp_f32 v98, v98
    v_exp_f32 v99, v99
    v_exp_f32 v100, v100
    v_exp_f32 v101, v101
    v_exp_f32 v102, v102
    v_exp_f32 v103, v103
    v_exp_f32 v104, v104
    v_exp_f32 v105, v105
    v_exp_f32 v106, v106
    v_exp_f32 v107, v107
    v_exp_f32 v108, v108
    v_exp_f32 v109, v109
    v_exp_f32 v110, v110
    v_exp_f32 v111, v111
    v_smfmac_f32_32x32x32_bf16 v[128:143], v[72:75], v[96:103], v164
    s_nop 0
    v_smfmac_f32_32x32x32_bf16 v[128:143], v[76:79], v[104:111], v164
    v_mfma_f32_32x32x16_bf16 v[96:111], v[24:27], v[160:163], 0
    s_nop 11
    v_sub_f32 v96, v96, v146
    v_sub_f32 v97, v97, v146
    v_sub_f32 v98, v98, v146
    v_sub_f32 v99, v99, v146
    v_sub_f32 v100, v100, v146
    v_sub_f32 v101, v101, v146
    v_sub_f32 v102, v102, v146
    v_sub_f32 v103, v103, v146
    v_sub_f32 v104, v104, v146
    v_sub_f32 v105, v105, v146
    v_sub_f32 v106, v106, v146
    v_sub_f32 v107, v107, v146
    v_sub_f32 v108, v108, v146
    v_sub_f32 v109, v109, v146
    v_sub_f32 v110, v110, v146
    v_sub_f32 v111, v111, v146
    v_exp_f32 v96, v96
    v_exp_f32 v97, v97
    v_exp_f32 v98, v98
    v_exp_f32 v99, v99
    v_exp_f32 v100, v100
    v_exp_f32 v101, v101
    v_exp_f32 v102, v102
    v_exp_f32 v103, v103
    v_exp_f32 v104, v104
    v_exp_f32 v105, v105
    v_exp_f32 v106, v106
    v_exp_f32 v107, v107
    v_exp_f32 v108, v108
    v_exp_f32 v109, v109
    v_exp_f32 v110, v110
    v_exp_f32 v111, v111
    v_smfmac_f32_32x32x32_bf16 v[128:143], v[80:83], v[96:103], v164
    s_nop 0
    v_smfmac_f32_32x32x32_bf16 v[128:143], v[84:87], v[104:111], v164
    v_mfma_f32_32x32x16_bf16 v[96:111], v[28:31], v[160:163], 0
    s_nop 11
    v_sub_f32 v96, v96, v146
    v_sub_f32 v97, v97, v146
    v_sub_f32 v98, v98, v146
    v_sub_f32 v99, v99, v146
    v_sub_f32 v100, v100, v146
    v_sub_f32 v101, v101, v146
    v_sub_f32 v102, v102, v146
    v_sub_f32 v103, v103, v146
    v_sub_f32 v104, v104, v146
    v_sub_f32 v105, v105, v146
    v_sub_f32 v106, v106, v146
    v_sub_f32 v107, v107, v146
    v_sub_f32 v108, v108, v146
    v_sub_f32 v109, v109, v146
    v_sub_f32 v110, v110, v146
    v_sub_f32 v111, v111, v146
    v_exp_f32 v96, v96
    v_exp_f32 v97, v97
    v_exp_f32 v98, v98
    v_exp_f32 v99, v99
    v_exp_f32 v100, v100
    v_exp_f32 v101, v101
    v_exp_f32 v102, v102
    v_exp_f32 v103, v103
    v_exp_f32 v104, v104
    v_exp_f32 v105, v105
    v_exp_f32 v106, v106
    v_exp_f32 v107, v107
    v_exp_f32 v108, v108
    v_exp_f32 v109, v109
    v_exp_f32 v110, v110
    v_exp_f32 v111, v111
    v_smfmac_f32_32x32x32_bf16 v[128:143], v[88:91], v[96:103], v164
    s_nop 0
    v_smfmac_f32_32x32x32_bf16 v[128:143], v[92:95], v[104:111], v164
    s_cmp_eq_u32 s67, 7
    s_cbranch_scc1 L_fb5
    s_nop 9
    ds_write_b128 v165, v[128:131] offset:2048
    ds_write_b128 v165, v[132:135] offset:3072
    ds_write_b32 v165, v136 offset:0
    s_mov_b64 exec, 1
    ds_inc_u32 v165, v164 offset:8
    s_mov_b64 exec, -1
    s_branch L_fb6
L_fb5:
    s_cmp_eq_u32 s73, 0
    s_cbranch_scc0 L_fb7
    s_nop 7
    v_rcp_f32 v136, v136
    s_add_u32 s66, s75, s69
    v_pk_mul_f32 v[128:129], v[128:129], v[136:137] op_sel_hi:[1,0]
    v_pk_mul_f32 v[130:131], v[130:131], v[136:137] op_sel_hi:[1,0]
    v_pk_mul_f32 v[132:133], v[132:133], v[136:137] op_sel_hi:[1,0]
    v_pk_mul_f32 v[134:135], v[134:135], v[136:137] op_sel_hi:[1,0]
    v_cvt_pk_bf16_f32 v140, v128, v129
    v_cvt_pk_bf16_f32 v141, v130, v131
    v_cvt_pk_bf16_f32 v142, v132, v133
    v_cvt_pk_bf16_f32 v143, v134, v135
    buffer_store_dwordx4 v[140:143], v166, s[48:51], s66 offen sc1
    s_lshl_b32 s56, s4, 12
    s_lshl_b32 s57, s5, 9
    s_add_u32 s56, s56, s57
    s_lshr_b32 s57, s75, 3
    s_add_u32 s56, s56, s57
    s_add_u32 s56, s56, 8126464
    v_mov_b32 v148, s6
    v_mbcnt_lo_u32_b32 v149, -1, 0
    v_lshlrev_b32 v149, 2, v149
    s_mov_b32 exec_hi, 0
    s_waitcnt vmcnt(0)
    buffer_store_dword v148, v149, s[48:51], s56 offen sc1
    s_mov_b64 exec, -1
    s_branch L_fb6
L_fb7:
    s_nop 7
    v_rcp_f32 v136, v136
    s_add_u32 s66, s75, s69
    s_add_u32 s66, s66, 0x8000
    v_pk_mul_f32 v[128:129], v[128:129], v[136:137] op_sel_hi:[1,0]
    v_pk_mul_f32 v[130:131], v[130:131], v[136:137] op_sel_hi:[1,0]
    v_pk_mul_f32 v[132:133], v[132:133], v[136:137] op_sel_hi:[1,0]
    v_pk_mul_f32 v[134:135], v[134:135], v[136:137] op_sel_hi:[1,0]
    v_cvt_pk_bf16_f32 v140, v128, v129
    v_cvt_pk_bf16_f32 v141, v130, v131
    v_cvt_pk_bf16_f32 v142, v132, v133
    v_cvt_pk_bf16_f32 v143, v134, v135
    buffer_store_dwordx4 v[140:143], v166, s[48:51], s66 offen sc1
    s_lshl_b32 s56, s4, 12
    s_lshl_b32 s57, s5, 9
    s_add_u32 s56, s56, s57
    s_lshr_b32 s57, s75, 3
    s_add_u32 s56, s56, s57
    s_add_u32 s56, s56, 8257536
    v_mov_b32 v148, s6
    v_mbcnt_lo_u32_b32 v149, -1, 0
    v_lshlrev_b32 v149, 2, v149
    s_mov_b32 exec_hi, 0
    s_waitcnt vmcnt(0)
    buffer_store_dword v148, v149, s[48:51], s56 offen sc1
    s_mov_b64 exec, -1
    s_mov_b64 exec, 1
    ds_inc_u32 v166, v164 offset:248
    s_mov_b64 exec, -1
L_fb6:
    s_add_u32 s70, s70, 1
    s_cmp_lt_u32 s70, 8
    s_cbranch_scc1 L_fb2
    s_branch L_A_end
L_G:
    s_cmp_ge_u32 s3, 10
    s_cbranch_scc0 L_G_nocpfa
    s_getpc_b64 s[60:61]
L_pcrefa:
    s_sub_u32 s60, s60, L_pcrefa-L_start
    s_subb_u32 s61, s61, 0
    s_lshr_b32 s57, s2, 3
    s_sub_u32 s58, s3, 10
    s_lshl_b32 s58, s58, 4
    s_xor_b32 s57, s57, s58
    s_mul_i32 s57, s57, 1408
    v_min_u32 v156, 10, v167
    v_lshl_add_u32 v156, v156, 7, s57
    v_min_u32 v156, L_end-L_start, v156
    v_mov_b32 v155, s61
    v_add_co_u32 v154, vcc, s60, v156
    s_nop 1
    v_addc_co_u32 v155, vcc, 0, v155, vcc
    global_load_dword v156, v[154:155], off
L_G_nocpfa:
    s_sub_u32 s64, s3, 8
    s_lshr_b32 s65, s64, 1
    s_and_b32 s66, s64, 1
    s_max_u32 s56, s5, 4
    s_sub_u32 s56, s56, 4
    s_min_u32 s56, s56, 3
    s_mul_i32 s67, s5, 5
    s_add_u32 s67, s67, s56
    s_mul_i32 s56, s65, 3
    s_add_u32 s67, s67, s56
    s_sub_u32 s56, s5, 4
    s_cmp_lt_u32 s56, 3
    s_cselect_b32 s68, 1, 0
    s_cmp_eq_u32 s65, 0
    s_cselect_b32 s68, 1, s68
    s_mul_i32 s69, s64, 12288
    s_add_u32 s69, s69, 114688
    s_mul_i32 s70, s66, 704512
    s_lshl_b32 s56, s67, 6
    s_add_u32 s70, s70, s56
    s_mul_i32 s56, s7, 176128
    s_add_u32 s70, s70, s56
    s_waitcnt lgkmcnt(0)
    s_mov_b32 s48, s30
    s_mov_b32 s49, s31
    s_mov_b32 s50, 9437184
    s_mov_b32 s51, 0x20000
    s_barrier
    s_mov_b32 s32, s20
    s_mov_b32 s33, s21
    s_mov_b32 s34, 1409024
    s_mov_b32 s35, 0x20000
    s_mov_b32 s36, s22
    s_mov_b32 s37, s23
    s_mov_b32 s38, 2752
    s_mov_b32 s39, 0x20000
    v_lshlrev_b32 v150, 1, v167
    v_cmp_gt_u32 vcc, 32, v167
    v_mov_b32 v151, 0x10000
    s_nop 0
    v_cndmask_b32 v150, v151, v150, vcc
    s_lshl_b32 s56, s67, 6
    buffer_load_ushort v108, v150, s[36:39], s56 offen offset:0
    buffer_load_ushort v112, v150, s[36:39], s56 offen offset:64
    buffer_load_ushort v116, v150, s[36:39], s56 offen offset:128
    v_lshlrev_b32 v165, 2, v167
    v_lshlrev_b32 v166, 4, v167
    v_add_u32 v165, 65536, v165
    v_add_u32 v166, 65536, v166
    v_mov_b32 v164, 0xdddd
    s_mul_i32 s56, s66, 0xc000
    v_lshrrev_b32 v150, 5, v167
    v_and_b32 v151, 31, v167
    v_xor_b32 v151, v150, v151
    v_lshl_add_u32 v150, v150, 9, s56
    v_xor_b32 v136, 0, v151
    v_lshl_add_u32 v136, v136, 4, v150
    v_xor_b32 v140, 0x8000, v136
    v_xor_b32 v137, 2, v151
    v_lshl_add_u32 v137, v137, 4, v150
    v_xor_b32 v141, 0x8000, v137
    v_xor_b32 v138, 4, v151
    v_lshl_add_u32 v138, v138, 4, v150
    v_xor_b32 v142, 0x8000, v138
    v_xor_b32 v139, 6, v151
    v_lshl_add_u32 v139, v139, 4, v150
    v_xor_b32 v143, 0x8000, v139
    v_mov_b32 v109, 0
    v_mov_b32 v110, 0
    v_mov_b32 v111, 0
    v_mov_b32 v113, 0
    v_mov_b32 v114, 0
    v_mov_b32 v115, 0
    v_mov_b32 v117, 0
    v_mov_b32 v118, 0
    v_mov_b32 v119, 0
    v_mov_b32 v128, 0
    v_mov_b32 v129, 0
    v_mov_b32 v130, 0
    v_mov_b32 v131, 0
    s_mov_b32 s44, s10
    s_mov_b32 s45, s11
    s_mov_b32 s46, 524288
    s_mov_b32 s47, 0x20000
    v_lshrrev_b32 v150, 3, v167
    v_mul_u32_u24 v149, 1024, v150
    v_bfe_u32 v150, v167, 4, 1
    v_lshlrev_b32 v150, 2, v150
    v_xor_b32 v150, v150, v167
    v_and_b32 v150, 7, v150
    v_lshl_add_u32 v149, v150, 4, v149
    s_lshl_b32 s57, s64, 14
    s_add_u32 m0, s57, 98304
    s_lshl_b32 s58, s65, 18
    s_lshl_b32 s57, s5, 7
    s_add_u32 s58, s58, s57
    s_lshl_b32 s59, s66, 1
    s_add_u32 s59, s59, s7
    s_and_b32 s56, s59, 3
    s_lshl_b32 s56, s56, 16
    s_add_u32 s56, s56, s58
    buffer_load_dwordx4 v149, s[44:47], s56 offen lds
    s_add_u32 m0, m0, 0x400
    s_add_u32 s56, s56, 0x2000
    buffer_load_dwordx4 v149, s[44:47], s56 offen lds
    s_add_u32 m0, m0, 0x400
    s_add_u32 s56, s56, 0x2000
    buffer_load_dwordx4 v149, s[44:47], s56 offen lds
    s_add_u32 m0, m0, 0x400
    s_add_u32 s56, s56, 0x2000
    buffer_load_dwordx4 v149, s[44:47], s56 offen lds
    s_add_u32 m0, m0, 0x400
    s_add_u32 s56, s56, 0x2000
    buffer_load_dwordx4 v149, s[44:47], s56 offen lds
    s_add_u32 m0, m0, 0x400
    s_add_u32 s56, s56, 0x2000
    buffer_load_dwordx4 v149, s[44:47], s56 offen lds
    s_add_u32 m0, m0, 0x400
    s_add_u32 s56, s56, 0x2000
    buffer_load_dwordx4 v149, s[44:47], s56 offen lds
    s_add_u32 m0, m0, 0x400
    s_add_u32 s56, s56, 0x2000
    buffer_load_dwordx4 v149, s[44:47], s56 offen lds
    s_add_u32 m0, m0, 0x400
    s_add_u32 s56, s56, 0x2000
    s_add_u32 s59, s59, 1
    s_cmp_lt_u32 s5, 4
    s_cbranch_scc0 L_G_wq2
    s_mov_b32 s76, 0x40000
L_spin_61:
    ds_read_b32 v154, v165 offset:168
    s_waitcnt lgkmcnt(0)
    v_readfirstlane_b32 s77, v154
    s_nop 0
    s_cmp_ge_u32 s77, 4
    s_cbranch_scc1 L_spun_62
    s_sleep 1
    s_sub_u32 s76, s76, 1
    s_cbranch_scc0 L_spin_61
L_spun_62:
L_G_wq2:
    s_and_b32 s56, s59, 3
    s_lshl_b32 s56, s56, 16
    s_add_u32 s56, s56, s58
    buffer_load_dwordx4 v149, s[44:47], s56 offen lds
    s_add_u32 m0, m0, 0x400
    s_add_u32 s56, s56, 0x2000
    buffer_load_dwordx4 v149, s[44:47], s56 offen lds
    s_add_u32 m0, m0, 0x400
    s_add_u32 s56, s56, 0x2000
    buffer_load_dwordx4 v149, s[44:47], s56 offen lds
    s_add_u32 m0, m0, 0x400
    s_add_u32 s56, s56, 0x2000
    buffer_load_dwordx4 v149, s[44:47], s56 offen lds
    s_add_u32 m0, m0, 0x400
    s_add_u32 s56, s56, 0x2000
    buffer_load_dwordx4 v149, s[44:47], s56 offen lds
    s_add_u32 m0, m0, 0x400
    s_add_u32 s56, s56, 0x2000
    buffer_load_dwordx4 v149, s[44:47], s56 offen lds
    s_add_u32 m0, m0, 0x400
    s_add_u32 s56, s56, 0x2000
    buffer_load_dwordx4 v149, s[44:47], s56 offen lds
    s_add_u32 m0, m0, 0x400
    s_add_u32 s56, s56, 0x2000
    buffer_load_dwordx4 v149, s[44:47], s56 offen lds
    v_mov_b32 v159, v149
    v_add_u32 v160, 0x2000, v149
    v_lshrrev_b32 v150, 5, v167
    v_mul_u32_u24 v157, 512, v150
    v_bfe_u32 v150, v167, 2, 2
    v_lshl_add_u32 v157, v150, 7, v157
    v_bfe_u32 v150, v167, 3, 1
    v_lshl_add_u32 v157, v150, 6, v157
    v_bfe_u32 v150, v167, 4, 1
    v_lshl_add_u32 v157, v150, 5, v157
    v_and_b32 v150, 3, v167
    v_lshl_add_u32 v157, v150, 3, v157
    s_lshl_b32 s57, s66, 6
    v_xor_b32 v157, s57, v157
    s_lshl_b32 s57, s64, 14
    v_add_u32 v157, s57, v157
    v_xor_b32 v158, 64, v157
    v_lshrrev_b32 v150, 3, v167
    v_and_b32 v151, 7, v167
    v_lshlrev_b32 v150, 10, v150
    v_lshl_add_u32 v161, v151, 4, v150
    v_lshlrev_b32 v162, 4, v167
    v_lshlrev_b32 v163, 7, v167
    s_cmp_eq_u32 s68, 1
    s_cbranch_scc0 L_ffn1_2
    v_add_u32 v150, 0, v167
    v_mul_u32_u24 v151, 43691, v150
    v_lshrrev_b32 v151, 19, v151
    v_mul_u32_u24 v146, 2560, v151
    v_lshl_add_u32 v146, v150, 4, v146
    v_add_u32 v150, 64, v167
    v_mul_u32_u24 v151, 43691, v150
    v_lshrrev_b32 v151, 19, v151
    v_mul_u32_u24 v147, 2560, v151
    v_lshl_add_u32 v147, v150, 4, v147
    v_add_u32 v150, 128, v167
    v_mul_u32_u24 v151, 43691, v150
    v_lshrrev_b32 v151, 19, v151
    v_mul_u32_u24 v148, 2560, v151
    v_lshl_add_u32 v148, v150, 4, v148
    v_lshrrev_b32 v150, 5, v167
    v_bfe_u32 v151, v167, 2, 2
    v_lshl_add_u32 v150, v150, 3, v151
    v_mul_u32_u24 v144, 192, v150
    v_bfe_u32 v151, v167, 4, 1
    v_lshl_add_u32 v144, v151, 5, v144
    v_and_b32 v151, 3, v167
    v_lshl_add_u32 v144, v151, 3, v144
    v_add_u32 v144, s69, v144
    s_lshl_b32 s56, s66, 7
    v_and_b32 v150, 31, v167
    v_lshl_add_u32 v150, v150, 2, s56
    v_add_u32 v150, 65536, v150
    s_waitcnt vmcnt(0)
    s_mov_b64 exec, 1
    ds_inc_u32 v165, v164 offset:328
    s_mov_b64 exec, -1
    s_mov_b32 s76, 0x40000
L_spin_63:
    ds_read_b32 v154, v165 offset:328
    s_waitcnt lgkmcnt(0)
    v_readfirstlane_b32 s77, v154
    s_nop 0
    s_cmp_ge_u32 s77, 12
    s_cbranch_scc1 L_spun_64
    s_sleep 1
    s_sub_u32 s76, s76, 1
    s_cbranch_scc0 L_spin_63
L_spun_64:
    s_setprio 3
    s_mov_b32 s44, s24
    s_mov_b32 s45, s25
    s_mov_b32 s46, 1409024
    s_mov_b32 s47, 0x20000
    s_mov_b32 s40, s16
    s_mov_b32 s41, s17
    s_mov_b32 s42, 524288
    s_mov_b32 s43, 0x20000
    s_lshr_b32 s74, s2, 3
    s_lshl_b32 s74, s74, 2
    s_add_u32 s74, s74, s64
    s_lshl_b32 s75, s74, 12
    s_mul_i32 s74, s74, 11008
    ds_read_b32 v153, v165 offset:296
    ds_read_b32 v128, v150 offset:2304
    ds_read_b32 v152, v150 offset:2048
    s_mov_b64 exec, 1
    ds_inc_u32 v165, v164 offset:56
    s_mov_b64 exec, -1
    s_waitcnt lgkmcnt(1)
    v_readfirstlane_b32 s6, v153
    v_mfma_f32_32x32x16_bf16 v[0:15], v[108:111], v[128:131], 0
    v_mfma_f32_32x32x16_bf16 v[32:47], v[112:115], v[128:131], 0
    v_mfma_f32_32x32x16_bf16 v[64:79], v[116:119], v[128:131], 0
    s_mov_b32 s76, 0x40000
L_spin_65:
    ds_read_b32 v154, v165 offset:40
    s_waitcnt lgkmcnt(0)
    v_readfirstlane_b32 s77, v154
    s_nop 0
    s_cmp_ge_u32 s77, 4
    s_cbranch_scc1 L_spun_66
    s_sleep 1
    s_sub_u32 s76, s76, 1
    s_cbranch_scc0 L_spin_65
L_spun_66:
    s_mov_b32 s76, 0x40000
L_spin_67:
    ds_read_b32 v154, v165 offset:312
    s_waitcnt lgkmcnt(0)
    v_readfirstlane_b32 s77, v154
    s_nop 0
    s_cmp_ge_u32 s77, 4
    s_cbranch_scc1 L_spun_68
    s_sleep 1
    s_sub_u32 s76, s76, 1
    s_cbranch_scc0 L_spin_67
L_spun_68:
    s_add_u32 m0, s69, 0
    s_nop 0
    buffer_load_dwordx4 v146, s[32:35], s70 offen lds
    s_add_u32 m0, s69, 1024
    s_nop 0
    buffer_load_dwordx4 v147, s[32:35], s70 offen lds
    s_add_u32 m0, s69, 2048
    s_nop 0
    buffer_load_dwordx4 v148, s[32:35], s70 offen lds
    s_add_u32 s70, s70, 44032
    s_add_u32 m0, s69, 3072
    s_nop 0
    buffer_load_dwordx4 v146, s[32:35], s70 offen lds
    s_add_u32 m0, s69, 4096
    s_nop 0
    buffer_load_dwordx4 v147, s[32:35], s70 offen lds
    s_add_u32 m0, s69, 5120
    s_nop 0
    buffer_load_dwordx4 v148, s[32:35], s70 offen lds
    s_add_u32 s70, s70, 44032
    s_add_u32 m0, s69, 6144
    s_nop 0
    buffer_load_dwordx4 v146, s[32:35], s70 offen lds
    s_add_u32 m0, s69, 7168
    s_nop 0
    buffer_load_dwordx4 v147, s[32:35], s70 offen lds
    s_add_u32 m0, s69, 8192
    s_nop 0
    buffer_load_dwordx4 v148, s[32:35], s70 offen lds
    s_add_u32 s70, s70, 44032
    s_add_u32 m0, s69, 9216
    s_nop 0
    buffer_load_dwordx4 v146, s[32:35], s70 offen lds
    s_add_u32 m0, s69, 10240
    s_nop 0
    buffer_load_dwordx4 v147, s[32:35], s70 offen lds
    s_add_u32 m0, s69, 11264
    s_nop 0
    buffer_load_dwordx4 v148, s[32:35], s70 offen lds
    s_add_u32 s70, s70, 44032
    s_cmp_eq_u32 s7, 3
    s_cselect_b32 s58, 704512, 0
    s_sub_u32 s70, s70, s58
    s_setprio 0
    s_waitcnt vmcnt(9)
    ds_read_b64_tr_b16 v[96:97], v144 offset:0
    ds_read_b64_tr_b16 v[98:99], v144 offset:768
    ds_read_b128 v[120:123], v136 offset:0
    ds_read_b128 v[124:127], v140 offset:0
    ds_read_b64_tr_b16 v[100:101], v144 offset:64
    ds_read_b64_tr_b16 v[102:103], v144 offset:832
    ds_read_b64_tr_b16 v[104:105], v144 offset:128
    ds_read_b64_tr_b16 v[106:107], v144 offset:896
    s_waitcnt lgkmcnt(0)
    s_waitcnt vmcnt(6)
    ds_read_b64_tr_b16 v[108:109], v144 offset:3072
    ds_read_b64_tr_b16 v[110:111], v144 offset:3840
    v_mfma_f32_32x32x16_bf16 v[0:15], v[96:99], v[120:123], v[0:15]
    ds_read_b128 v[128:131], v137 offset:1024
    s_add_u32 m0, s69, 0
    v_mfma_f32_32x32x16_bf16 v[16:31], v[96:99], v[124:127], 0
    buffer_load_dwordx4 v146, s[32:35], s70 offen lds
    ds_read_b128 v[132:135], v141 offset:1024
    v_mfma_f32_32x32x16_bf16 v[32:47], v[100:103], v[120:123], v[32:47]
    ds_read_b64_tr_b16 v[112:113], v144 offset:3136
    ds_read_b64_tr_b16 v[114:115], v144 offset:3904
    s_add_u32 m0, s69, 1024
    v_mfma_f32_32x32x16_bf16 v[48:63], v[100:103], v[124:127], 0
    buffer_load_dwordx4 v147, s[32:35], s70 offen lds
    ds_read_b64_tr_b16 v[116:117], v144 offset:3200
    v_mfma_f32_32x32x16_bf16 v[64:79], v[104:107], v[120:123], v[64:79]
    ds_read_b64_tr_b16 v[118:119], v144 offset:3968
    s_add_u32 m0, s69, 2048
    v_mfma_f32_32x32x16_bf16 v[80:95], v[104:107], v[124:127], 0
    buffer_load_dwordx4 v148, s[32:35], s70 offen lds
    s_add_u32 s70, s70, 44032
    s_waitcnt lgkmcnt(0)
    s_waitcnt vmcnt(6)
    ds_read_b64_tr_b16 v[96:97], v144 offset:6144
    ds_read_b64_tr_b16 v[98:99], v144 offset:6912
    v_mfma_f32_32x32x16_bf16 v[0:15], v[108:111], v[128:131], v[0:15]
    ds_read_b128 v[120:123], v138 offset:2048
    s_add_u32 m0, s69, 3072
    v_mfma_f32_32x32x16_bf16 v[16:31], v[108:111], v[132:135], v[16:31]
    buffer_load_dwordx4 v146, s[32:35], s70 offen lds
    ds_read_b128 v[124:127], v142 offset:2048
    v_mfma_f32_32x32x16_bf16 v[32:47], v[112:115], v[128:131], v[32:47]
    ds_read_b64_tr_b16 v[100:101], v144 offset:6208
    ds_read_b64_tr_b16 v[102:103], v144 offset:6976
    s_add_u32 m0, s69, 4096
    v_mfma_f32_32x32x16_bf16 v[48:63], v[112:115], v[132:135], v[48:63]
    buffer_load_dwordx4 v147, s[32:35], s70 offen lds
    ds_read_b64_tr_b16 v[104:105], v144 offset:6272
    v_mfma_f32_32x32x16_bf16 v[64:79], v[116:119], v[128:131], v[64:79]
    ds_read_b64_tr_b16 v[106:107], v144 offset:7040
    s_add_u32 m0, s69, 5120
    v_mfma_f32_32x32x16_bf16 v[80:95], v[116:119], v[132:135], v[80:95]
    buffer_load_dwordx4 v148, s[32:35], s70 offen lds
    s_add_u32 s70, s70, 44032
    s_waitcnt lgkmcnt(0)
    s_waitcnt vmcnt(6)
    ds_read_b64_tr_b16 v[108:109], v144 offset:9216
    ds_read_b64_tr_b16 v[110:111], v144 offset:9984
    v_mfma_f32_32x32x16_bf16 v[0:15], v[96:99], v[120:123], v[0:15]
    ds_read_b128 v[128:131], v139 offset:3072
    s_add_u32 m0, s69, 6144
    v_mfma_f32_32x32x16_bf16 v[16:31], v[96:99], v[124:127], v[16:31]
    buffer_load_dwordx4 v146, s[32:35], s70 offen lds
    ds_read_b128 v[132:135], v143 offset:3072
    v_mfma_f32_32x32x16_bf16 v[32:47], v[100:103], v[120:123], v[32:47]
    ds_read_b64_tr_b16 v[112:113], v144 offset:9280
    ds_read_b64_tr_b16 v[114:115], v144 offset:10048
    s_add_u32 m0, s69, 7168
    v_mfma_f32_32x32x16_bf16 v[48:63], v[100:103], v[124:127], v[48:63]
    buffer_load_dwordx4 v147, s[32:35], s70 offen lds
    ds_read_b64_tr_b16 v[116:117], v144 offset:9344
    v_mfma_f32_32x32x16_bf16 v[64:79], v[104:107], v[120:123], v[64:79]
    ds_read_b64_tr_b16 v[118:119], v144 offset:10112
    s_add_u32 m0, s69, 8192
    v_mfma_f32_32x32x16_bf16 v[80:95], v[104:107], v[124:127], v[80:95]
    buffer_load_dwordx4 v148, s[32:35], s70 offen lds
    s_add_u32 s70, s70, 44032
    s_waitcnt lgkmcnt(0)
    s_waitcnt vmcnt(6)
    ds_read_b64_tr_b16 v[96:97], v144 offset:0
    ds_read_b64_tr_b16 v[98:99], v144 offset:768
    v_mfma_f32_32x32x16_bf16 v[0:15], v[108:111], v[128:131], v[0:15]
    ds_read_b128 v[120:123], v136 offset:4096
    s_add_u32 m0, s69, 9216
    v_mfma_f32_32x32x16_bf16 v[16:31], v[108:111], v[132:135], v[16:31]
    buffer_load_dwordx4 v146, s[32:35], s70 offen lds
    ds_read_b128 v[124:127], v140 offset:4096
    v_mfma_f32_32x32x16_bf16 v[32:47], v[112:115], v[128:131], v[32:47]
    ds_read_b64_tr_b16 v[100:101], v144 offset:64
    ds_read_b64_tr_b16 v[102:103], v144 offset:832
    s_add_u32 m0, s69, 10240
    v_mfma_f32_32x32x16_bf16 v[48:63], v[112:115], v[132:135], v[48:63]
    buffer_load_dwordx4 v147, s[32:35], s70 offen lds
    ds_read_b64_tr_b16 v[104:105], v144 offset:128
    v_mfma_f32_32x32x16_bf16 v[64:79], v[116:119], v[128:131], v[64:79]
    ds_read_b64_tr_b16 v[106:107], v144 offset:896
    s_add_u32 m0, s69, 11264
    v_mfma_f32_32x32x16_bf16 v[80:95], v[116:119], v[132:135], v[80:95]
    buffer_load_dwordx4 v148, s[32:35], s70 offen lds
    s_add_u32 s70, s70, 44032
    s_cmp_eq_u32 s7, 2
    s_cselect_b32 s58, 704512, 0
    s_sub_u32 s70, s70, s58
    s_waitcnt lgkmcnt(0)
    s_waitcnt vmcnt(6)
    ds_read_b64_tr_b16 v[108:109], v144 offset:3072
    ds_read_b64_tr_b16 v[110:111], v144 offset:3840
    v_mfma_f32_32x32x16_bf16 v[0:15], v[96:99], v[120:123], v[0:15]
    ds_read_b128 v[128:131], v137 offset:5120
    s_add_u32 m0, s69, 0
    v_mfma_f32_32x32x16_bf16 v[16:31], v[96:99], v[124:127], v[16:31]
    buffer_load_dwordx4 v146, s[32:35], s70 offen lds
    ds_read_b128 v[132:135], v141 offset:5120
    v_mfma_f32_32x32x16_bf16 v[32:47], v[100:103], v[120:123], v[32:47]
    ds_read_b64_tr_b16 v[112:113], v144 offset:3136
    ds_read_b64_tr_b16 v[114:115], v144 offset:3904
    s_add_u32 m0, s69, 1024
    v_mfma_f32_32x32x16_bf16 v[48:63], v[100:103], v[124:127], v[48:63]
    buffer_load_dwordx4 v147, s[32:35], s70 offen lds
    ds_read_b64_tr_b16 v[116:117], v144 offset:3200
    v_mfma_f32_32x32x16_bf16 v[64:79], v[104:107], v[120:123], v[64:79]
    ds_read_b64_tr_b16 v[118:119], v144 offset:3968
    s_add_u32 m0, s69, 2048
    v_mfma_f32_32x32x16_bf16 v[80:95], v[104:107], v[124:127], v[80:95]
    buffer_load_dwordx4 v148, s[32:35], s70 offen lds
    s_add_u32 s70, s70, 44032
    s_waitcnt lgkmcnt(0)
    s_waitcnt vmcnt(6)
    ds_read_b64_tr_b16 v[96:97], v144 offset:6144
    ds_read_b64_tr_b16 v[98:99], v144 offset:6912
    v_mfma_f32_32x32x16_bf16 v[0:15], v[108:111], v[128:131], v[0:15]
    ds_read_b128 v[120:123], v138 offset:6144
    s_add_u32 m0, s69, 3072
    v_mfma_f32_32x32x16_bf16 v[16:31], v[108:111], v[132:135], v[16:31]
    buffer_load_dwordx4 v146, s[32:35], s70 offen lds
    ds_read_b128 v[124:127], v142 offset:6144
    v_mfma_f32_32x32x16_bf16 v[32:47], v[112:115], v[128:131], v[32:47]
    ds_read_b64_tr_b16 v[100:101], v144 offset:6208
    ds_read_b64_tr_b16 v[102:103], v144 offset:6976
    s_add_u32 m0, s69, 4096
    v_mfma_f32_32x32x16_bf16 v[48:63], v[112:115], v[132:135], v[48:63]
    buffer_load_dwordx4 v147, s[32:35], s70 offen lds
    ds_read_b64_tr_b16 v[104:105], v144 offset:6272
    v_mfma_f32_32x32x16_bf16 v[64:79], v[116:119], v[128:131], v[64:79]
    ds_read_b64_tr_b16 v[106:107], v144 offset:7040
    s_add_u32 m0, s69, 5120
    v_mfma_f32_32x32x16_bf16 v[80:95], v[116:119], v[132:135], v[80:95]
    buffer_load_dwordx4 v148, s[32:35], s70 offen lds
    s_add_u32 s70, s70, 44032
    s_waitcnt lgkmcnt(0)
    s_waitcnt vmcnt(6)
    ds_read_b64_tr_b16 v[108:109], v144 offset:9216
    ds_read_b64_tr_b16 v[110:111], v144 offset:9984
    v_mfma_f32_32x32x16_bf16 v[0:15], v[96:99], v[120:123], v[0:15]
    ds_read_b128 v[128:131], v139 offset:7168
    s_add_u32 m0, s69, 6144
    v_mfma_f32_32x32x16_bf16 v[16:31], v[96:99], v[124:127], v[16:31]
    buffer_load_dwordx4 v146, s[32:35], s70 offen lds
    ds_read_b128 v[132:135], v143 offset:7168
    v_mfma_f32_32x32x16_bf16 v[32:47], v[100:103], v[120:123], v[32:47]
    ds_read_b64_tr_b16 v[112:113], v144 offset:9280
    ds_read_b64_tr_b16 v[114:115], v144 offset:10048
    s_add_u32 m0, s69, 7168
    v_mfma_f32_32x32x16_bf16 v[48:63], v[100:103], v[124:127], v[48:63]
    buffer_load_dwordx4 v147, s[32:35], s70 offen lds
    ds_read_b64_tr_b16 v[116:117], v144 offset:9344
    v_mfma_f32_32x32x16_bf16 v[64:79], v[104:107], v[120:123], v[64:79]
    ds_read_b64_tr_b16 v[118:119], v144 offset:10112
    s_add_u32 m0, s69, 8192
    v_mfma_f32_32x32x16_bf16 v[80:95], v[104:107], v[124:127], v[80:95]
    buffer_load_dwordx4 v148, s[32:35], s70 offen lds
    s_add_u32 s70, s70, 44032
    s_waitcnt lgkmcnt(0)
    s_waitcnt vmcnt(6)
    ds_read_b64_tr_b16 v[96:97], v144 offset:0
    ds_read_b64_tr_b16 v[98:99], v144 offset:768
    v_mfma_f32_32x32x16_bf16 v[0:15], v[108:111], v[128:131], v[0:15]
    ds_read_b128 v[120:123], v136 offset:8192
    s_add_u32 m0, s69, 9216
    v_mfma_f32_32x32x16_bf16 v[16:31], v[108:111], v[132:135], v[16:31]
    buffer_load_dwordx4 v146, s[32:35], s70 offen lds
    ds_read_b128 v[124:127], v140 offset:8192
    v_mfma_f32_32x32x16_bf16 v[32:47], v[112:115], v[128:131], v[32:47]
    ds_read_b64_tr_b16 v[100:101], v144 offset:64
    ds_read_b64_tr_b16 v[102:103], v144 offset:832
    s_add_u32 m0, s69, 10240
    v_mfma_f32_32x32x16_bf16 v[48:63], v[112:115], v[132:135], v[48:63]
    buffer_load_dwordx4 v147, s[32:35], s70 offen lds
    ds_read_b64_tr_b16 v[104:105], v144 offset:128
    v_mfma_f32_32x32x16_bf16 v[64:79], v[116:119], v[128:131], v[64:79]
    ds_read_b64_tr_b16 v[106:107], v144 offset:896
    s_add_u32 m0, s69, 11264
    v_mfma_f32_32x32x16_bf16 v[80:95], v[116:119], v[132:135], v[80:95]
    buffer_load_dwordx4 v148, s[32:35], s70 offen lds
    s_add_u32 s70, s70, 44032
    s_cmp_eq_u32 s7, 1
    s_cselect_b32 s58, 704512, 0
    s_sub_u32 s70, s70, s58
    s_waitcnt lgkmcnt(0)
    s_waitcnt vmcnt(6)
    ds_read_b64_tr_b16 v[108:109], v144 offset:3072
    ds_read_b64_tr_b16 v[110:111], v144 offset:3840
    v_mfma_f32_32x32x16_bf16 v[0:15], v[96:99], v[120:123], v[0:15]
    ds_read_b128 v[128:131], v137 offset:9216
    s_add_u32 m0, s69, 0
    v_mfma_f32_32x32x16_bf16 v[16:31], v[96:99], v[124:127], v[16:31]
    buffer_load_dwordx4 v146, s[32:35], s70 offen lds
    ds_read_b128 v[132:135], v141 offset:9216
    v_mfma_f32_32x32x16_bf16 v[32:47], v[100:103], v[120:123], v[32:47]
    ds_read_b64_tr_b16 v[112:113], v144 offset:3136
    ds_read_b64_tr_b16 v[114:115], v144 offset:3904
    s_add_u32 m0, s69, 1024
    v_mfma_f32_32x32x16_bf16 v[48:63], v[100:103], v[124:127], v[48:63]
    buffer_load_dwordx4 v147, s[32:35], s70 offen lds
    ds_read_b64_tr_b16 v[116:117], v144 offset:3200
    v_mfma_f32_32x32x16_bf16 v[64:79], v[104:107], v[120:123], v[64:79]
    ds_read_b64_tr_b16 v[118:119], v144 offset:3968
    s_add_u32 m0, s69, 2048
    v_mfma_f32_32x32x16_bf16 v[80:95], v[104:107], v[124:127], v[80:95]
    buffer_load_dwordx4 v148, s[32:35], s70 offen lds
    s_add_u32 s70, s70, 44032
    s_waitcnt lgkmcnt(0)
    s_waitcnt vmcnt(6)
    ds_read_b64_tr_b16 v[96:97], v144 offset:6144
    ds_read_b64_tr_b16 v[98:99], v144 offset:6912
    v_mfma_f32_32x32x16_bf16 v[0:15], v[108:111], v[128:131], v[0:15]
    buffer_load_dword v156, v163, s[44:47], s74 offen offset:0
    s_add_u32 s74, s74, 0x2000
    ds_read_b128 v[120:123], v138 offset:10240
    s_add_u32 m0, s69, 3072
    v_mfma_f32_32x32x16_bf16 v[16:31], v[108:111], v[132:135], v[16:31]
    buffer_load_dwordx4 v146, s[32:35], s70 offen lds
    ds_read_b128 v[124:127], v142 offset:10240
    v_mfma_f32_32x32x16_bf16 v[32:47], v[112:115], v[128:131], v[32:47]
    ds_read_b64_tr_b16 v[100:101], v144 offset:6208
    ds_read_b64_tr_b16 v[102:103], v144 offset:6976
    s_add_u32 m0, s69, 4096
    v_mfma_f32_32x32x16_bf16 v[48:63], v[112:115], v[132:135], v[48:63]
    buffer_load_dwordx4 v147, s[32:35], s70 offen lds
    ds_read_b64_tr_b16 v[104:105], v144 offset:6272
    v_mfma_f32_32x32x16_bf16 v[64:79], v[116:119], v[128:131], v[64:79]
    ds_read_b64_tr_b16 v[106:107], v144 offset:7040
    s_add_u32 m0, s69, 5120
    v_mfma_f32_32x32x16_bf16 v[80:95], v[116:119], v[132:135], v[80:95]
    buffer_load_dwordx4 v148, s[32:35], s70 offen lds
    s_add_u32 s70, s70, 44032
    s_waitcnt lgkmcnt(0)
    s_waitcnt vmcnt(7)
    ds_read_b64_tr_b16 v[108:109], v144 offset:9216
    ds_read_b64_tr_b16 v[110:111], v144 offset:9984
    v_mfma_f32_32x32x16_bf16 v[0:15], v[96:99], v[120:123], v[0:15]
    ds_read_b128 v[128:131], v139 offset:11264
    s_add_u32 m0, s69, 6144
    v_mfma_f32_32x32x16_bf16 v[16:31], v[96:99], v[124:127], v[16:31]
    buffer_load_dwordx4 v146, s[32:35], s70 offen lds
    ds_read_b128 v[132:135], v143 offset:11264
    v_mfma_f32_32x32x16_bf16 v[32:47], v[100:103], v[120:123], v[32:47]
    ds_read_b64_tr_b16 v[112:113], v144 offset:9280
    ds_read_b64_tr_b16 v[114:115], v144 offset:10048
    s_add_u32 m0, s69, 7168
    v_mfma_f32_32x32x16_bf16 v[48:63], v[100:103], v[124:127], v[48:63]
    buffer_load_dwordx4 v147, s[32:35], s70 offen lds
    ds_read_b64_tr_b16 v[116:117], v144 offset:9344
    v_mfma_f32_32x32x16_bf16 v[64:79], v[104:107], v[120:123], v[64:79]
    ds_read_b64_tr_b16 v[118:119], v144 offset:10112
    s_add_u32 m0, s69, 8192
    v_mfma_f32_32x32x16_bf16 v[80:95], v[104:107], v[124:127], v[80:95]
    buffer_load_dwordx4 v148, s[32:35], s70 offen lds
    s_add_u32 s70, s70, 44032
    s_waitcnt lgkmcnt(0)
    s_waitcnt vmcnt(7)
    ds_read_b64_tr_b16 v[96:97], v144 offset:0
    ds_read_b64_tr_b16 v[98:99], v144 offset:768
    v_mfma_f32_32x32x16_bf16 v[0:15], v[108:111], v[128:131], v[0:15]
    ds_read_b128 v[120:123], v136 offset:12288
    s_add_u32 m0, s69, 9216
    v_mfma_f32_32x32x16_bf16 v[16:31], v[108:111], v[132:135], v[16:31]
    buffer_load_dwordx4 v146, s[32:35], s70 offen lds
    ds_read_b128 v[124:127], v140 offset:12288
    v_mfma_f32_32x32x16_bf16 v[32:47], v[112:115], v[128:131], v[32:47]
    ds_read_b64_tr_b16 v[100:101], v144 offset:64
    ds_read_b64_tr_b16 v[102:103], v144 offset:832
    s_add_u32 m0, s69, 10240
    v_mfma_f32_32x32x16_bf16 v[48:63], v[112:115], v[132:135], v[48:63]
    buffer_load_dwordx4 v147, s[32:35], s70 offen lds
    ds_read_b64_tr_b16 v[104:105], v144 offset:128
    v_mfma_f32_32x32x16_bf16 v[64:79], v[116:119], v[128:131], v[64:79]
    ds_read_b64_tr_b16 v[106:107], v144 offset:896
    s_add_u32 m0, s69, 11264
    v_mfma_f32_32x32x16_bf16 v[80:95], v[116:119], v[132:135], v[80:95]
    buffer_load_dwordx4 v148, s[32:35], s70 offen lds
    s_add_u32 s70, s70, 44032
    s_waitcnt lgkmcnt(0)
    s_waitcnt vmcnt(6)
    ds_read_b64_tr_b16 v[108:109], v144 offset:3072
    ds_read_b64_tr_b16 v[110:111], v144 offset:3840
    v_mfma_f32_32x32x16_bf16 v[0:15], v[96:99], v[120:123], v[0:15]
    s_mov_b32 exec_hi, 0
    s_mov_b32 exec_lo, 0x3fffff
    buffer_load_dword v156, v163, s[44:47], s74 offen offset:0
    s_mov_b64 exec, -1
    ds_read_b128 v[128:131], v137 offset:13312
    v_mfma_f32_32x32x16_bf16 v[16:31], v[96:99], v[124:127], v[16:31]
    ds_read_b128 v[132:135], v141 offset:13312
    v_mfma_f32_32x32x16_bf16 v[32:47], v[100:103], v[120:123], v[32:47]
    ds_read_b64_tr_b16 v[112:113], v144 offset:3136
    ds_read_b64_tr_b16 v[114:115], v144 offset:3904
    v_mfma_f32_32x32x16_bf16 v[48:63], v[100:103], v[124:127], v[48:63]
    ds_read_b64_tr_b16 v[116:117], v144 offset:3200
    v_mfma_f32_32x32x16_bf16 v[64:79], v[104:107], v[120:123], v[64:79]
    ds_read_b64_tr_b16 v[118:119], v144 offset:3968
    v_mfma_f32_32x32x16_bf16 v[80:95], v[104:107], v[124:127], v[80:95]
    s_waitcnt lgkmcnt(0)
    s_waitcnt vmcnt(4)
    ds_read_b64_tr_b16 v[96:97], v144 offset:6144
    ds_read_b64_tr_b16 v[98:99], v144 offset:6912
    v_mfma_f32_32x32x16_bf16 v[0:15], v[108:111], v[128:131], v[0:15]
    ds_read_b128 v[120:123], v138 offset:14336
    v_mfma_f32_32x32x16_bf16 v[16:31], v[108:111], v[132:135], v[16:31]
    ds_read_b128 v[124:127], v142 offset:14336
    v_mfma_f32_32x32x16_bf16 v[32:47], v[112:115], v[128:131], v[32:47]
    ds_read_b64_tr_b16 v[100:101], v144 offset:6208
    ds_read_b64_tr_b16 v[102:103], v144 offset:6976
    v_mfma_f32_32x32x16_bf16 v[48:63], v[112:115], v[132:135], v[48:63]
    ds_read_b64_tr_b16 v[104:105], v144 offset:6272
    v_mfma_f32_32x32x16_bf16 v[64:79], v[116:119], v[128:131], v[64:79]
    ds_read_b64_tr_b16 v[106:107], v144 offset:7040
    v_mfma_f32_32x32x16_bf16 v[80:95], v[116:119], v[132:135], v[80:95]
    s_waitcnt lgkmcnt(0)
    s_waitcnt vmcnt(1)
    ds_read_b64_tr_b16 v[108:109], v144 offset:9216
    ds_read_b64_tr_b16 v[110:111], v144 offset:9984
    v_mfma_f32_32x32x16_bf16 v[0:15], v[96:99], v[120:123], v[0:15]
    s_mov_b32 exec_hi, 0
    buffer_load_dword v156, v163, s[40:43], s75 offen offset:0
    s_mov_b64 exec, -1
    ds_read_b128 v[128:131], v139 offset:15360
    v_mfma_f32_32x32x16_bf16 v[16:31], v[96:99], v[124:127], v[16:31]
    ds_read_b128 v[132:135], v143 offset:15360
    v_mfma_f32_32x32x16_bf16 v[32:47], v[100:103], v[120:123], v[32:47]
    ds_read_b64_tr_b16 v[112:113], v144 offset:9280
    ds_read_b64_tr_b16 v[114:115], v144 offset:10048
    v_mfma_f32_32x32x16_bf16 v[48:63], v[100:103], v[124:127], v[48:63]
    ds_read_b64_tr_b16 v[116:117], v144 offset:9344
    v_mfma_f32_32x32x16_bf16 v[64:79], v[104:107], v[120:123], v[64:79]
    ds_read_b64_tr_b16 v[118:119], v144 offset:10112
    v_mfma_f32_32x32x16_bf16 v[80:95], v[104:107], v[124:127], v[80:95]
    s_waitcnt lgkmcnt(0)
    v_mfma_f32_32x32x16_bf16 v[16:31], v[108:111], v[132:135], v[16:31]
    v_mfma_f32_32x32x16_bf16 v[48:63], v[112:115], v[132:135], v[48:63]
    v_mfma_f32_32x32x16_bf16 v[80:95], v[116:119], v[132:135], v[80:95]
    v_mfma_f32_32x32x16_bf16 v[0:15], v[108:111], v[128:131], v[0:15]
    v_mfma_f32_32x32x16_bf16 v[32:47], v[112:115], v[128:131], v[32:47]
    v_mfma_f32_32x32x16_bf16 v[64:79], v[116:119], v[128:131], v[64:79]
    s_branch L_ffn1_done
L_ffn1_2:
    v_lshrrev_b32 v150, 3, v167
    v_mul_u32_u24 v146, 2752, v150
    v_bfe_u32 v150, v167, 4, 1
    v_lshlrev_b32 v150, 2, v150
    v_xor_b32 v150, v150, v167
    v_and_b32 v150, 7, v150
    v_lshl_add_u32 v146, v150, 4, v146
    v_add_u32 v147, 22016, v146
    v_lshrrev_b32 v150, 5, v167
    v_mul_u32_u24 v144, 1024, v150
    v_bfe_u32 v150, v167, 2, 2
    v_lshl_add_u32 v144, v150, 7, v144
    v_bfe_u32 v150, v167, 3, 1
    v_lshl_add_u32 v144, v150, 6, v144
    v_bfe_u32 v150, v167, 4, 1
    v_lshl_add_u32 v144, v150, 5, v144
    v_and_b32 v150, 3, v167
    v_lshl_add_u32 v144, v150, 3, v144
    v_xor_b32 v145, 64, v144
    v_add_u32 v144, s69, v144
    v_add_u32 v145, s69, v145
    s_lshl_b32 s56, s66, 7
    v_and_b32 v150, 31, v167
    v_lshl_add_u32 v150, v150, 2, s56
    v_add_u32 v150, 65536, v150
    s_waitcnt vmcnt(0)
    s_mov_b64 exec, 1
    ds_inc_u32 v165, v164 offset:328
    s_mov_b64 exec, -1
    s_mov_b32 s76, 0x40000
L_spin_69:
    ds_read_b32 v154, v165 offset:328
    s_waitcnt lgkmcnt(0)
    v_readfirstlane_b32 s77, v154
    s_nop 0
    s_cmp_ge_u32 s77, 12
    s_cbranch_scc1 L_spun_70
    s_sleep 1
    s_sub_u32 s76, s76, 1
    s_cbranch_scc0 L_spin_69
L_spun_70:
    s_setprio 3
    s_mov_b32 s44, s24
    s_mov_b32 s45, s25
    s_mov_b32 s46, 1409024
    s_mov_b32 s47, 0x20000
    s_mov_b32 s40, s16
    s_mov_b32 s41, s17
    s_mov_b32 s42, 524288
    s_mov_b32 s43, 0x20000
    s_lshr_b32 s74, s2, 3
    s_lshl_b32 s74, s74, 2
    s_add_u32 s74, s74, s64
    s_lshl_b32 s75, s74, 12
    s_mul_i32 s74, s74, 11008
    ds_read_b32 v153, v165 offset:296
    ds_read_b32 v128, v150 offset:2304
    ds_read_b32 v152, v150 offset:2048
    s_mov_b64 exec, 1
    ds_inc_u32 v165, v164 offset:56
    s_mov_b64 exec, -1
    s_waitcnt lgkmcnt(1)
    v_readfirstlane_b32 s6, v153
    v_mfma_f32_32x32x16_bf16 v[0:15], v[108:111], v[128:131], 0
    v_mfma_f32_32x32x16_bf16 v[32:47], v[112:115], v[128:131], 0
    s_mov_b32 s76, 0x40000
L_spin_71:
    ds_read_b32 v154, v165 offset:40
    s_waitcnt lgkmcnt(0)
    v_readfirstlane_b32 s77, v154
    s_nop 0
    s_cmp_ge_u32 s77, 4
    s_cbranch_scc1 L_spun_72
    s_sleep 1
    s_sub_u32 s76, s76, 1
    s_cbranch_scc0 L_spin_71
L_spun_72:
    s_mov_b32 s76, 0x40000
L_spin_73:
    ds_read_b32 v154, v165 offset:312
    s_waitcnt lgkmcnt(0)
    v_readfirstlane_b32 s77, v154
    s_nop 0
    s_cmp_ge_u32 s77, 4
    s_cbranch_scc1 L_spun_74
    s_sleep 1
    s_sub_u32 s76, s76, 1
    s_cbranch_scc0 L_spin_73
L_spun_74:
    s_add_u32 m0, s69, 0
    s_nop 0
    buffer_load_dwordx4 v146, s[32:35], s70 offen lds
    s_add_u32 m0, s69, 1024
    s_nop 0
    buffer_load_dwordx4 v147, s[32:35], s70 offen lds
    s_add_u32 s70, s70, 44032
    s_add_u32 m0, s69, 3072
    s_nop 0
    buffer_load_dwordx4 v146, s[32:35], s70 offen lds
    s_add_u32 m0, s69, 4096
    s_nop 0
    buffer_load_dwordx4 v147, s[32:35], s70 offen lds
    s_add_u32 s70, s70, 44032
    s_add_u32 m0, s69, 6144
    s_nop 0
    buffer_load_dwordx4 v146, s[32:35], s70 offen lds
    s_add_u32 m0, s69, 7168
    s_nop 0
    buffer_load_dwordx4 v147, s[32:35], s70 offen lds
    s_add_u32 s70, s70, 44032
    s_add_u32 m0, s69, 9216
    s_nop 0
    buffer_load_dwordx4 v146, s[32:35], s70 offen lds
    s_add_u32 m0, s69, 10240
    s_nop 0
    buffer_load_dwordx4 v147, s[32:35], s70 offen lds
    s_add_u32 s70, s70, 44032
    s_cmp_eq_u32 s7, 3
    s_cselect_b32 s58, 704512, 0
    s_sub_u32 s70, s70, s58
    s_setprio 0
    s_waitcnt vmcnt(6)
    ds_read_b64_tr_b16 v[96:97], v144 offset:0
    ds_read_b64_tr_b16 v[98:99], v144 offset:512
    ds_read_b128 v[120:123], v136 offset:0
    ds_read_b128 v[124:127], v140 offset:0
    ds_read_b64_tr_b16 v[100:101], v145 offset:0
    ds_read_b64_tr_b16 v[102:103], v145 offset:512
    s_waitcnt lgkmcnt(0)
    s_waitcnt vmcnt(4)
    ds_read_b64_tr_b16 v[108:109], v144 offset:3072
    ds_read_b64_tr_b16 v[110:111], v144 offset:3584
    v_mfma_f32_32x32x16_bf16 v[0:15], v[96:99], v[120:123], v[0:15]
    ds_read_b128 v[128:131], v137 offset:1024
    s_add_u32 m0, s69, 0
    v_mfma_f32_32x32x16_bf16 v[16:31], v[96:99], v[124:127], 0
    buffer_load_dwordx4 v146, s[32:35], s70 offen lds
    ds_read_b128 v[132:135], v141 offset:1024
    ds_read_b64_tr_b16 v[112:113], v145 offset:3072
    v_mfma_f32_32x32x16_bf16 v[32:47], v[100:103], v[120:123], v[32:47]
    ds_read_b64_tr_b16 v[114:115], v145 offset:3584
    s_add_u32 m0, s69, 1024
    v_mfma_f32_32x32x16_bf16 v[48:63], v[100:103], v[124:127], 0
    buffer_load_dwordx4 v147, s[32:35], s70 offen lds
    s_add_u32 s70, s70, 44032
    s_waitcnt lgkmcnt(0)
    s_waitcnt vmcnt(4)
    ds_read_b64_tr_b16 v[96:97], v144 offset:6144
    ds_read_b64_tr_b16 v[98:99], v144 offset:6656
    v_mfma_f32_32x32x16_bf16 v[0:15], v[108:111], v[128:131], v[0:15]
    ds_read_b128 v[120:123], v138 offset:2048
    s_add_u32 m0, s69, 3072
    v_mfma_f32_32x32x16_bf16 v[16:31], v[108:111], v[132:135], v[16:31]
    buffer_load_dwordx4 v146, s[32:35], s70 offen lds
    ds_read_b128 v[124:127], v142 offset:2048
    ds_read_b64_tr_b16 v[100:101], v145 offset:6144
    v_mfma_f32_32x32x16_bf16 v[32:47], v[112:115], v[128:131], v[32:47]
    ds_read_b64_tr_b16 v[102:103], v145 offset:6656
    s_add_u32 m0, s69, 4096
    v_mfma_f32_32x32x16_bf16 v[48:63], v[112:115], v[132:135], v[48:63]
    buffer_load_dwordx4 v147, s[32:35], s70 offen lds
    s_add_u32 s70, s70, 44032
    s_waitcnt lgkmcnt(0)
    s_waitcnt vmcnt(4)
    ds_read_b64_tr_b16 v[108:109], v144 offset:9216
    ds_read_b64_tr_b16 v[110:111], v144 offset:9728
    v_mfma_f32_32x32x16_bf16 v[0:15], v[96:99], v[120:123], v[0:15]
    ds_read_b128 v[128:131], v139 offset:3072
    s_add_u32 m0, s69, 6144
    v_mfma_f32_32x32x16_bf16 v[16:31], v[96:99], v[124:127], v[16:31]
    buffer_load_dwordx4 v146, s[32:35], s70 offen lds
    ds_read_b128 v[132:135], v143 offset:3072
    ds_read_b64_tr_b16 v[112:113], v145 offset:9216
    v_mfma_f32_32x32x16_bf16 v[32:47], v[100:103], v[120:123], v[32:47]
    ds_read_b64_tr_b16 v[114:115], v145 offset:9728
    s_add_u32 m0, s69, 7168
    v_mfma_f32_32x32x16_bf16 v[48:63], v[100:103], v[124:127], v[48:63]
    buffer_load_dwordx4 v147, s[32:35], s70 offen lds
    s_add_u32 s70, s70, 44032
    s_waitcnt lgkmcnt(0)
    s_waitcnt vmcnt(4)
    ds_read_b64_tr_b16 v[96:97], v144 offset:0
    ds_read_b64_tr_b16 v[98:99], v144 offset:512
    v_mfma_f32_32x32x16_bf16 v[0:15], v[108:111], v[128:131], v[0:15]
    ds_read_b128 v[120:123], v136 offset:4096
    s_add_u32 m0, s69, 9216
    v_mfma_f32_32x32x16_bf16 v[16:31], v[108:111], v[132:135], v[16:31]
    buffer_load_dwordx4 v146, s[32:35], s70 offen lds
    ds_read_b128 v[124:127], v140 offset:4096
    ds_read_b64_tr_b16 v[100:101], v145 offset:0
    v_mfma_f32_32x32x16_bf16 v[32:47], v[112:115], v[128:131], v[32:47]
    ds_read_b64_tr_b16 v[102:103], v145 offset:512
    s_add_u32 m0, s69, 10240
    v_mfma_f32_32x32x16_bf16 v[48:63], v[112:115], v[132:135], v[48:63]
    buffer_load_dwordx4 v147, s[32:35], s70 offen lds
    s_add_u32 s70, s70, 44032
    s_cmp_eq_u32 s7, 2
    s_cselect_b32 s58, 704512, 0
    s_sub_u32 s70, s70, s58
    s_waitcnt lgkmcnt(0)
    s_waitcnt vmcnt(4)
    ds_read_b64_tr_b16 v[108:109], v144 offset:3072
    ds_read_b64_tr_b16 v[110:111], v144 offset:3584
    v_mfma_f32_32x32x16_bf16 v[0:15], v[96:99], v[120:123], v[0:15]
    ds_read_b128 v[128:131], v137 offset:5120
    s_add_u32 m0, s69, 0
    v_mfma_f32_32x32x16_bf16 v[16:31], v[96:99], v[124:127], v[16:31]
    buffer_load_dwordx4 v146, s[32:35], s70 offen lds
    ds_read_b128 v[132:135], v141 offset:5120
    ds_read_b64_tr_b16 v[112:113], v145 offset:3072
    v_mfma_f32_32x32x16_bf16 v[32:47], v[100:103], v[120:123], v[32:47]
    ds_read_b64_tr_b16 v[114:115], v145 offset:3584
    s_add_u32 m0, s69, 1024
    v_mfma_f32_32x32x16_bf16 v[48:63], v[100:103], v[124:127], v[48:63]
    buffer_load_dwordx4 v147, s[32:35], s70 offen lds
    s_add_u32 s70, s70, 44032
    s_waitcnt lgkmcnt(0)
    s_waitcnt vmcnt(4)
    ds_read_b64_tr_b16 v[96:97], v144 offset:6144
    ds_read_b64_tr_b16 v[98:99], v144 offset:6656
    v_mfma_f32_32x32x16_bf16 v[0:15], v[108:111], v[128:131], v[0:15]
    ds_read_b128 v[120:123], v138 offset:6144
    s_add_u32 m0, s69, 3072
    v_mfma_f32_32x32x16_bf16 v[16:31], v[108:111], v[132:135], v[16:31]
    buffer_load_dwordx4 v146, s[32:35], s70 offen lds
    ds_read_b128 v[124:127], v142 offset:6144
    ds_read_b64_tr_b16 v[100:101], v145 offset:6144
    v_mfma_f32_32x32x16_bf16 v[32:47], v[112:115], v[128:131], v[32:47]
    ds_read_b64_tr_b16 v[102:103], v145 offset:6656
    s_add_u32 m0, s69, 4096
    v_mfma_f32_32x32x16_bf16 v[48:63], v[112:115], v[132:135], v[48:63]
    buffer_load_dwordx4 v147, s[32:35], s70 offen lds
    s_add_u32 s70, s70, 44032
    s_waitcnt lgkmcnt(0)
    s_waitcnt vmcnt(4)
    ds_read_b64_tr_b16 v[108:109], v144 offset:9216
    ds_read_b64_tr_b16 v[110:111], v144 offset:9728
    v_mfma_f32_32x32x16_bf16 v[0:15], v[96:99], v[120:123], v[0:15]
    ds_read_b128 v[128:131], v139 offset:7168
    s_add_u32 m0, s69, 6144
    v_mfma_f32_32x32x16_bf16 v[16:31], v[96:99], v[124:127], v[16:31]
    buffer_load_dwordx4 v146, s[32:35], s70 offen lds
    ds_read_b128 v[132:135], v143 offset:7168
    ds_read_b64_tr_b16 v[112:113], v145 offset:9216
    v_mfma_f32_32x32x16_bf16 v[32:47], v[100:103], v[120:123], v[32:47]
    ds_read_b64_tr_b16 v[114:115], v145 offset:9728
    s_add_u32 m0, s69, 7168
    v_mfma_f32_32x32x16_bf16 v[48:63], v[100:103], v[124:127], v[48:63]
    buffer_load_dwordx4 v147, s[32:35], s70 offen lds
    s_add_u32 s70, s70, 44032
    s_waitcnt lgkmcnt(0)
    s_waitcnt vmcnt(4)
    ds_read_b64_tr_b16 v[96:97], v144 offset:0
    ds_read_b64_tr_b16 v[98:99], v144 offset:512
    v_mfma_f32_32x32x16_bf16 v[0:15], v[108:111], v[128:131], v[0:15]
    ds_read_b128 v[120:123], v136 offset:8192
    s_add_u32 m0, s69, 9216
    v_mfma_f32_32x32x16_bf16 v[16:31], v[108:111], v[132:135], v[16:31]
    buffer_load_dwordx4 v146, s[32:35], s70 offen lds
    ds_read_b128 v[124:127], v140 offset:8192
    ds_read_b64_tr_b16 v[100:101], v145 offset:0
    v_mfma_f32_32x32x16_bf16 v[32:47], v[112:115], v[128:131], v[32:47]
    ds_read_b64_tr_b16 v[102:103], v145 offset:512
    s_add_u32 m0, s69, 10240
    v_mfma_f32_32x32x16_bf16 v[48:63], v[112:115], v[132:135], v[48:63]
    buffer_load_dwordx4 v147, s[32:35], s70 offen lds
    s_add_u32 s70, s70, 44032
    s_cmp_eq_u32 s7, 1
    s_cselect_b32 s58, 704512, 0
    s_sub_u32 s70, s70, s58
    s_waitcnt lgkmcnt(0)
    s_waitcnt vmcnt(4)
    ds_read_b64_tr_b16 v[108:109], v144 offset:3072
    ds_read_b64_tr_b16 v[110:111], v144 offset:3584
    v_mfma_f32_32x32x16_bf16 v[0:15], v[96:99], v[120:123], v[0:15]
    ds_read_b128 v[128:131], v137 offset:9216
    s_add_u32 m0, s69, 0
    v_mfma_f32_32x32x16_bf16 v[16:31], v[96:99], v[124:127], v[16:31]
    buffer_load_dwordx4 v146, s[32:35], s70 offen lds
    ds_read_b128 v[132:135], v141 offset:9216
    ds_read_b64_tr_b16 v[112:113], v145 offset:3072
    v_mfma_f32_32x32x16_bf16 v[32:47], v[100:103], v[120:123], v[32:47]
    ds_read_b64_tr_b16 v[114:115], v145 offset:3584
    s_add_u32 m0, s69, 1024
    v_mfma_f32_32x32x16_bf16 v[48:63], v[100:103], v[124:127], v[48:63]
    buffer_load_dwordx4 v147, s[32:35], s70 offen lds
    s_add_u32 s70, s70, 44032
    s_waitcnt lgkmcnt(0)
    s_waitcnt vmcnt(4)
    ds_read_b64_tr_b16 v[96:97], v144 offset:6144
    ds_read_b64_tr_b16 v[98:99], v144 offset:6656
    v_mfma_f32_32x32x16_bf16 v[0:15], v[108:111], v[128:131], v[0:15]
    buffer_load_dword v156, v163, s[44:47], s74 offen offset:0
    s_add_u32 s74, s74, 0x2000
    ds_read_b128 v[120:123], v138 offset:10240
    s_add_u32 m0, s69, 3072
    v_mfma_f32_32x32x16_bf16 v[16:31], v[108:111], v[132:135], v[16:31]
    buffer_load_dwordx4 v146, s[32:35], s70 offen lds
    ds_read_b128 v[124:127], v142 offset:10240
    ds_read_b64_tr_b16 v[100:101], v145 offset:6144
    v_mfma_f32_32x32x16_bf16 v[32:47], v[112:115], v[128:131], v[32:47]
    ds_read_b64_tr_b16 v[102:103], v145 offset:6656
    s_add_u32 m0, s69, 4096
    v_mfma_f32_32x32x16_bf16 v[48:63], v[112:115], v[132:135], v[48:63]
    buffer_load_dwordx4 v147, s[32:35], s70 offen lds
    s_add_u32 s70, s70, 44032
    s_waitcnt lgkmcnt(0)
    s_waitcnt vmcnt(5)
    ds_read_b64_tr_b16 v[108:109], v144 offset:9216
    ds_read_b64_tr_b16 v[110:111], v144 offset:9728
    v_mfma_f32_32x32x16_bf16 v[0:15], v[96:99], v[120:123], v[0:15]
    ds_read_b128 v[128:131], v139 offset:11264
    s_add_u32 m0, s69, 6144
    v_mfma_f32_32x32x16_bf16 v[16:31], v[96:99], v[124:127], v[16:31]
    buffer_load_dwordx4 v146, s[32:35], s70 offen lds
    ds_read_b128 v[132:135], v143 offset:11264
    ds_read_b64_tr_b16 v[112:113], v145 offset:9216
    v_mfma_f32_32x32x16_bf16 v[32:47], v[100:103], v[120:123], v[32:47]
    ds_read_b64_tr_b16 v[114:115], v145 offset:9728
    s_add_u32 m0, s69, 7168
    v_mfma_f32_32x32x16_bf16 v[48:63], v[100:103], v[124:127], v[48:63]
    buffer_load_dwordx4 v147, s[32:35], s70 offen lds
    s_add_u32 s70, s70, 44032
    s_waitcnt lgkmcnt(0)
    s_waitcnt vmcnt(5)
    ds_read_b64_tr_b16 v[96:97], v144 offset:0
    ds_read_b64_tr_b16 v[98:99], v144 offset:512
    v_mfma_f32_32x32x16_bf16 v[0:15], v[108:111], v[128:131], v[0:15]
    ds_read_b128 v[120:123], v136 offset:12288
    s_add_u32 m0, s69, 9216
    v_mfma_f32_32x32x16_bf16 v[16:31], v[108:111], v[132:135], v[16:31]
    buffer_load_dwordx4 v146, s[32:35], s70 offen lds
    ds_read_b128 v[124:127], v140 offset:12288
    ds_read_b64_tr_b16 v[100:101], v145 offset:0
    v_mfma_f32_32x32x16_bf16 v[32:47], v[112:115], v[128:131], v[32:47]
    ds_read_b64_tr_b16 v[102:103], v145 offset:512
    s_add_u32 m0, s69, 10240
    v_mfma_f32_32x32x16_bf16 v[48:63], v[112:115], v[132:135], v[48:63]
    buffer_load_dwordx4 v147, s[32:35], s70 offen lds
    s_add_u32 s70, s70, 44032
    s_waitcnt lgkmcnt(0)
    s_waitcnt vmcnt(4)
    ds_read_b64_tr_b16 v[108:109], v144 offset:3072
    ds_read_b64_tr_b16 v[110:111], v144 offset:3584
    v_mfma_f32_32x32x16_bf16 v[0:15], v[96:99], v[120:123], v[0:15]
    s_mov_b32 exec_hi, 0
    s_mov_b32 exec_lo, 0x3fffff
    buffer_load_dword v156, v163, s[44:47], s74 offen offset:0
    s_mov_b64 exec, -1
    ds_read_b128 v[128:131], v137 offset:13312
    v_mfma_f32_32x32x16_bf16 v[16:31], v[96:99], v[124:127], v[16:31]
    ds_read_b128 v[132:135], v141 offset:13312
    ds_read_b64_tr_b16 v[112:113], v145 offset:3072
    v_mfma_f32_32x32x16_bf16 v[32:47], v[100:103], v[120:123], v[32:47]
    ds_read_b64_tr_b16 v[114:115], v145 offset:3584
    v_mfma_f32_32x32x16_bf16 v[48:63], v[100:103], v[124:127], v[48:63]
    s_waitcnt lgkmcnt(0)
    s_waitcnt vmcnt(3)
    ds_read_b64_tr_b16 v[96:97], v144 offset:6144
    ds_read_b64_tr_b16 v[98:99], v144 offset:6656
    v_mfma_f32_32x32x16_bf16 v[0:15], v[108:111], v[128:131], v[0:15]
    ds_read_b128 v[120:123], v138 offset:14336
    v_mfma_f32_32x32x16_bf16 v[16:31], v[108:111], v[132:135], v[16:31]
    ds_read_b128 v[124:127], v142 offset:14336
    ds_read_b64_tr_b16 v[100:101], v145 offset:6144
    v_mfma_f32_32x32x16_bf16 v[32:47], v[112:115], v[128:131], v[32:47]
    ds_read_b64_tr_b16 v[102:103], v145 offset:6656
    v_mfma_f32_32x32x16_bf16 v[48:63], v[112:115], v[132:135], v[48:63]
    s_waitcnt lgkmcnt(0)
    s_waitcnt vmcnt(1)
    ds_read_b64_tr_b16 v[108:109], v144 offset:9216
    ds_read_b64_tr_b16 v[110:111], v144 offset:9728
    v_mfma_f32_32x32x16_bf16 v[0:15], v[96:99], v[120:123], v[0:15]
    s_mov_b32 exec_hi, 0
    buffer_load_dword v156, v163, s[40:43], s75 offen offset:0
    s_mov_b64 exec, -1
    ds_read_b128 v[128:131], v139 offset:15360
    v_mfma_f32_32x32x16_bf16 v[16:31], v[96:99], v[124:127], v[16:31]
    ds_read_b128 v[132:135], v143 offset:15360
    ds_read_b64_tr_b16 v[112:113], v145 offset:9216
    v_mfma_f32_32x32x16_bf16 v[32:47], v[100:103], v[120:123], v[32:47]
    ds_read_b64_tr_b16 v[114:115], v145 offset:9728
    v_mfma_f32_32x32x16_bf16 v[48:63], v[100:103], v[124:127], v[48:63]
    s_waitcnt lgkmcnt(0)
    v_mfma_f32_32x32x16_bf16 v[16:31], v[108:111], v[132:135], v[16:31]
    v_mfma_f32_32x32x16_bf16 v[48:63], v[112:115], v[132:135], v[48:63]
    v_mfma_f32_32x32x16_bf16 v[0:15], v[108:111], v[128:131], v[0:15]
    v_mfma_f32_32x32x16_bf16 v[32:47], v[112:115], v[128:131], v[32:47]
L_ffn1_done:
    s_setprio 3
    v_add_u32 v151, s69, v162
    s_nop 6
    ds_write_b128 v151, v[16:19] offset:0
    ds_write_b128 v151, v[20:23] offset:1024
    ds_write_b128 v151, v[24:27] offset:2048
    ds_write_b128 v151, v[28:31] offset:3072
    ds_write_b128 v151, v[48:51] offset:4096
    ds_write_b128 v151, v[52:55] offset:5120
    ds_write_b128 v151, v[56:59] offset:6144
    ds_write_b128 v151, v[60:63] offset:7168
    ds_write_b128 v151, v[80:83] offset:8192
    ds_write_b128 v151, v[84:87] offset:9216
    ds_write_b128 v151, v[88:91] offset:10240
    ds_write_b128 v151, v[92:95] offset:11264
    s_xor_b32 s56, s64, 1
    s_mul_i32 s56, s56, 12288
    s_add_u32 s56, s56, 114688
    v_add_u32 v151, s56, v162
    s_waitcnt lgkmcnt(0)
    s_mov_b64 exec, 1
    ds_inc_u32 v165, v164 offset:136
    s_mov_b64 exec, -1
    s_mov_b32 s76, 0x40000
L_spin_75:
    ds_read_b32 v154, v165 offset:136
    s_waitcnt lgkmcnt(0)
    v_readfirstlane_b32 s77, v154
    s_nop 0
    s_cmp_ge_u32 s77, 4
    s_cbranch_scc1 L_spun_76
    s_sleep 1
    s_sub_u32 s76, s76, 1
    s_cbranch_scc0 L_spin_75
L_spun_76:
    ds_read_b128 v[16:19], v151 offset:0
    ds_read_b128 v[20:23], v151 offset:1024
    ds_read_b128 v[24:27], v151 offset:2048
    ds_read_b128 v[28:31], v151 offset:3072
    ds_read_b128 v[48:51], v151 offset:4096
    ds_read_b128 v[52:55], v151 offset:5120
    ds_read_b128 v[56:59], v151 offset:6144
    ds_read_b128 v[60:63], v151 offset:7168
    ds_read_b128 v[80:83], v151 offset:8192
    ds_read_b128 v[84:87], v151 offset:9216
    ds_read_b128 v[88:91], v151 offset:10240
    ds_read_b128 v[92:95], v151 offset:11264
    v_mul_f32 v153, -2.0, v152
    v_mul_f32 v154, 0x3fb8aa3b, v152
    s_lshl_b32 s56, s4, 1
    s_add_u32 s56, s56, s66
    s_mul_i32 s56, s56, 86
    s_lshl_b32 s57, s67, 1
    s_add_u32 s56, s56, s57
    s_lshl_b32 s56, s56, 10
    s_add_u32 s56, s56, 2359296
    s_waitcnt lgkmcnt(8)
    v_pk_add_f32 v[0:1], v[0:1], v[16:17]
    v_pk_add_f32 v[2:3], v[2:3], v[18:19]
    v_pk_add_f32 v[4:5], v[4:5], v[20:21]
    v_pk_add_f32 v[6:7], v[6:7], v[22:23]
    v_pk_add_f32 v[8:9], v[8:9], v[24:25]
    v_pk_add_f32 v[10:11], v[10:11], v[26:27]
    v_pk_add_f32 v[12:13], v[12:13], v[28:29]
    v_pk_add_f32 v[14:15], v[14:15], v[30:31]
    v_pk_mul_f32 v[16:17], v[0:1], v[154:155] op_sel_hi:[1,0]
    v_pk_mul_f32 v[18:19], v[2:3], v[154:155] op_sel_hi:[1,0]
    v_pk_mul_f32 v[20:21], v[4:5], v[154:155] op_sel_hi:[1,0]
    v_pk_mul_f32 v[22:23], v[6:7], v[154:155] op_sel_hi:[1,0]
    v_pk_mul_f32 v[24:25], v[8:9], v[154:155] op_sel_hi:[1,0]
    v_pk_mul_f32 v[26:27], v[10:11], v[154:155] op_sel_hi:[1,0]
    v_pk_mul_f32 v[28:29], v[12:13], v[154:155] op_sel_hi:[1,0]
    v_pk_mul_f32 v[30:31], v[14:15], v[154:155] op_sel_hi:[1,0]
    v_exp_f32 v16, v16
    v_exp_f32 v17, v17
    v_exp_f32 v18, v18
    v_exp_f32 v19, v19
    v_exp_f32 v20, v20
    v_exp_f32 v21, v21
    v_exp_f32 v22, v22
    v_exp_f32 v23, v23
    v_exp_f32 v24, v24
    v_exp_f32 v25, v25
    v_exp_f32 v26, v26
    v_exp_f32 v27, v27
    v_exp_f32 v28, v28
    v_exp_f32 v29, v29
    v_exp_f32 v30, v30
    v_exp_f32 v31, v31
    v_pk_add_f32 v[16:17], v[16:17], 1.0 op_sel_hi:[1,0]
    v_pk_add_f32 v[18:19], v[18:19], 1.0 op_sel_hi:[1,0]
    v_pk_add_f32 v[20:21], v[20:21], 1.0 op_sel_hi:[1,0]
    v_pk_add_f32 v[22:23], v[22:23], 1.0 op_sel_hi:[1,0]
    v_pk_add_f32 v[24:25], v[24:25], 1.0 op_sel_hi:[1,0]
    v_pk_add_f32 v[26:27], v[26:27], 1.0 op_sel_hi:[1,0]
    v_pk_add_f32 v[28:29], v[28:29], 1.0 op_sel_hi:[1,0]
    v_pk_add_f32 v[30:31], v[30:31], 1.0 op_sel_hi:[1,0]
    v_pk_fma_f32 v[16:17], v[16:17], v[16:17], 1.0 op_sel_hi:[1,1,0]
    v_pk_fma_f32 v[18:19], v[18:19], v[18:19], 1.0 op_sel_hi:[1,1,0]
    v_pk_fma_f32 v[20:21], v[20:21], v[20:21], 1.0 op_sel_hi:[1,1,0]
    v_pk_fma_f32 v[22:23], v[22:23], v[22:23], 1.0 op_sel_hi:[1,1,0]
    v_pk_fma_f32 v[24:25], v[24:25], v[24:25], 1.0 op_sel_hi:[1,1,0]
    v_pk_fma_f32 v[26:27], v[26:27], v[26:27], 1.0 op_sel_hi:[1,1,0]
    v_pk_fma_f32 v[28:29], v[28:29], v[28:29], 1.0 op_sel_hi:[1,1,0]
    v_pk_fma_f32 v[30:31], v[30:31], v[30:31], 1.0 op_sel_hi:[1,1,0]
    v_rcp_f32 v16, v16
    v_rcp_f32 v17, v17
    v_rcp_f32 v18, v18
    v_rcp_f32 v19, v19
    v_rcp_f32 v20, v20
    v_rcp_f32 v21, v21
    v_rcp_f32 v22, v22
    v_rcp_f32 v23, v23
    v_rcp_f32 v24, v24
    v_rcp_f32 v25, v25
    v_rcp_f32 v26, v26
    v_rcp_f32 v27, v27
    v_rcp_f32 v28, v28
    v_rcp_f32 v29, v29
    v_rcp_f32 v30, v30
    v_rcp_f32 v31, v31
    v_pk_fma_f32 v[16:17], v[16:17], v[152:153], v[152:153] op_sel:[0,1,0] op_sel_hi:[1,1,0]
    v_pk_fma_f32 v[18:19], v[18:19], v[152:153], v[152:153] op_sel:[0,1,0] op_sel_hi:[1,1,0]
    v_pk_fma_f32 v[20:21], v[20:21], v[152:153], v[152:153] op_sel:[0,1,0] op_sel_hi:[1,1,0]
    v_pk_fma_f32 v[22:23], v[22:23], v[152:153], v[152:153] op_sel:[0,1,0] op_sel_hi:[1,1,0]
    v_pk_fma_f32 v[24:25], v[24:25], v[152:153], v[152:153] op_sel:[0,1,0] op_sel_hi:[1,1,0]
    v_pk_fma_f32 v[26:27], v[26:27], v[152:153], v[152:153] op_sel:[0,1,0] op_sel_hi:[1,1,0]
    v_pk_fma_f32 v[28:29], v[28:29], v[152:153], v[152:153] op_sel:[0,1,0] op_sel_hi:[1,1,0]
    v_pk_fma_f32 v[30:31], v[30:31], v[152:153], v[152:153] op_sel:[0,1,0] op_sel_hi:[1,1,0]
    v_pk_mul_f32 v[0:1], v[0:1], v[16:17]
    v_pk_mul_f32 v[2:3], v[2:3], v[18:19]
    v_pk_mul_f32 v[4:5], v[4:5], v[20:21]
    v_pk_mul_f32 v[6:7], v[6:7], v[22:23]
    v_pk_mul_f32 v[8:9], v[8:9], v[24:25]
    v_pk_mul_f32 v[10:11], v[10:11], v[26:27]
    v_pk_mul_f32 v[12:13], v[12:13], v[28:29]
    v_pk_mul_f32 v[14:15], v[14:15], v[30:31]
    v_cvt_pk_bf16_f32 v16, v0, v1
    v_cvt_pk_bf16_f32 v17, v2, v3
    v_cvt_pk_bf16_f32 v18, v4, v5
    v_cvt_pk_bf16_f32 v19, v6, v7
    v_cvt_pk_bf16_f32 v20, v8, v9
    v_cvt_pk_bf16_f32 v21, v10, v11
    v_cvt_pk_bf16_f32 v22, v12, v13
    v_cvt_pk_bf16_f32 v23, v14, v15
    buffer_store_dwordx4 v[16:19], v162, s[48:51], s56 offen offset:0 sc1
    buffer_store_dwordx4 v[20:23], v162, s[48:51], s56 offen offset:1024 sc1
    s_waitcnt lgkmcnt(4)
    v_pk_add_f32 v[32:33], v[32:33], v[48:49]
    v_pk_add_f32 v[34:35], v[34:35], v[50:51]
    v_pk_add_f32 v[36:37], v[36:37], v[52:53]
    v_pk_add_f32 v[38:39], v[38:39], v[54:55]
    v_pk_add_f32 v[40:41], v[40:41], v[56:57]
    v_pk_add_f32 v[42:43], v[42:43], v[58:59]
    v_pk_add_f32 v[44:45], v[44:45], v[60:61]
    v_pk_add_f32 v[46:47], v[46:47], v[62:63]
    v_pk_mul_f32 v[48:49], v[32:33], v[154:155] op_sel_hi:[1,0]
    v_pk_mul_f32 v[50:51], v[34:35], v[154:155] op_sel_hi:[1,0]
    v_pk_mul_f32 v[52:53], v[36:37], v[154:155] op_sel_hi:[1,0]
    v_pk_mul_f32 v[54:55], v[38:39], v[154:155] op_sel_hi:[1,0]
    v_pk_mul_f32 v[56:57], v[40:41], v[154:155] op_sel_hi:[1,0]
    v_pk_mul_f32 v[58:59], v[42:43], v[154:155] op_sel_hi:[1,0]
    v_pk_mul_f32 v[60:61], v[44:45], v[154:155] op_sel_hi:[1,0]
    v_pk_mul_f32 v[62:63], v[46:47], v[154:155] op_sel_hi:[1,0]
    v_exp_f32 v48, v48
    v_exp_f32 v49, v49
    v_exp_f32 v50, v50
    v_exp_f32 v51, v51
    v_exp_f32 v52, v52
    v_exp_f32 v53, v53
    v_exp_f32 v54, v54
    v_exp_f32 v55, v55
    v_exp_f32 v56, v56
    v_exp_f32 v57, v57
    v_exp_f32 v58, v58
    v_exp_f32 v59, v59
    v_exp_f32 v60, v60
    v_exp_f32 v61, v61
    v_exp_f32 v62, v62
    v_exp_f32 v63, v63
    v_pk_add_f32 v[48:49], v[48:49], 1.0 op_sel_hi:[1,0]
    v_pk_add_f32 v[50:51], v[50:51], 1.0 op_sel_hi:[1,0]
    v_pk_add_f32 v[52:53], v[52:53], 1.0 op_sel_hi:[1,0]
    v_pk_add_f32 v[54:55], v[54:55], 1.0 op_sel_hi:[1,0]
    v_pk_add_f32 v[56:57], v[56:57], 1.0 op_sel_hi:[1,0]
    v_pk_add_f32 v[58:59], v[58:59], 1.0 op_sel_hi:[1,0]
    v_pk_add_f32 v[60:61], v[60:61], 1.0 op_sel_hi:[1,0]
    v_pk_add_f32 v[62:63], v[62:63], 1.0 op_sel_hi:[1,0]
    v_pk_fma_f32 v[48:49], v[48:49], v[48:49], 1.0 op_sel_hi:[1,1,0]
    v_pk_fma_f32 v[50:51], v[50:51], v[50:51], 1.0 op_sel_hi:[1,1,0]
    v_pk_fma_f32 v[52:53], v[52:53], v[52:53], 1.0 op_sel_hi:[1,1,0]
    v_pk_fma_f32 v[54:55], v[54:55], v[54:55], 1.0 op_sel_hi:[1,1,0]
    v_pk_fma_f32 v[56:57], v[56:57], v[56:57], 1.0 op_sel_hi:[1,1,0]
    v_pk_fma_f32 v[58:59], v[58:59], v[58:59], 1.0 op_sel_hi:[1,1,0]
    v_pk_fma_f32 v[60:61], v[60:61], v[60:61], 1.0 op_sel_hi:[1,1,0]
    v_pk_fma_f32 v[62:63], v[62:63], v[62:63], 1.0 op_sel_hi:[1,1,0]
    v_rcp_f32 v48, v48
    v_rcp_f32 v49, v49
    v_rcp_f32 v50, v50
    v_rcp_f32 v51, v51
    v_rcp_f32 v52, v52
    v_rcp_f32 v53, v53
    v_rcp_f32 v54, v54
    v_rcp_f32 v55, v55
    v_rcp_f32 v56, v56
    v_rcp_f32 v57, v57
    v_rcp_f32 v58, v58
    v_rcp_f32 v59, v59
    v_rcp_f32 v60, v60
    v_rcp_f32 v61, v61
    v_rcp_f32 v62, v62
    v_rcp_f32 v63, v63
    v_pk_fma_f32 v[48:49], v[48:49], v[152:153], v[152:153] op_sel:[0,1,0] op_sel_hi:[1,1,0]
    v_pk_fma_f32 v[50:51], v[50:51], v[152:153], v[152:153] op_sel:[0,1,0] op_sel_hi:[1,1,0]
    v_pk_fma_f32 v[52:53], v[52:53], v[152:153], v[152:153] op_sel:[0,1,0] op_sel_hi:[1,1,0]
    v_pk_fma_f32 v[54:55], v[54:55], v[152:153], v[152:153] op_sel:[0,1,0] op_sel_hi:[1,1,0]
    v_pk_fma_f32 v[56:57], v[56:57], v[152:153], v[152:153] op_sel:[0,1,0] op_sel_hi:[1,1,0]
    v_pk_fma_f32 v[58:59], v[58:59], v[152:153], v[152:153] op_sel:[0,1,0] op_sel_hi:[1,1,0]
    v_pk_fma_f32 v[60:61], v[60:61], v[152:153], v[152:153] op_sel:[0,1,0] op_sel_hi:[1,1,0]
    v_pk_fma_f32 v[62:63], v[62:63], v[152:153], v[152:153] op_sel:[0,1,0] op_sel_hi:[1,1,0]
    v_pk_mul_f32 v[32:33], v[32:33], v[48:49]
    v_pk_mul_f32 v[34:35], v[34:35], v[50:51]
    v_pk_mul_f32 v[36:37], v[36:37], v[52:53]
    v_pk_mul_f32 v[38:39], v[38:39], v[54:55]
    v_pk_mul_f32 v[40:41], v[40:41], v[56:57]
    v_pk_mul_f32 v[42:43], v[42:43], v[58:59]
    v_pk_mul_f32 v[44:45], v[44:45], v[60:61]
    v_pk_mul_f32 v[46:47], v[46:47], v[62:63]
    v_cvt_pk_bf16_f32 v48, v32, v33
    v_cvt_pk_bf16_f32 v49, v34, v35
    v_cvt_pk_bf16_f32 v50, v36, v37
    v_cvt_pk_bf16_f32 v51, v38, v39
    v_cvt_pk_bf16_f32 v52, v40, v41
    v_cvt_pk_bf16_f32 v53, v42, v43
    v_cvt_pk_bf16_f32 v54, v44, v45
    v_cvt_pk_bf16_f32 v55, v46, v47
    buffer_store_dwordx4 v[48:51], v162, s[48:51], s56 offen offset:2048 sc1
    buffer_store_dwordx4 v[52:55], v162, s[48:51], s56 offen offset:3072 sc1
    s_cmp_eq_u32 s68, 1
    s_cbranch_scc0 L_mish_done
    s_waitcnt lgkmcnt(0)
    v_pk_add_f32 v[64:65], v[64:65], v[80:81]
    v_pk_add_f32 v[66:67], v[66:67], v[82:83]
    v_pk_add_f32 v[68:69], v[68:69], v[84:85]
    v_pk_add_f32 v[70:71], v[70:71], v[86:87]
    v_pk_add_f32 v[72:73], v[72:73], v[88:89]
    v_pk_add_f32 v[74:75], v[74:75], v[90:91]
    v_pk_add_f32 v[76:77], v[76:77], v[92:93]
    v_pk_add_f32 v[78:79], v[78:79], v[94:95]
    v_pk_mul_f32 v[80:81], v[64:65], v[154:155] op_sel_hi:[1,0]
    v_pk_mul_f32 v[82:83], v[66:67], v[154:155] op_sel_hi:[1,0]
    v_pk_mul_f32 v[84:85], v[68:69], v[154:155] op_sel_hi:[1,0]
    v_pk_mul_f32 v[86:87], v[70:71], v[154:155] op_sel_hi:[1,0]
    v_pk_mul_f32 v[88:89], v[72:73], v[154:155] op_sel_hi:[1,0]
    v_pk_mul_f32 v[90:91], v[74:75], v[154:155] op_sel_hi:[1,0]
    v_pk_mul_f32 v[92:93], v[76:77], v[154:155] op_sel_hi:[1,0]
    v_pk_mul_f32 v[94:95], v[78:79], v[154:155] op_sel_hi:[1,0]
    v_exp_f32 v80, v80
    v_exp_f32 v81, v81
    v_exp_f32 v82, v82
    v_exp_f32 v83, v83
    v_exp_f32 v84, v84
    v_exp_f32 v85, v85
    v_exp_f32 v86, v86
    v_exp_f32 v87, v87
    v_exp_f32 v88, v88
    v_exp_f32 v89, v89
    v_exp_f32 v90, v90
    v_exp_f32 v91, v91
    v_exp_f32 v92, v92
    v_exp_f32 v93, v93
    v_exp_f32 v94, v94
    v_exp_f32 v95, v95
    v_pk_add_f32 v[80:81], v[80:81], 1.0 op_sel_hi:[1,0]
    v_pk_add_f32 v[82:83], v[82:83], 1.0 op_sel_hi:[1,0]
    v_pk_add_f32 v[84:85], v[84:85], 1.0 op_sel_hi:[1,0]
    v_pk_add_f32 v[86:87], v[86:87], 1.0 op_sel_hi:[1,0]
    v_pk_add_f32 v[88:89], v[88:89], 1.0 op_sel_hi:[1,0]
    v_pk_add_f32 v[90:91], v[90:91], 1.0 op_sel_hi:[1,0]
    v_pk_add_f32 v[92:93], v[92:93], 1.0 op_sel_hi:[1,0]
    v_pk_add_f32 v[94:95], v[94:95], 1.0 op_sel_hi:[1,0]
    v_pk_fma_f32 v[80:81], v[80:81], v[80:81], 1.0 op_sel_hi:[1,1,0]
    v_pk_fma_f32 v[82:83], v[82:83], v[82:83], 1.0 op_sel_hi:[1,1,0]
    v_pk_fma_f32 v[84:85], v[84:85], v[84:85], 1.0 op_sel_hi:[1,1,0]
    v_pk_fma_f32 v[86:87], v[86:87], v[86:87], 1.0 op_sel_hi:[1,1,0]
    v_pk_fma_f32 v[88:89], v[88:89], v[88:89], 1.0 op_sel_hi:[1,1,0]
    v_pk_fma_f32 v[90:91], v[90:91], v[90:91], 1.0 op_sel_hi:[1,1,0]
    v_pk_fma_f32 v[92:93], v[92:93], v[92:93], 1.0 op_sel_hi:[1,1,0]
    v_pk_fma_f32 v[94:95], v[94:95], v[94:95], 1.0 op_sel_hi:[1,1,0]
    v_rcp_f32 v80, v80
    v_rcp_f32 v81, v81
    v_rcp_f32 v82, v82
    v_rcp_f32 v83, v83
    v_rcp_f32 v84, v84
    v_rcp_f32 v85, v85
    v_rcp_f32 v86, v86
    v_rcp_f32 v87, v87
    v_rcp_f32 v88, v88
    v_rcp_f32 v89, v89
    v_rcp_f32 v90, v90
    v_rcp_f32 v91, v91
    v_rcp_f32 v92, v92
    v_rcp_f32 v93, v93
    v_rcp_f32 v94, v94
    v_rcp_f32 v95, v95
    v_pk_fma_f32 v[80:81], v[80:81], v[152:153], v[152:153] op_sel:[0,1,0] op_sel_hi:[1,1,0]
    v_pk_fma_f32 v[82:83], v[82:83], v[152:153], v[152:153] op_sel:[0,1,0] op_sel_hi:[1,1,0]
    v_pk_fma_f32 v[84:85], v[84:85], v[152:153], v[152:153] op_sel:[0,1,0] op_sel_hi:[1,1,0]
    v_pk_fma_f32 v[86:87], v[86:87], v[152:153], v[152:153] op_sel:[0,1,0] op_sel_hi:[1,1,0]
    v_pk_fma_f32 v[88:89], v[88:89], v[152:153], v[152:153] op_sel:[0,1,0] op_sel_hi:[1,1,0]
    v_pk_fma_f32 v[90:91], v[90:91], v[152:153], v[152:153] op_sel:[0,1,0] op_sel_hi:[1,1,0]
    v_pk_fma_f32 v[92:93], v[92:93], v[152:153], v[152:153] op_sel:[0,1,0] op_sel_hi:[1,1,0]
    v_pk_fma_f32 v[94:95], v[94:95], v[152:153], v[152:153] op_sel:[0,1,0] op_sel_hi:[1,1,0]
    v_pk_mul_f32 v[64:65], v[64:65], v[80:81]
    v_pk_mul_f32 v[66:67], v[66:67], v[82:83]
    v_pk_mul_f32 v[68:69], v[68:69], v[84:85]
    v_pk_mul_f32 v[70:71], v[70:71], v[86:87]
    v_pk_mul_f32 v[72:73], v[72:73], v[88:89]
    v_pk_mul_f32 v[74:75], v[74:75], v[90:91]
    v_pk_mul_f32 v[76:77], v[76:77], v[92:93]
    v_pk_mul_f32 v[78:79], v[78:79], v[94:95]
    v_cvt_pk_bf16_f32 v80, v64, v65
    v_cvt_pk_bf16_f32 v81, v66, v67
    v_cvt_pk_bf16_f32 v82, v68, v69
    v_cvt_pk_bf16_f32 v83, v70, v71
    v_cvt_pk_bf16_f32 v84, v72, v73
    v_cvt_pk_bf16_f32 v85, v74, v75
    v_cvt_pk_bf16_f32 v86, v76, v77
    v_cvt_pk_bf16_f32 v87, v78, v79
    s_add_u32 s57, s56, 0x1000
    buffer_store_dwordx4 v[80:83], v162, s[48:51], s57 offen offset:0 sc1
    buffer_store_dwordx4 v[84:87], v162, s[48:51], s57 offen offset:1024 sc1
L_mish_done:
    s_mov_b32 s32, s24
    s_mov_b32 s33, s25
    s_mov_b32 s34, 1409024
    s_mov_b32 s35, 0x20000
    s_mov_b32 s36, s8
    s_mov_b32 s37, s9
    s_mov_b32 s38, 2097152
    s_mov_b32 s39, 0x20000
    s_mov_b32 s40, s16
    s_mov_b32 s41, s17
    s_mov_b32 s42, 524288
    s_mov_b32 s43, 0x20000
    s_mov_b32 s44, s26
    s_mov_b32 s45, s27
    s_mov_b32 s46, 2097152
    s_mov_b32 s47, 0x20000
    s_and_b32 s71, s64, 1
    s_lshr_b32 s72, s64, 1
    s_xor_b32 s72, s72, 1
    s_lshl_b32 s69, s64, 14
    s_lshl_b32 s73, s4, 16
    s_lshl_b32 s57, s64, 14
    s_add_u32 s73, s73, s57
    s_xor_b32 s57, s5, 4
    s_lshl_b32 s57, s57, 7
    s_add_u32 s73, s73, s57
    s_add_u32 s67, s73, 0x2000
    s_mul_i32 s57, s5, 3
    s_mul_i32 s58, s7, 5
    s_add_u32 s57, s57, s58
    s_cmp_ge_u32 s57, 22
    s_cselect_b32 s58, 22, 0
    s_sub_u32 s57, s57, s58
    s_mul_i32 s75, s64, 22528
    s_add_u32 s61, s75, 22528
    s_lshl_b32 s57, s57, 10
    s_add_u32 s74, s75, s57
    s_xor_b32 s58, s5, 4
    s_lshl_b32 s58, s58, 7
    s_lshl_b32 s62, s75, 4
    s_add_u32 s62, s62, s58
    s_lshl_b32 s63, s61, 4
    s_add_u32 s63, s63, s58
    s_lshl_b32 s70, s74, 4
    s_add_u32 s70, s70, s58
    buffer_load_dwordx4 v[132:135], v161, s[36:39], s73 offen
    buffer_load_dwordx4 v[136:139], v161, s[36:39], s67 offen
    s_waitcnt vmcnt(2)
    s_mov_b64 exec, 1
    ds_inc_rtn_u32 v128, v165, v164 offset:152
    s_mov_b64 exec, -1
    s_waitcnt lgkmcnt(0)
    v_readfirstlane_b32 s58, v128
    s_nop 0
    s_cmp_eq_u32 s58, 3
    s_cbranch_scc0 L_G_noact
    s_lshl_b32 s56, s4, 10
    s_lshl_b32 s57, s5, 7
    s_add_u32 s56, s56, s57
    s_add_u32 s56, s56, 163840
    v_mov_b32 v128, s6
    v_mbcnt_lo_u32_b32 v129, -1, 0
    v_lshlrev_b32 v129, 2, v129
    s_mov_b32 exec_hi, 0
    buffer_store_dword v128, v129, s[48:51], s56 offen sc1
    s_mov_b64 exec, -1
L_G_noact:
    s_add_u32 m0, s69, 0
    s_nop 0
    buffer_load_dwordx4 v159, s[32:35], s70 offen lds
    s_add_u32 m0, s69, 1024
    s_nop 0
    buffer_load_dwordx4 v160, s[32:35], s70 offen lds
    s_add_u32 s70, s70, 0x4000
    s_cmp_eq_u32 s70, s63
    s_cselect_b32 s70, s62, s70
    s_add_u32 m0, s69, 2048
    s_nop 0
    buffer_load_dwordx4 v159, s[32:35], s70 offen lds
    s_add_u32 m0, s69, 3072
    s_nop 0
    buffer_load_dwordx4 v160, s[32:35], s70 offen lds
    s_add_u32 s70, s70, 0x4000
    s_cmp_eq_u32 s70, s63
    s_cselect_b32 s70, s62, s70
    s_lshl_b32 s58, s4, 1
    s_mul_i32 s57, s58, 88064
    s_add_u32 s57, s57, 2359296
    s_add_u32 s36, s30, s57
    s_addc_u32 s37, s31, 0
    s_mov_b32 s38, 88064
    s_mov_b32 s39, 0x20000
    s_xor_b32 s58, s58, 1
    s_mul_i32 s57, s58, 88064
    s_add_u32 s57, s57, 2359296
    s_add_u32 s52, s30, s57
    s_addc_u32 s53, s31, 0
    s_mov_b32 s54, 88064
    s_mov_b32 s55, 0x20000
    s_xor_b32 s58, s58, 1
    s_lshl_b32 s60, s4, 10
    s_add_u32 s60, s60, 163840
    s_lshl_b32 s56, s64, 3
    s_lshr_b32 s57, 0x6040200, s56
    s_and_b32 s57, s57, 0xff
    s_lshl_b32 s57, s57, 7
    s_add_u32 s58, s57, s60
    s_lshr_b32 s59, 0x3070707, s56
    s_and_b32 s59, s59, 0xff
    s_mov_b32 s76, 0x8000
    s_mov_b32 exec_lo, s59
    s_mov_b32 exec_hi, 0
L_poll_77:
    buffer_load_dword v128, v163, s[48:51], s58 offen sc1
    s_waitcnt vmcnt(0)
    v_cmp_eq_u32 vcc, s6, v128
    s_nop 0
    s_cmp_eq_u64 vcc, exec
    s_cbranch_scc1 L_polled_78
    s_sleep 4
    s_sub_u32 s76, s76, 1
    s_cbranch_scc0 L_poll_77
L_polled_78:
    s_mov_b64 exec, -1
    s_mov_b32 s76, 0x40000
L_spin_79:
    ds_read_b32 v128, v165 offset:152
    s_waitcnt lgkmcnt(0)
    v_readfirstlane_b32 s77, v128
    s_nop 0
    s_cmp_ge_u32 s77, 4
    s_cbranch_scc1 L_spun_80
    s_sleep 1
    s_sub_u32 s76, s76, 1
    s_cbranch_scc0 L_spin_79
L_spun_80:
    s_mul_i32 s72, s64, 12288
    s_add_u32 s72, s72, 114688
    s_lshl_b32 s59, s64, 17
    s_xor_b32 s57, s5, 4
    s_lshl_b32 s57, s57, 7
    s_add_u32 s59, s59, s57
    buffer_load_dwordx4 v[64:67], v162, s[36:39], s74 offen sc1
    buffer_load_dwordx4 v[68:71], v162, s[52:55], s74 offen sc1
    s_add_u32 s74, s74, 0x400
    s_cmp_eq_u32 s74, s61
    s_cselect_b32 s74, s75, s74
    buffer_load_dwordx4 v[72:75], v162, s[36:39], s74 offen sc1
    buffer_load_dwordx4 v[76:79], v162, s[52:55], s74 offen sc1
    s_add_u32 s74, s74, 0x400
    s_cmp_eq_u32 s74, s61
    s_cselect_b32 s74, s75, s74
    s_add_u32 m0, s69, 4096
    s_nop 0
    buffer_load_dwordx4 v159, s[32:35], s70 offen lds
    s_add_u32 m0, s69, 5120
    s_nop 0
    buffer_load_dwordx4 v160, s[32:35], s70 offen lds
    s_add_u32 s70, s70, 0x4000
    s_cmp_eq_u32 s70, s63
    s_cselect_b32 s70, s62, s70
    buffer_load_dwordx4 v[80:83], v162, s[36:39], s74 offen sc1
    buffer_load_dwordx4 v[84:87], v162, s[52:55], s74 offen sc1
    s_add_u32 s74, s74, 0x400
    s_cmp_eq_u32 s74, s61
    s_cselect_b32 s74, s75, s74
    ds_read_b64_tr_b16 v[112:113], v157 offset:0
    ds_read_b64_tr_b16 v[114:115], v157 offset:1024
    ds_read_b64_tr_b16 v[116:117], v158 offset:0
    ds_read_b64_tr_b16 v[118:119], v158 offset:1024
    s_setprio 0
    s_waitcnt lgkmcnt(0)
    s_waitcnt vmcnt(6)
    ds_read_b64_tr_b16 v[120:121], v157 offset:2048
    s_add_u32 m0, s69, 0
    v_mfma_f32_32x32x16_bf16 v[0:15], v[112:115], v[64:67], 0
    buffer_load_dwordx4 v159, s[32:35], s70 offen lds
    ds_read_b64_tr_b16 v[122:123], v157 offset:3072
    v_mfma_f32_32x32x16_bf16 v[16:31], v[116:119], v[64:67], 0
    buffer_load_dwordx4 v[64:67], v162, s[36:39], s74 offen sc1
    ds_read_b64_tr_b16 v[124:125], v158 offset:2048
    s_add_u32 m0, s69, 1024
    v_mfma_f32_32x32x16_bf16 v[32:47], v[112:115], v[68:71], 0
    buffer_load_dwordx4 v160, s[32:35], s70 offen lds
    s_add_u32 s70, s70, 0x4000
    s_cmp_eq_u32 s70, s63
    s_cselect_b32 s70, s62, s70
    ds_read_b64_tr_b16 v[126:127], v158 offset:3072
    v_mfma_f32_32x32x16_bf16 v[48:63], v[116:119], v[68:71], 0
    buffer_load_dwordx4 v[68:71], v162, s[52:55], s74 offen sc1
    s_add_u32 s74, s74, 0x400
    s_cmp_eq_u32 s74, s61
    s_cselect_b32 s74, s75, s74
    s_waitcnt lgkmcnt(0)
    s_waitcnt vmcnt(6)
    ds_read_b64_tr_b16 v[112:113], v157 offset:4096
    s_add_u32 m0, s69, 2048
    v_mfma_f32_32x32x16_bf16 v[0:15], v[120:123], v[72:75], v[0:15]
    buffer_load_dwordx4 v159, s[32:35], s70 offen lds
    ds_read_b64_tr_b16 v[114:115], v157 offset:5120
    v_mfma_f32_32x32x16_bf16 v[16:31], v[124:127], v[72:75], v[16:31]
    buffer_load_dwordx4 v[72:75], v162, s[36:39], s74 offen sc1
    ds_read_b64_tr_b16 v[116:117], v158 offset:4096
    s_add_u32 m0, s69, 3072
    v_mfma_f32_32x32x16_bf16 v[32:47], v[120:123], v[76:79], v[32:47]
    buffer_load_dwordx4 v160, s[32:35], s70 offen lds
    s_add_u32 s70, s70, 0x4000
    s_cmp_eq_u32 s70, s63
    s_cselect_b32 s70, s62, s70
    ds_read_b64_tr_b16 v[118:119], v158 offset:5120
    v_mfma_f32_32x32x16_bf16 v[48:63], v[124:127], v[76:79], v[48:63]
    buffer_load_dwordx4 v[76:79], v162, s[52:55], s74 offen sc1
    s_add_u32 s74, s74, 0x400
    s_cmp_eq_u32 s74, s61
    s_cselect_b32 s74, s75, s74
    s_add_u32 m0, s72, 0
    s_add_u32 s56, s59, 0
    buffer_load_dwordx4 v159, s[40:43], s56 offen lds
    s_waitcnt lgkmcnt(0)
    s_waitcnt vmcnt(6)
    ds_read_b64_tr_b16 v[120:121], v157 offset:0
    s_add_u32 m0, s69, 4096
    v_mfma_f32_32x32x16_bf16 v[0:15], v[112:115], v[80:83], v[0:15]
    buffer_load_dwordx4 v159, s[32:35], s70 offen lds
    ds_read_b64_tr_b16 v[122:123], v157 offset:1024
    v_mfma_f32_32x32x16_bf16 v[16:31], v[116:119], v[80:83], v[16:31]
    buffer_load_dwordx4 v[80:83], v162, s[36:39], s74 offen sc1
    ds_read_b64_tr_b16 v[124:125], v158 offset:0
    s_add_u32 m0, s69, 5120
    v_mfma_f32_32x32x16_bf16 v[32:47], v[112:115], v[84:87], v[32:47]
    buffer_load_dwordx4 v160, s[32:35], s70 offen lds
    s_add_u32 s70, s70, 0x4000
    s_cmp_eq_u32 s70, s63
    s_cselect_b32 s70, s62, s70
    ds_read_b64_tr_b16 v[126:127], v158 offset:1024
    v_mfma_f32_32x32x16_bf16 v[48:63], v[116:119], v[84:87], v[48:63]
    buffer_load_dwordx4 v[84:87], v162, s[52:55], s74 offen sc1
    s_add_u32 s74, s74, 0x400
    s_cmp_eq_u32 s74, s61
    s_cselect_b32 s74, s75, s74
    s_add_u32 m0, s72, 1024
    s_nop 0
    buffer_load_dwordx4 v160, s[40:43], s56 offen lds
    s_waitcnt lgkmcnt(0)
    s_waitcnt vmcnt(7)
    ds_read_b64_tr_b16 v[112:113], v157 offset:2048
    s_add_u32 m0, s69, 0
    v_mfma_f32_32x32x16_bf16 v[0:15], v[120:123], v[64:67], v[0:15]
    buffer_load_dwordx4 v159, s[32:35], s70 offen lds
    ds_read_b64_tr_b16 v[114:115], v157 offset:3072
    v_mfma_f32_32x32x16_bf16 v[16:31], v[124:127], v[64:67], v[16:31]
    buffer_load_dwordx4 v[64:67], v162, s[36:39], s74 offen sc1
    ds_read_b64_tr_b16 v[116:117], v158 offset:2048
    s_add_u32 m0, s69, 1024
    v_mfma_f32_32x32x16_bf16 v[32:47], v[120:123], v[68:71], v[32:47]
    buffer_load_dwordx4 v160, s[32:35], s70 offen lds
    s_add_u32 s70, s70, 0x4000
    s_cmp_eq_u32 s70, s63
    s_cselect_b32 s70, s62, s70
    ds_read_b64_tr_b16 v[118:119], v158 offset:3072
    v_mfma_f32_32x32x16_bf16 v[48:63], v[124:127], v[68:71], v[48:63]
    buffer_load_dwordx4 v[68:71], v162, s[52:55], s74 offen sc1
    s_add_u32 s74, s74, 0x400
    s_cmp_eq_u32 s74, s61
    s_cselect_b32 s74, s75, s74
    s_add_u32 m0, s72, 2048
    s_add_u32 s56, s59, 16384
    buffer_load_dwordx4 v159, s[40:43], s56 offen lds
    s_waitcnt lgkmcnt(0)
    s_waitcnt vmcnt(7)
    ds_read_b64_tr_b16 v[120:121], v157 offset:4096
    s_add_u32 m0, s69, 2048
    v_mfma_f32_32x32x16_bf16 v[0:15], v[112:115], v[72:75], v[0:15]
    buffer_load_dwordx4 v159, s[32:35], s70 offen lds
    ds_read_b64_tr_b16 v[122:123], v157 offset:5120
    v_mfma_f32_32x32x16_bf16 v[16:31], v[116:119], v[72:75], v[16:31]
    buffer_load_dwordx4 v[72:75], v162, s[36:39], s74 offen sc1
    ds_read_b64_tr_b16 v[124:125], v158 offset:4096
    s_add_u32 m0, s69, 3072
    v_mfma_f32_32x32x16_bf16 v[32:47], v[112:115], v[76:79], v[32:47]
    buffer_load_dwordx4 v160, s[32:35], s70 offen lds
    s_add_u32 s70, s70, 0x4000
    s_cmp_eq_u32 s70, s63
    s_cselect_b32 s70, s62, s70
    ds_read_b64_tr_b16 v[126:127], v158 offset:5120
    v_mfma_f32_32x32x16_bf16 v[48:63], v[116:119], v[76:79], v[48:63]
    buffer_load_dwordx4 v[76:79], v162, s[52:55], s74 offen sc1
    s_add_u32 s74, s74, 0x400
    s_cmp_eq_u32 s74, s61
    s_cselect_b32 s74, s75, s74
    s_add_u32 m0, s72, 3072
    s_nop 0
    buffer_load_dwordx4 v160, s[40:43], s56 offen lds
    s_waitcnt lgkmcnt(0)
    s_waitcnt vmcnt(7)
    ds_read_b64_tr_b16 v[112:113], v157 offset:0
    s_add_u32 m0, s69, 4096
    v_mfma_f32_32x32x16_bf16 v[0:15], v[120:123], v[80:83], v[0:15]
    buffer_load_dwordx4 v159, s[32:35], s70 offen lds
    ds_read_b64_tr_b16 v[114:115], v157 offset:1024
    v_mfma_f32_32x32x16_bf16 v[16:31], v[124:127], v[80:83], v[16:31]
    buffer_load_dwordx4 v[80:83], v162, s[36:39], s74 offen sc1
    ds_read_b64_tr_b16 v[116:117], v158 offset:0
    s_add_u32 m0, s69, 5120
    v_mfma_f32_32x32x16_bf16 v[32:47], v[120:123], v[84:87], v[32:47]
    buffer_load_dwordx4 v160, s[32:35], s70 offen lds
    s_add_u32 s70, s70, 0x4000
    s_cmp_eq_u32 s70, s63
    s_cselect_b32 s70, s62, s70
    ds_read_b64_tr_b16 v[118:119], v158 offset:1024
    v_mfma_f32_32x32x16_bf16 v[48:63], v[124:127], v[84:87], v[48:63]
    buffer_load_dwordx4 v[84:87], v162, s[52:55], s74 offen sc1
    s_add_u32 s74, s74, 0x400
    s_cmp_eq_u32 s74, s61
    s_cselect_b32 s74, s75, s74
    s_add_u32 m0, s72, 4096
    s_add_u32 s56, s59, 32768
    buffer_load_dwordx4 v159, s[40:43], s56 offen lds
    s_waitcnt lgkmcnt(0)
    s_waitcnt vmcnt(7)
    ds_read_b64_tr_b16 v[120:121], v157 offset:2048
    s_add_u32 m0, s69, 0
    v_mfma_f32_32x32x16_bf16 v[0:15], v[112:115], v[64:67], v[0:15]
    buffer_load_dwordx4 v159, s[32:35], s70 offen lds
    ds_read_b64_tr_b16 v[122:123], v157 offset:3072
    v_mfma_f32_32x32x16_bf16 v[16:31], v[116:119], v[64:67], v[16:31]
    buffer_load_dwordx4 v[64:67], v162, s[36:39], s74 offen sc1
    ds_read_b64_tr_b16 v[124:125], v158 offset:2048
    s_add_u32 m0, s69, 1024
    v_mfma_f32_32x32x16_bf16 v[32:47], v[112:115], v[68:71], v[32:47]
    buffer_load_dwordx4 v160, s[32:35], s70 offen lds
    s_add_u32 s70, s70, 0x4000
    s_cmp_eq_u32 s70, s63
    s_cselect_b32 s70, s62, s70
    ds_read_b64_tr_b16 v[126:127], v158 offset:3072
    v_mfma_f32_32x32x16_bf16 v[48:63], v[116:119], v[68:71], v[48:63]
    buffer_load_dwordx4 v[68:71], v162, s[52:55], s74 offen sc1
    s_add_u32 s74, s74, 0x400
    s_cmp_eq_u32 s74, s61
    s_cselect_b32 s74, s75, s74
    s_add_u32 m0, s72, 5120
    s_nop 0
    buffer_load_dwordx4 v160, s[40:43], s56 offen lds
    s_waitcnt lgkmcnt(0)
    s_waitcnt vmcnt(7)
    ds_read_b64_tr_b16 v[112:113], v157 offset:4096
    s_add_u32 m0, s69, 2048
    v_mfma_f32_32x32x16_bf16 v[0:15], v[120:123], v[72:75], v[0:15]
    buffer_load_dwordx4 v159, s[32:35], s70 offen lds
    ds_read_b64_tr_b16 v[114:115], v157 offset:5120
    v_mfma_f32_32x32x16_bf16 v[16:31], v[124:127], v[72:75], v[16:31]
    buffer_load_dwordx4 v[72:75], v162, s[36:39], s74 offen sc1
    ds_read_b64_tr_b16 v[116:117], v158 offset:4096
    s_add_u32 m0, s69, 3072
    v_mfma_f32_32x32x16_bf16 v[32:47], v[120:123], v[76:79], v[32:47]
    buffer_load_dwordx4 v160, s[32:35], s70 offen lds
    s_add_u32 s70, s70, 0x4000
    s_cmp_eq_u32 s70, s63
    s_cselect_b32 s70, s62, s70
    ds_read_b64_tr_b16 v[118:119], v158 offset:5120
    v_mfma_f32_32x32x16_bf16 v[48:63], v[124:127], v[76:79], v[48:63]
    buffer_load_dwordx4 v[76:79], v162, s[52:55], s74 offen sc1
    s_add_u32 s74, s74, 0x400
    s_cmp_eq_u32 s74, s61
    s_cselect_b32 s74, s75, s74
    s_add_u32 m0, s72, 6144
    s_add_u32 s56, s59, 49152
    buffer_load_dwordx4 v159, s[40:43], s56 offen lds
    s_waitcnt lgkmcnt(0)
    s_waitcnt vmcnt(7)
    ds_read_b64_tr_b16 v[120:121], v157 offset:0
    s_add_u32 m0, s69, 4096
    v_mfma_f32_32x32x16_bf16 v[0:15], v[112:115], v[80:83], v[0:15]
    buffer_load_dwordx4 v159, s[32:35], s70 offen lds
    ds_read_b64_tr_b16 v[122:123], v157 offset:1024
    v_mfma_f32_32x32x16_bf16 v[16:31], v[116:119], v[80:83], v[16:31]
    buffer_load_dwordx4 v[80:83], v162, s[36:39], s74 offen sc1
    ds_read_b64_tr_b16 v[124:125], v158 offset:0
    s_add_u32 m0, s69, 5120
    v_mfma_f32_32x32x16_bf16 v[32:47], v[112:115], v[84:87], v[32:47]
    buffer_load_dwordx4 v160, s[32:35], s70 offen lds
    s_add_u32 s70, s70, 0x4000
    s_cmp_eq_u32 s70, s63
    s_cselect_b32 s70, s62, s70
    ds_read_b64_tr_b16 v[126:127], v158 offset:1024
    v_mfma_f32_32x32x16_bf16 v[48:63], v[116:119], v[84:87], v[48:63]
    buffer_load_dwordx4 v[84:87], v162, s[52:55], s74 offen sc1
    s_add_u32 s74, s74, 0x400
    s_cmp_eq_u32 s74, s61
    s_cselect_b32 s74, s75, s74
    s_add_u32 m0, s72, 7168
    s_nop 0
    buffer_load_dwordx4 v160, s[40:43], s56 offen lds
    s_waitcnt lgkmcnt(0)
    s_waitcnt vmcnt(7)
    ds_read_b64_tr_b16 v[112:113], v157 offset:2048
    s_add_u32 m0, s69, 0
    v_mfma_f32_32x32x16_bf16 v[0:15], v[120:123], v[64:67], v[0:15]
    buffer_load_dwordx4 v159, s[32:35], s70 offen lds
    ds_read_b64_tr_b16 v[114:115], v157 offset:3072
    v_mfma_f32_32x32x16_bf16 v[16:31], v[124:127], v[64:67], v[16:31]
    buffer_load_dwordx4 v[64:67], v162, s[36:39], s74 offen sc1
    ds_read_b64_tr_b16 v[116:117], v158 offset:2048
    s_add_u32 m0, s69, 1024
    v_mfma_f32_32x32x16_bf16 v[32:47], v[120:123], v[68:71], v[32:47]
    buffer_load_dwordx4 v160, s[32:35], s70 offen lds
    s_add_u32 s70, s70, 0x4000
    s_cmp_eq_u32 s70, s63
    s_cselect_b32 s70, s62, s70
    ds_read_b64_tr_b16 v[118:119], v158 offset:3072
    v_mfma_f32_32x32x16_bf16 v[48:63], v[124:127], v[68:71], v[48:63]
    buffer_load_dwordx4 v[68:71], v162, s[52:55], s74 offen sc1
    s_add_u32 s74, s74, 0x400
    s_cmp_eq_u32 s74, s61
    s_cselect_b32 s74, s75, s74
    s_add_u32 m0, s72, 8192
    s_add_u32 s56, s59, 65536
    buffer_load_dwordx4 v159, s[40:43], s56 offen lds
    s_waitcnt lgkmcnt(0)
    s_waitcnt vmcnt(7)
    ds_read_b64_tr_b16 v[120:121], v157 offset:4096
    s_add_u32 m0, s69, 2048
    v_mfma_f32_32x32x16_bf16 v[0:15], v[112:115], v[72:75], v[0:15]
    buffer_load_dwordx4 v159, s[32:35], s70 offen lds
    ds_read_b64_tr_b16 v[122:123], v157 offset:5120
    v_mfma_f32_32x32x16_bf16 v[16:31], v[116:119], v[72:75], v[16:31]
    buffer_load_dwordx4 v[72:75], v162, s[36:39], s74 offen sc1
    ds_read_b64_tr_b16 v[124:125], v158 offset:4096
    s_add_u32 m0, s69, 3072
    v_mfma_f32_32x32x16_bf16 v[32:47], v[112:115], v[76:79], v[32:47]
    buffer_load_dwordx4 v160, s[32:35], s70 offen lds
    s_add_u32 s70, s70, 0x4000
    s_cmp_eq_u32 s70, s63
    s_cselect_b32 s70, s62, s70
    ds_read_b64_tr_b16 v[126:127], v158 offset:5120
    v_mfma_f32_32x32x16_bf16 v[48:63], v[116:119], v[76:79], v[48:63]
    buffer_load_dwordx4 v[76:79], v162, s[52:55], s74 offen sc1
    s_add_u32 s74, s74, 0x400
    s_cmp_eq_u32 s74, s61
    s_cselect_b32 s74, s75, s74
    s_add_u32 m0, s72, 9216
    s_nop 0
    buffer_load_dwordx4 v160, s[40:43], s56 offen lds
    s_waitcnt lgkmcnt(0)
    s_waitcnt vmcnt(7)
    ds_read_b64_tr_b16 v[112:113], v157 offset:0
    s_add_u32 m0, s69, 4096
    v_mfma_f32_32x32x16_bf16 v[0:15], v[120:123], v[80:83], v[0:15]
    buffer_load_dwordx4 v159, s[32:35], s70 offen lds
    ds_read_b64_tr_b16 v[114:115], v157 offset:1024
    v_mfma_f32_32x32x16_bf16 v[16:31], v[124:127], v[80:83], v[16:31]
    buffer_load_dwordx4 v[80:83], v162, s[36:39], s74 offen sc1
    ds_read_b64_tr_b16 v[116:117], v158 offset:0
    s_add_u32 m0, s69, 5120
    v_mfma_f32_32x32x16_bf16 v[32:47], v[120:123], v[84:87], v[32:47]
    buffer_load_dwordx4 v160, s[32:35], s70 offen lds
    s_add_u32 s70, s70, 0x4000
    s_cmp_eq_u32 s70, s63
    s_cselect_b32 s70, s62, s70
    ds_read_b64_tr_b16 v[118:119], v158 offset:1024
    v_mfma_f32_32x32x16_bf16 v[48:63], v[124:127], v[84:87], v[48:63]
    buffer_load_dwordx4 v[84:87], v162, s[52:55], s74 offen sc1
    s_add_u32 s74, s74, 0x400
    s_cmp_eq_u32 s74, s61
    s_cselect_b32 s74, s75, s74
    s_add_u32 m0, s72, 10240
    s_add_u32 s56, s59, 81920
    buffer_load_dwordx4 v159, s[40:43], s56 offen lds
    s_waitcnt lgkmcnt(0)
    s_waitcnt vmcnt(7)
    ds_read_b64_tr_b16 v[120:121], v157 offset:2048
    s_add_u32 m0, s69, 0
    v_mfma_f32_32x32x16_bf16 v[0:15], v[112:115], v[64:67], v[0:15]
    buffer_load_dwordx4 v159, s[32:35], s70 offen lds
    ds_read_b64_tr_b16 v[122:123], v157 offset:3072
    v_mfma_f32_32x32x16_bf16 v[16:31], v[116:119], v[64:67], v[16:31]
    buffer_load_dwordx4 v[64:67], v162, s[36:39], s74 offen sc1
    ds_read_b64_tr_b16 v[124:125], v158 offset:2048
    s_add_u32 m0, s69, 1024
    v_mfma_f32_32x32x16_bf16 v[32:47], v[112:115], v[68:71], v[32:47]
    buffer_load_dwordx4 v160, s[32:35], s70 offen lds
    s_add_u32 s70, s70, 0x4000
    s_cmp_eq_u32 s70, s63
    s_cselect_b32 s70, s62, s70
    ds_read_b64_tr_b16 v[126:127], v158 offset:3072
    v_mfma_f32_32x32x16_bf16 v[48:63], v[116:119], v[68:71], v[48:63]
    buffer_load_dwordx4 v[68:71], v162, s[52:55], s74 offen sc1
    s_add_u32 s74, s74, 0x400
    s_cmp_eq_u32 s74, s61
    s_cselect_b32 s74, s75, s74
    s_add_u32 m0, s72, 11264
    s_nop 0
    buffer_load_dwordx4 v160, s[40:43], s56 offen lds
    s_waitcnt lgkmcnt(0)
    s_waitcnt vmcnt(7)
    ds_read_b64_tr_b16 v[112:113], v157 offset:4096
    s_add_u32 m0, s69, 2048
    v_mfma_f32_32x32x16_bf16 v[0:15], v[120:123], v[72:75], v[0:15]
    buffer_load_dwordx4 v159, s[32:35], s70 offen lds
    ds_read_b64_tr_b16 v[114:115], v157 offset:5120
    v_mfma_f32_32x32x16_bf16 v[16:31], v[124:127], v[72:75], v[16:31]
    buffer_load_dwordx4 v[72:75], v162, s[36:39], s74 offen sc1
    ds_read_b64_tr_b16 v[116:117], v158 offset:4096
    s_add_u32 m0, s69, 3072
    v_mfma_f32_32x32x16_bf16 v[32:47], v[120:123], v[76:79], v[32:47]
    buffer_load_dwordx4 v160, s[32:35], s70 offen lds
    s_add_u32 s70, s70, 0x4000
    s_cmp_eq_u32 s70, s63
    s_cselect_b32 s70, s62, s70
    ds_read_b64_tr_b16 v[118:119], v158 offset:5120
    v_mfma_f32_32x32x16_bf16 v[48:63], v[124:127], v[76:79], v[48:63]
    buffer_load_dwordx4 v[76:79], v162, s[52:55], s74 offen sc1
    s_add_u32 s74, s74, 0x400
    s_cmp_eq_u32 s74, s61
    s_cselect_b32 s74, s75, s74
    s_add_u32 m0, s69, 12288
    s_add_u32 s56, s59, 98304
    buffer_load_dwordx4 v159, s[40:43], s56 offen lds
    s_waitcnt lgkmcnt(0)
    s_waitcnt vmcnt(7)
    ds_read_b64_tr_b16 v[120:121], v157 offset:0
    s_add_u32 m0, s69, 4096
    v_mfma_f32_32x32x16_bf16 v[0:15], v[112:115], v[80:83], v[0:15]
    buffer_load_dwordx4 v159, s[32:35], s70 offen lds
    ds_read_b64_tr_b16 v[122:123], v157 offset:1024
    v_mfma_f32_32x32x16_bf16 v[16:31], v[116:119], v[80:83], v[16:31]
    buffer_load_dwordx4 v[80:83], v162, s[36:39], s74 offen sc1
    ds_read_b64_tr_b16 v[124:125], v158 offset:0
    s_add_u32 m0, s69, 5120
    v_mfma_f32_32x32x16_bf16 v[32:47], v[112:115], v[84:87], v[32:47]
    buffer_load_dwordx4 v160, s[32:35], s70 offen lds
    s_add_u32 s70, s70, 0x4000
    s_cmp_eq_u32 s70, s63
    s_cselect_b32 s70, s62, s70
    ds_read_b64_tr_b16 v[126:127], v158 offset:1024
    v_mfma_f32_32x32x16_bf16 v[48:63], v[116:119], v[84:87], v[48:63]
    buffer_load_dwordx4 v[84:87], v162, s[52:55], s74 offen sc1
    s_add_u32 s74, s74, 0x400
    s_cmp_eq_u32 s74, s61
    s_cselect_b32 s74, s75, s74
    s_add_u32 m0, s69, 13312
    s_nop 0
    buffer_load_dwordx4 v160, s[40:43], s56 offen lds
    s_waitcnt lgkmcnt(0)
    s_waitcnt vmcnt(7)
    ds_read_b64_tr_b16 v[112:113], v157 offset:2048
    s_add_u32 m0, s69, 0
    v_mfma_f32_32x32x16_bf16 v[0:15], v[120:123], v[64:67], v[0:15]
    buffer_load_dwordx4 v159, s[32:35], s70 offen lds
    ds_read_b64_tr_b16 v[114:115], v157 offset:3072
    v_mfma_f32_32x32x16_bf16 v[16:31], v[124:127], v[64:67], v[16:31]
    buffer_load_dwordx4 v[64:67], v162, s[36:39], s74 offen sc1
    ds_read_b64_tr_b16 v[116:117], v158 offset:2048
    s_add_u32 m0, s69, 1024
    v_mfma_f32_32x32x16_bf16 v[32:47], v[120:123], v[68:71], v[32:47]
    buffer_load_dwordx4 v160, s[32:35], s70 offen lds
    s_add_u32 s70, s70, 0x4000
    s_cmp_eq_u32 s70, s63
    s_cselect_b32 s70, s62, s70
    ds_read_b64_tr_b16 v[118:119], v158 offset:3072
    v_mfma_f32_32x32x16_bf16 v[48:63], v[124:127], v[68:71], v[48:63]
    buffer_load_dwordx4 v[68:71], v162, s[52:55], s74 offen sc1
    s_add_u32 s74, s74, 0x400
    s_cmp_eq_u32 s74, s61
    s_cselect_b32 s74, s75, s74
    s_add_u32 m0, s69, 14336
    s_add_u32 s56, s59, 114688
    buffer_load_dwordx4 v159, s[40:43], s56 offen lds
    s_waitcnt lgkmcnt(0)
    s_waitcnt vmcnt(7)
    ds_read_b64_tr_b16 v[120:121], v157 offset:4096
    s_add_u32 m0, s69, 2048
    v_mfma_f32_32x32x16_bf16 v[0:15], v[112:115], v[72:75], v[0:15]
    buffer_load_dwordx4 v159, s[32:35], s70 offen lds
    ds_read_b64_tr_b16 v[122:123], v157 offset:5120
    v_mfma_f32_32x32x16_bf16 v[16:31], v[116:119], v[72:75], v[16:31]
    buffer_load_dwordx4 v[72:75], v162, s[36:39], s74 offen sc1
    ds_read_b64_tr_b16 v[124:125], v158 offset:4096
    s_add_u32 m0, s69, 3072
    v_mfma_f32_32x32x16_bf16 v[32:47], v[112:115], v[76:79], v[32:47]
    buffer_load_dwordx4 v160, s[32:35], s70 offen lds
    s_add_u32 s70, s70, 0x4000
    s_cmp_eq_u32 s70, s63
    s_cselect_b32 s70, s62, s70
    ds_read_b64_tr_b16 v[126:127], v158 offset:5120
    v_mfma_f32_32x32x16_bf16 v[48:63], v[116:119], v[76:79], v[48:63]
    buffer_load_dwordx4 v[76:79], v162, s[52:55], s74 offen sc1
    s_add_u32 s74, s74, 0x400
    s_cmp_eq_u32 s74, s61
    s_cselect_b32 s74, s75, s74
    s_add_u32 m0, s69, 15360
    s_nop 0
    buffer_load_dwordx4 v160, s[40:43], s56 offen lds
    s_waitcnt lgkmcnt(0)
    s_waitcnt vmcnt(7)
    ds_read_b64_tr_b16 v[112:113], v157 offset:0
    s_add_u32 m0, s69, 4096
    v_mfma_f32_32x32x16_bf16 v[0:15], v[120:123], v[80:83], v[0:15]
    buffer_load_dwordx4 v159, s[32:35], s70 offen lds
    ds_read_b64_tr_b16 v[114:115], v157 offset:1024
    v_mfma_f32_32x32x16_bf16 v[16:31], v[124:127], v[80:83], v[16:31]
    buffer_load_dwordx4 v[80:83], v162, s[36:39], s74 offen sc1
    ds_read_b64_tr_b16 v[116:117], v158 offset:0
    s_add_u32 m0, s69, 5120
    v_mfma_f32_32x32x16_bf16 v[32:47], v[120:123], v[84:87], v[32:47]
    buffer_load_dwordx4 v160, s[32:35], s70 offen lds
    s_add_u32 s70, s70, 0x4000
    s_cmp_eq_u32 s70, s63
    s_cselect_b32 s70, s62, s70
    ds_read_b64_tr_b16 v[118:119], v158 offset:1024
    v_mfma_f32_32x32x16_bf16 v[48:63], v[124:127], v[84:87], v[48:63]
    buffer_load_dwordx4 v[84:87], v162, s[52:55], s74 offen sc1
    s_add_u32 s74, s74, 0x400
    s_cmp_eq_u32 s74, s61
    s_cselect_b32 s74, s75, s74
    s_waitcnt lgkmcnt(0)
    s_waitcnt vmcnt(6)
    ds_read_b64_tr_b16 v[120:121], v157 offset:2048
    s_add_u32 m0, s69, 0
    v_mfma_f32_32x32x16_bf16 v[0:15], v[112:115], v[64:67], v[0:15]
    buffer_load_dwordx4 v159, s[32:35], s70 offen lds
    ds_read_b64_tr_b16 v[122:123], v157 offset:3072
    v_mfma_f32_32x32x16_bf16 v[16:31], v[116:119], v[64:67], v[16:31]
    buffer_load_dwordx4 v[64:67], v162, s[36:39], s74 offen sc1
    ds_read_b64_tr_b16 v[124:125], v158 offset:2048
    s_add_u32 m0, s69, 1024
    v_mfma_f32_32x32x16_bf16 v[32:47], v[112:115], v[68:71], v[32:47]
    buffer_load_dwordx4 v160, s[32:35], s70 offen lds
    s_add_u32 s70, s70, 0x4000
    s_cmp_eq_u32 s70, s63
    s_cselect_b32 s70, s62, s70
    ds_read_b64_tr_b16 v[126:127], v158 offset:3072
    v_mfma_f32_32x32x16_bf16 v[48:63], v[116:119], v[68:71], v[48:63]
    buffer_load_dwordx4 v[68:71], v162, s[52:55], s74 offen sc1
    s_add_u32 s74, s74, 0x400
    s_cmp_eq_u32 s74, s61
    s_cselect_b32 s74, s75, s74
    s_waitcnt lgkmcnt(0)
    s_waitcnt vmcnt(5)
    ds_read_b64_tr_b16 v[112:113], v157 offset:4096
    v_mfma_f32_32x32x16_bf16 v[0:15], v[120:123], v[72:75], v[0:15]
    ds_read_b64_tr_b16 v[114:115], v157 offset:5120
    v_mfma_f32_32x32x16_bf16 v[16:31], v[124:127], v[72:75], v[16:31]
    ds_read_b64_tr_b16 v[116:117], v158 offset:4096
    v_mfma_f32_32x32x16_bf16 v[32:47], v[120:123], v[76:79], v[32:47]
    ds_read_b64_tr_b16 v[118:119], v158 offset:5120
    v_mfma_f32_32x32x16_bf16 v[48:63], v[124:127], v[76:79], v[48:63]
    s_waitcnt lgkmcnt(0)
    s_waitcnt vmcnt(1)
    ds_read_b64_tr_b16 v[120:121], v157 offset:0
    v_mfma_f32_32x32x16_bf16 v[0:15], v[112:115], v[80:83], v[0:15]
    ds_read_b64_tr_b16 v[122:123], v157 offset:1024
    v_mfma_f32_32x32x16_bf16 v[16:31], v[116:119], v[80:83], v[16:31]
    ds_read_b64_tr_b16 v[124:125], v158 offset:0
    v_mfma_f32_32x32x16_bf16 v[32:47], v[112:115], v[84:87], v[32:47]
    ds_read_b64_tr_b16 v[126:127], v158 offset:1024
    v_mfma_f32_32x32x16_bf16 v[48:63], v[116:119], v[84:87], v[48:63]
    s_waitcnt lgkmcnt(0)
    s_waitcnt vmcnt(0)
    v_mfma_f32_32x32x16_bf16 v[0:15], v[120:123], v[64:67], v[0:15]
    v_mfma_f32_32x32x16_bf16 v[16:31], v[124:127], v[64:67], v[16:31]
    v_mfma_f32_32x32x16_bf16 v[32:47], v[120:123], v[68:71], v[32:47]
    v_mfma_f32_32x32x16_bf16 v[48:63], v[124:127], v[68:71], v[48:63]
    s_setprio 3
    s_sub_u32 s57, s72, s69
    v_add_u32 v159, s57, v157
    v_add_u32 v160, s57, v158
    s_lshl_b32 s62, s4, 16
    s_lshl_b32 s57, s64, 13
    s_add_u32 s62, s62, s57
    s_add_u32 s62, s62, 262144
    s_lshl_b32 s63, s4, 12
    s_lshl_b32 s57, s64, 10
    s_add_u32 s63, s63, s57
    s_xor_b32 s56, s71, 0
    s_lshl_b32 s58, s56, 7
    s_lshl_b32 s56, s56, 12
    s_add_u32 s56, s56, s69
    v_xor_b32 v128, s58, v162
    v_add_u32 v128, s56, v128
    v_xor_b32 v129, 32, v128
    s_xor_b32 s56, s71, 1
    s_lshl_b32 s58, s56, 7
    s_lshl_b32 s56, s56, 12
    s_add_u32 s56, s56, s69
    v_xor_b32 v130, s58, v162
    v_add_u32 v130, s56, v130
    v_xor_b32 v131, 32, v130
    v_and_b32 v142, 7, v167
    v_lshrrev_b32 v143, 3, v167
    s_lshl_b32 s56, s71, 4
    v_add_u32 v143, s56, v143
    v_lshlrev_b32 v140, 1, v142
    v_xor_b32 v140, v140, v143
    v_lshlrev_b32 v140, 4, v140
    v_lshl_add_u32 v140, v142, 10, v140
    v_xor_b32 v141, 0x80, v140
    s_add_u32 s57, s63, 8126464
    s_mov_b32 s76, 0x40000
L_spin_81:
    ds_read_b32 v143, v165 offset:248
    s_waitcnt lgkmcnt(0)
    v_readfirstlane_b32 s77, v143
    s_nop 0
    s_cmp_ge_u32 s77, 1
    s_cbranch_scc1 L_spun_82
    s_sleep 1
    s_sub_u32 s76, s76, 1
    s_cbranch_scc0 L_spin_81
L_spun_82:
    s_mov_b32 s76, 0x8000
    s_mov_b32 exec_lo, 0xff
    s_mov_b32 exec_hi, 0
L_poll_83:
    buffer_load_dword v143, v163, s[48:51], s57 offen sc1
    s_waitcnt vmcnt(0)
    v_cmp_eq_u32 vcc, s6, v143
    s_nop 0
    s_cmp_eq_u64 vcc, exec
    s_cbranch_scc1 L_polled_84
    s_sleep 4
    s_sub_u32 s76, s76, 1
    s_cbranch_scc0 L_poll_83
L_polled_84:
    s_mov_b64 exec, -1
    s_mov_b32 s76, 0x40000
L_spin_85:
    ds_read_b32 v143, v165 offset:248
    s_waitcnt lgkmcnt(0)
    v_readfirstlane_b32 s77, v143
    s_nop 0
    s_cmp_ge_u32 s77, 4
    s_cbranch_scc1 L_spun_86
    s_sub_u32 s76, s76, 1
    s_cbranch_scc0 L_spin_85
L_spun_86:
    s_add_u32 s58, s62, 0
    s_add_u32 s59, s58, 0x1000
    buffer_load_dwordx4 v[64:67], v162, s[48:51], s58 offen offset:0 sc1
    buffer_load_dwordx4 v[68:71], v162, s[48:51], s58 offen offset:1024 sc1
    buffer_load_dwordx4 v[72:75], v162, s[48:51], s58 offen offset:2048 sc1
    buffer_load_dwordx4 v[76:79], v162, s[48:51], s58 offen offset:3072 sc1
    buffer_load_dwordx4 v[80:83], v162, s[48:51], s59 offen offset:0 sc1
    buffer_load_dwordx4 v[84:87], v162, s[48:51], s59 offen offset:1024 sc1
    buffer_load_dwordx4 v[88:91], v162, s[48:51], s59 offen offset:2048 sc1
    buffer_load_dwordx4 v[92:95], v162, s[48:51], s59 offen offset:3072 sc1
    s_add_u32 s57, s63, 8257536
    s_waitcnt vmcnt(0)
    s_mov_b64 exec, 0xff
    buffer_load_dword v143, v163, s[48:51], s57 offen sc1
    s_mov_b64 exec, -1
    ds_read_b64_tr_b16 v[144:145], v160 offset:0
    ds_read_b64_tr_b16 v[146:147], v160 offset:1024
    ds_read_b64_tr_b16 v[148:149], v159 offset:0
    ds_read_b64_tr_b16 v[150:151], v159 offset:1024
    ds_read_b64_tr_b16 v[152:153], v160 offset:2048
    ds_read_b64_tr_b16 v[154:155], v160 offset:3072
    s_waitcnt lgkmcnt(4)
    v_mfma_f32_32x32x16_bf16 v[16:31], v[144:147], v[64:67], v[16:31]
    ds_read_b64_tr_b16 v[144:145], v159 offset:2048
    ds_read_b64_tr_b16 v[146:147], v159 offset:3072
    s_waitcnt lgkmcnt(4)
    v_mfma_f32_32x32x16_bf16 v[0:15], v[148:151], v[64:67], v[0:15]
    ds_read_b64_tr_b16 v[148:149], v160 offset:4096
    ds_read_b64_tr_b16 v[150:151], v160 offset:5120
    s_waitcnt lgkmcnt(4)
    v_mfma_f32_32x32x16_bf16 v[16:31], v[152:155], v[68:71], v[16:31]
    ds_read_b64_tr_b16 v[152:153], v159 offset:4096
    ds_read_b64_tr_b16 v[154:155], v159 offset:5120
    s_waitcnt lgkmcnt(4)
    v_mfma_f32_32x32x16_bf16 v[0:15], v[144:147], v[68:71], v[0:15]
    ds_read_b64_tr_b16 v[144:145], v160 offset:6144
    ds_read_b64_tr_b16 v[146:147], v160 offset:7168
    s_waitcnt lgkmcnt(4)
    v_mfma_f32_32x32x16_bf16 v[16:31], v[148:151], v[72:75], v[16:31]
    ds_read_b64_tr_b16 v[148:149], v159 offset:6144
    ds_read_b64_tr_b16 v[150:151], v159 offset:7168
    s_waitcnt lgkmcnt(4)
    v_mfma_f32_32x32x16_bf16 v[0:15], v[152:155], v[72:75], v[0:15]
    ds_read_b64_tr_b16 v[152:153], v160 offset:8192
    ds_read_b64_tr_b16 v[154:155], v160 offset:9216
    s_waitcnt lgkmcnt(4)
    v_mfma_f32_32x32x16_bf16 v[16:31], v[144:147], v[76:79], v[16:31]
    ds_read_b64_tr_b16 v[144:145], v159 offset:8192
    ds_read_b64_tr_b16 v[146:147], v159 offset:9216
    s_waitcnt lgkmcnt(4)
    v_mfma_f32_32x32x16_bf16 v[0:15], v[148:151], v[76:79], v[0:15]
    ds_read_b64_tr_b16 v[148:149], v160 offset:10240
    ds_read_b64_tr_b16 v[150:151], v160 offset:11264
    s_waitcnt lgkmcnt(4)
    v_mfma_f32_32x32x16_bf16 v[16:31], v[152:155], v[80:83], v[16:31]
    ds_read_b64_tr_b16 v[152:153], v159 offset:10240
    ds_read_b64_tr_b16 v[154:155], v159 offset:11264
    s_waitcnt lgkmcnt(4)
    v_mfma_f32_32x32x16_bf16 v[0:15], v[144:147], v[80:83], v[0:15]
    ds_read_b64_tr_b16 v[144:145], v158 offset:12288
    ds_read_b64_tr_b16 v[146:147], v158 offset:13312
    s_waitcnt lgkmcnt(4)
    v_mfma_f32_32x32x16_bf16 v[16:31], v[148:151], v[84:87], v[16:31]
    ds_read_b64_tr_b16 v[148:149], v157 offset:12288
    ds_read_b64_tr_b16 v[150:151], v157 offset:13312
    s_waitcnt lgkmcnt(4)
    v_mfma_f32_32x32x16_bf16 v[0:15], v[152:155], v[84:87], v[0:15]
    ds_read_b64_tr_b16 v[152:153], v158 offset:14336
    ds_read_b64_tr_b16 v[154:155], v158 offset:15360
    s_waitcnt lgkmcnt(4)
    v_mfma_f32_32x32x16_bf16 v[16:31], v[144:147], v[88:91], v[16:31]
    ds_read_b64_tr_b16 v[144:145], v157 offset:14336
    ds_read_b64_tr_b16 v[146:147], v157 offset:15360
    s_waitcnt lgkmcnt(4)
    v_mfma_f32_32x32x16_bf16 v[0:15], v[148:151], v[88:91], v[0:15]
    s_waitcnt lgkmcnt(2)
    v_mfma_f32_32x32x16_bf16 v[16:31], v[152:155], v[92:95], v[16:31]
    s_waitcnt lgkmcnt(0)
    v_mfma_f32_32x32x16_bf16 v[0:15], v[144:147], v[92:95], v[0:15]
    s_waitcnt vmcnt(0)
    s_mov_b64 exec, 0xff
    v_cmp_ne_u32 vcc, s6, v143
    s_mov_b64 exec, -1
    s_cbranch_vccz L_o1
    s_mov_b32 s76, 0x8000
    s_mov_b32 exec_lo, 0xff
    s_mov_b32 exec_hi, 0
L_poll_87:
    buffer_load_dword v143, v163, s[48:51], s57 offen sc1
    s_waitcnt vmcnt(0)
    v_cmp_eq_u32 vcc, s6, v143
    s_nop 0
    s_cmp_eq_u64 vcc, exec
    s_cbranch_scc1 L_polled_88
    s_sleep 4
    s_sub_u32 s76, s76, 1
    s_cbranch_scc0 L_poll_87
L_polled_88:
    s_mov_b64 exec, -1
L_o1:
    s_add_u32 s58, s62, 32768
    s_add_u32 s59, s58, 0x1000
    buffer_load_dwordx4 v[96:99], v162, s[48:51], s58 offen offset:0 sc1
    buffer_load_dwordx4 v[100:103], v162, s[48:51], s58 offen offset:1024 sc1
    buffer_load_dwordx4 v[104:107], v162, s[48:51], s58 offen offset:2048 sc1
    buffer_load_dwordx4 v[108:111], v162, s[48:51], s58 offen offset:3072 sc1
    buffer_load_dwordx4 v[112:115], v162, s[48:51], s59 offen offset:0 sc1
    buffer_load_dwordx4 v[116:119], v162, s[48:51], s59 offen offset:1024 sc1
    buffer_load_dwordx4 v[120:123], v162, s[48:51], s59 offen offset:2048 sc1
    buffer_load_dwordx4 v[124:127], v162, s[48:51], s59 offen offset:3072 sc1
    ds_write_b128 v130, v[16:19] offset:0
    ds_write_b128 v131, v[20:23] offset:1024
    v_xor_b32 v130, 64, v130
    v_xor_b32 v131, 64, v131
    ds_write_b128 v130, v[24:27] offset:2048
    ds_write_b128 v131, v[28:31] offset:3072
    ds_write_b128 v128, v[0:3] offset:0
    ds_write_b128 v129, v[4:7] offset:1024
    v_xor_b32 v128, 64, v128
    v_xor_b32 v129, 64, v129
    ds_write_b128 v128, v[8:11] offset:2048
    ds_write_b128 v129, v[12:15] offset:3072
    s_mov_b64 exec, 1
    ds_inc_u32 v165, v164 offset:200
    s_mov_b64 exec, -1
    s_xor_b32 s56, s71, 0
    s_lshl_b32 s58, s56, 7
    s_lshl_b32 s56, s56, 12
    s_add_u32 s56, s56, s69
    v_xor_b32 v128, s58, v162
    v_add_u32 v128, s56, v128
    v_xor_b32 v129, 32, v128
    s_xor_b32 s56, s71, 1
    s_lshl_b32 s58, s56, 7
    s_lshl_b32 s56, s56, 12
    s_add_u32 s56, s56, s69
    v_xor_b32 v130, s58, v162
    v_add_u32 v130, s56, v130
    v_xor_b32 v131, 32, v130
    ds_read_b64_tr_b16 v[144:145], v160 offset:0
    ds_read_b64_tr_b16 v[146:147], v160 offset:1024
    ds_read_b64_tr_b16 v[148:149], v159 offset:0
    ds_read_b64_tr_b16 v[150:151], v159 offset:1024
    ds_read_b64_tr_b16 v[152:153], v160 offset:2048
    ds_read_b64_tr_b16 v[154:155], v160 offset:3072
    s_waitcnt lgkmcnt(4)
    s_waitcnt vmcnt(7)
    v_mfma_f32_32x32x16_bf16 v[48:63], v[144:147], v[96:99], v[48:63]
    ds_read_b64_tr_b16 v[144:145], v159 offset:2048
    ds_read_b64_tr_b16 v[146:147], v159 offset:3072
    s_waitcnt lgkmcnt(4)
    v_mfma_f32_32x32x16_bf16 v[32:47], v[148:151], v[96:99], v[32:47]
    ds_read_b64_tr_b16 v[148:149], v160 offset:4096
    ds_read_b64_tr_b16 v[150:151], v160 offset:5120
    s_waitcnt lgkmcnt(4)
    s_waitcnt vmcnt(6)
    v_mfma_f32_32x32x16_bf16 v[48:63], v[152:155], v[100:103], v[48:63]
    ds_read_b64_tr_b16 v[152:153], v159 offset:4096
    ds_read_b64_tr_b16 v[154:155], v159 offset:5120
    s_waitcnt lgkmcnt(4)
    v_mfma_f32_32x32x16_bf16 v[32:47], v[144:147], v[100:103], v[32:47]
    ds_read_b64_tr_b16 v[144:145], v160 offset:6144
    ds_read_b64_tr_b16 v[146:147], v160 offset:7168
    s_waitcnt lgkmcnt(4)
    s_waitcnt vmcnt(5)
    v_mfma_f32_32x32x16_bf16 v[48:63], v[148:151], v[104:107], v[48:63]
    ds_read_b64_tr_b16 v[148:149], v159 offset:6144
    ds_read_b64_tr_b16 v[150:151], v159 offset:7168
    s_waitcnt lgkmcnt(4)
    v_mfma_f32_32x32x16_bf16 v[32:47], v[152:155], v[104:107], v[32:47]
    ds_read_b64_tr_b16 v[152:153], v160 offset:8192
    ds_read_b64_tr_b16 v[154:155], v160 offset:9216
    s_waitcnt lgkmcnt(4)
    s_waitcnt vmcnt(4)
    v_mfma_f32_32x32x16_bf16 v[48:63], v[144:147], v[108:111], v[48:63]
    ds_read_b64_tr_b16 v[144:145], v159 offset:8192
    ds_read_b64_tr_b16 v[146:147], v159 offset:9216
    s_waitcnt lgkmcnt(4)
    v_mfma_f32_32x32x16_bf16 v[32:47], v[148:151], v[108:111], v[32:47]
    ds_read_b64_tr_b16 v[148:149], v160 offset:10240
    ds_read_b64_tr_b16 v[150:151], v160 offset:11264
    s_waitcnt lgkmcnt(4)
    s_waitcnt vmcnt(3)
    v_mfma_f32_32x32x16_bf16 v[48:63], v[152:155], v[112:115], v[48:63]
    ds_read_b64_tr_b16 v[152:153], v159 offset:10240
    ds_read_b64_tr_b16 v[154:155], v159 offset:11264
    s_waitcnt lgkmcnt(4)
    v_mfma_f32_32x32x16_bf16 v[32:47], v[144:147], v[112:115], v[32:47]
    ds_read_b64_tr_b16 v[144:145], v158 offset:12288
    ds_read_b64_tr_b16 v[146:147], v158 offset:13312
    s_waitcnt lgkmcnt(4)
    s_waitcnt vmcnt(2)
    v_mfma_f32_32x32x16_bf16 v[48:63], v[148:151], v[116:119], v[48:63]
    ds_read_b64_tr_b16 v[148:149], v157 offset:12288
    ds_read_b64_tr_b16 v[150:151], v157 offset:13312
    s_waitcnt lgkmcnt(4)
    v_mfma_f32_32x32x16_bf16 v[32:47], v[152:155], v[116:119], v[32:47]
    ds_read_b64_tr_b16 v[152:153], v158 offset:14336
    ds_read_b64_tr_b16 v[154:155], v158 offset:15360
    s_waitcnt lgkmcnt(4)
    s_waitcnt vmcnt(1)
    v_mfma_f32_32x32x16_bf16 v[48:63], v[144:147], v[120:123], v[48:63]
    ds_read_b64_tr_b16 v[144:145], v157 offset:14336
    ds_read_b64_tr_b16 v[146:147], v157 offset:15360
    s_waitcnt lgkmcnt(4)
    v_mfma_f32_32x32x16_bf16 v[32:47], v[148:151], v[120:123], v[32:47]
    s_waitcnt lgkmcnt(2)
    s_waitcnt vmcnt(0)
    v_mfma_f32_32x32x16_bf16 v[48:63], v[152:155], v[124:127], v[48:63]
    s_waitcnt lgkmcnt(0)
    v_mfma_f32_32x32x16_bf16 v[32:47], v[144:147], v[124:127], v[32:47]
    s_nop 9
    ds_write_b128 v130, v[48:51] offset:8192
    ds_write_b128 v131, v[52:55] offset:9216
    v_xor_b32 v130, 64, v130
    v_xor_b32 v131, 64, v131
    ds_write_b128 v130, v[56:59] offset:10240
    ds_write_b128 v131, v[60:63] offset:11264
    ds_write_b128 v128, v[32:35] offset:8192
    ds_write_b128 v129, v[36:39] offset:9216
    v_xor_b32 v128, 64, v128
    v_xor_b32 v129, 64, v129
    ds_write_b128 v128, v[40:43] offset:10240
    ds_write_b128 v129, v[44:47] offset:11264
    s_mov_b64 exec, 1
    ds_inc_u32 v165, v164 offset:216
    s_mov_b64 exec, -1
    v_lshlrev_b32 v112, 16, v132
    v_and_b32 v113, 0xffff0000, v132
    v_lshlrev_b32 v114, 16, v133
    v_and_b32 v115, 0xffff0000, v133
    v_lshlrev_b32 v116, 16, v134
    v_and_b32 v117, 0xffff0000, v134
    v_lshlrev_b32 v118, 16, v135
    v_and_b32 v119, 0xffff0000, v135
    v_lshlrev_b32 v120, 16, v136
    v_and_b32 v121, 0xffff0000, v136
    v_lshlrev_b32 v122, 16, v137
    v_and_b32 v123, 0xffff0000, v137
    v_lshlrev_b32 v124, 16, v138
    v_and_b32 v125, 0xffff0000, v138
    v_lshlrev_b32 v126, 16, v139
    v_and_b32 v127, 0xffff0000, v139
    s_cmp_lt_u32 s64, 2
    s_cbranch_scc0 L_own1
    s_mov_b32 s76, 0x40000
L_spin_89:
    ds_read_b32 v143, v165 offset:200
    s_waitcnt lgkmcnt(0)
    v_readfirstlane_b32 s77, v143
    s_nop 0
    s_cmp_ge_u32 s77, 4
    s_cbranch_scc1 L_spun_90
    s_sub_u32 s76, s76, 1
    s_cbranch_scc0 L_spin_89
L_spun_90:
    ds_read_b128 v[0:3], v140 offset:0
    ds_read_b128 v[4:7], v140 offset:512
    ds_read_b128 v[8:11], v141 offset:0
    ds_read_b128 v[12:15], v141 offset:512
    ds_read_b128 v[16:19], v140 offset:16384
    ds_read_b128 v[20:23], v140 offset:16896
    ds_read_b128 v[24:27], v141 offset:16384
    ds_read_b128 v[28:31], v141 offset:16896
    ds_read_b128 v[32:35], v140 offset:32768
    ds_read_b128 v[36:39], v140 offset:33280
    ds_read_b128 v[40:43], v141 offset:32768
    ds_read_b128 v[44:47], v141 offset:33280
    s_waitcnt lgkmcnt(8)
    ds_read_b128 v[48:51], v140 offset:49152
    ds_read_b128 v[52:55], v140 offset:49664
    ds_read_b128 v[56:59], v141 offset:49152
    ds_read_b128 v[60:63], v141 offset:49664
    s_branch L_own
L_own1:
    s_mov_b32 s76, 0x40000
L_spin_91:
    ds_read_b32 v143, v165 offset:216
    s_waitcnt lgkmcnt(0)
    v_readfirstlane_b32 s77, v143
    s_nop 0
    s_cmp_ge_u32 s77, 4
    s_cbranch_scc1 L_spun_92
    s_sub_u32 s76, s76, 1
    s_cbranch_scc0 L_spin_91
L_spun_92:
    ds_read_b128 v[0:3], v140 offset:8192
    ds_read_b128 v[4:7], v140 offset:8704
    ds_read_b128 v[8:11], v141 offset:8192
    ds_read_b128 v[12:15], v141 offset:8704
    ds_read_b128 v[16:19], v140 offset:24576
    ds_read_b128 v[20:23], v140 offset:25088
    ds_read_b128 v[24:27], v141 offset:24576
    ds_read_b128 v[28:31], v141 offset:25088
    ds_read_b128 v[32:35], v140 offset:40960
    ds_read_b128 v[36:39], v140 offset:41472
    ds_read_b128 v[40:43], v141 offset:40960
    ds_read_b128 v[44:47], v141 offset:41472
    s_waitcnt lgkmcnt(8)
    ds_read_b128 v[48:51], v140 offset:57344
    ds_read_b128 v[52:55], v140 offset:57856
    ds_read_b128 v[56:59], v141 offset:57344
    ds_read_b128 v[60:63], v141 offset:57856
L_own:
    s_waitcnt lgkmcnt(12)
    v_pk_add_f32 v[112:113], v[112:113], v[0:1]
    v_pk_add_f32 v[114:115], v[114:115], v[2:3]
    v_pk_add_f32 v[116:117], v[116:117], v[4:5]
    v_pk_add_f32 v[118:119], v[118:119], v[6:7]
    v_pk_add_f32 v[120:121], v[120:121], v[8:9]
    v_pk_add_f32 v[122:123], v[122:123], v[10:11]
    v_pk_add_f32 v[124:125], v[124:125], v[12:13]
    v_pk_add_f32 v[126:127], v[126:127], v[14:15]
    s_waitcnt lgkmcnt(8)
    v_pk_add_f32 v[112:113], v[112:113], v[16:17]
    v_pk_add_f32 v[114:115], v[114:115], v[18:19]
    v_pk_add_f32 v[116:117], v[116:117], v[20:21]
    v_pk_add_f32 v[118:119], v[118:119], v[22:23]
    v_pk_add_f32 v[120:121], v[120:121], v[24:25]
    v_pk_add_f32 v[122:123], v[122:123], v[26:27]
    v_pk_add_f32 v[124:125], v[124:125], v[28:29]
    v_pk_add_f32 v[126:127], v[126:127], v[30:31]
    s_waitcnt lgkmcnt(4)
    v_pk_add_f32 v[112:113], v[112:113], v[32:33]
    v_pk_add_f32 v[114:115], v[114:115], v[34:35]
    v_pk_add_f32 v[116:117], v[116:117], v[36:37]
    v_pk_add_f32 v[118:119], v[118:119], v[38:39]
    v_pk_add_f32 v[120:121], v[120:121], v[40:41]
    v_pk_add_f32 v[122:123], v[122:123], v[42:43]
    v_pk_add_f32 v[124:125], v[124:125], v[44:45]
    v_pk_add_f32 v[126:127], v[126:127], v[46:47]
    s_waitcnt lgkmcnt(0)
    v_pk_add_f32 v[112:113], v[112:113], v[48:49]
    v_pk_add_f32 v[114:115], v[114:115], v[50:51]
    v_pk_add_f32 v[116:117], v[116:117], v[52:53]
    v_pk_add_f32 v[118:119], v[118:119], v[54:55]
    v_pk_add_f32 v[120:121], v[120:121], v[56:57]
    v_pk_add_f32 v[122:123], v[122:123], v[58:59]
    v_pk_add_f32 v[124:125], v[124:125], v[60:61]
    v_pk_add_f32 v[126:127], v[126:127], v[62:63]
    v_cvt_pk_bf16_f32 v64, v112, v113
    v_cvt_pk_bf16_f32 v65, v114, v115
    v_cvt_pk_bf16_f32 v66, v116, v117
    v_cvt_pk_bf16_f32 v67, v118, v119
    buffer_store_dwordx4 v[64:67], v161, s[44:47], s73 offen sc1
    v_cvt_pk_bf16_f32 v68, v120, v121
    v_cvt_pk_bf16_f32 v69, v122, v123
    v_cvt_pk_bf16_f32 v70, v124, v125
    v_cvt_pk_bf16_f32 v71, v126, v127
    buffer_store_dwordx4 v[68:71], v161, s[44:47], s67 offen sc1
L_G_end:
L_end:
    s_endpgm
.section .rodata,"a"
.p2align 6
.amdhsa_kernel parallel_sum__grouped_kv_mqa__dense_activation_mish__prompt_kernel
  .amdhsa_next_free_vgpr 168
  .amdhsa_next_free_sgpr 102
  .amdhsa_accum_offset 168
  .amdhsa_group_segment_fixed_size 0
  .amdhsa_kernarg_size 96
  .amdhsa_user_sgpr_count 2
  .amdhsa_user_sgpr_kernarg_segment_ptr 1
  .amdhsa_system_sgpr_workgroup_id_x 1
.end_amdhsa_kernel
```
